```python
import torch

def _softmax(x, axis=-1):
    return torch.softmax(x, dim=axis)
def _gelu(x):
    return torch.nn.functional.gelu(x, approximate="tanh")
def _silu(x):
    return torch.nn.functional.silu(x)
def _sigmoid(x):
    return torch.sigmoid(x)
def _layernorm(x, axis=-1, eps=1e-5):
    m = x.mean(dim=axis, keepdim=True)
    v = x.var(dim=axis, keepdim=True, unbiased=False)
    return (x - m) / torch.sqrt(v + eps)
def _scatter_add(tgt, idx, src, axis=0):
    return tgt.clone().index_add_(axis, idx, src)
def _segment_sum(src, seg, n):
    out = torch.zeros((n,) + src.shape[1:], dtype=src.dtype)
    return out.index_add_(0, seg, src)
def _pad(x, pw):
    flat = tuple(v for pair in reversed(pw) for v in pair)
    return torch.nn.functional.pad(x, flat)

kernel_name = 'interleave_layers__sliding_block_cached__gqa_block_cached__decode'

def setup_inputs():

    _w = (lambda a: (lambda t: t.to(torch.bfloat16) if t.is_floating_point() else t)(torch.as_tensor(a)))
    def _A_setup():
        B, Sq, D = 2, 1, 640
        Hq, Hkv, Sk, Dh = 32, 32, 4096, 192
        assert Hq % Hkv == 0, (Hq, Hkv)
        return {
            "x": _w((lambda *s: torch.randn(*s, dtype=torch.bfloat16) * 0.1)(B, Sq, D)),
            "k_cache": _w((lambda *s: torch.randn(*s, dtype=torch.bfloat16) * 0.8)(B, Hkv, Sk, Dh)),
            "v_cache": _w((lambda *s: torch.randn(*s, dtype=torch.bfloat16) * 3.2)(B, Hkv, Sk, Dh)),
            "wq": _w((lambda *s: torch.randn(*s, dtype=torch.bfloat16) * 0.8)(D, Hq * Dh) * (D ** -0.5)),
            "wo": _w((lambda *s: torch.randn(*s, dtype=torch.bfloat16) * 3.2)(Hq * Dh, D) * ((Hq * Dh) ** -0.5)),
        }
    _A_in = _A_setup()

    def _B_setup():
        B, Sq, D = 2, 1, 640
        Hq, Hkv, Sk, Dh = 32, 32, 4096, 192
        assert Hq % Hkv == 0, (Hq, Hkv)
        return {
            "x": _w((lambda *s: torch.randn(*s, dtype=torch.bfloat16) * 0.1)(B, Sq, D)),
            "k_cache": _w((lambda *s: torch.randn(*s, dtype=torch.bfloat16) * 1.6)(B, Hkv, Sk, Dh)),
            "v_cache": _w((lambda *s: torch.randn(*s, dtype=torch.bfloat16) * 1.6)(B, Hkv, Sk, Dh)),
            "wq": _w((lambda *s: torch.randn(*s, dtype=torch.bfloat16) * 1.6)(D, Hq * Dh) * (D ** -0.5)),
            "wo": _w((lambda *s: torch.randn(*s, dtype=torch.bfloat16) * 1.6)(Hq * Dh, D) * ((Hq * Dh) ** -0.5)),
        }
    _B_in = _B_setup()

    return {
        "A_x": _A_in["x"],
        "A_k_cache": _A_in["k_cache"],
        "A_v_cache": _A_in["v_cache"],
        "A_wq": _A_in["wq"],
        "A_wo": _A_in["wo"],
        "B_x": _B_in["x"],
        "B_k_cache": _B_in["k_cache"],
        "B_v_cache": _B_in["v_cache"],
        "B_wq": _B_in["wq"],
        "B_wo": _B_in["wo"],
    }

def reference(A_x, A_k_cache, A_v_cache, A_wq, A_wo, B_x, B_k_cache, B_v_cache, B_wq, B_wo):
    def _A_ref(x, k_cache, v_cache, wq, wo):
        B, Sq, D = x.shape
        Hq, Dh = 32, 192
        Hkv, Sk = k_cache.shape[1], k_cache.shape[2]
        W = min(4096, max(256, Sk // 4))
        rep = Hq // Hkv
        q = (lambda x, *d: x.permute(*d))((x @ wq).reshape(B, Sq, Hq, Dh), 0, 2, 1, 3)
        k = (lambda x, n, axis: torch.repeat_interleave(x, n, dim=axis))(k_cache[:, :, Sk - W:, :], rep, axis=1)
        v = (lambda x, n, axis: torch.repeat_interleave(x, n, dim=axis))(v_cache[:, :, Sk - W:, :], rep, axis=1)
        scores = torch.einsum("bhqd,bhkd->bhqk", q, k) * (Dh ** -0.5)
        p = _softmax(scores, axis=-1)
        o = torch.einsum("bhqk,bhkd->bhqd", p, v)
        return (lambda x, *d: x.permute(*d))(o, 0, 2, 1, 3).reshape(B, Sq, Hq * Dh) @ wo

    def _B_ref(x, k_cache, v_cache, wq, wo):
        B, Sq, D = x.shape
        Hq, Dh = 32, 192
        Hkv = k_cache.shape[1]
        rep = Hq // Hkv
        q = (lambda x, *d: x.permute(*d))((x @ wq).reshape(B, Sq, Hq, Dh), 0, 2, 1, 3)
        k = (lambda x, n, axis: torch.repeat_interleave(x, n, dim=axis))(k_cache, rep, axis=1)
        v = (lambda x, n, axis: torch.repeat_interleave(x, n, dim=axis))(v_cache, rep, axis=1)
        scores = torch.einsum("bhqd,bhkd->bhqk", q, k) * (Dh ** -0.5)
        p = _softmax(scores, axis=-1)
        o = torch.einsum("bhqk,bhkd->bhqd", p, v)
        return (lambda x, *d: x.permute(*d))(o, 0, 2, 1, 3).reshape(B, Sq, Hq * Dh) @ wo

    x = A_x
    x = x + _A_ref(_layernorm(x, axis=-1), A_k_cache, A_v_cache, A_wq, A_wo)
    x = x + _B_ref(_layernorm(x, axis=-1), B_k_cache, B_v_cache, B_wq, B_wo)
    x = x + _A_ref(_layernorm(x, axis=-1), A_k_cache, A_v_cache, A_wq, A_wo)
    x = x + _B_ref(_layernorm(x, axis=-1), B_k_cache, B_v_cache, B_wq, B_wo)
    return x
```

```asm
; @launch grid=(256,1,1) block=(256,1,1) lds=160736
.amdgcn_target "amdgcn-amd-amdhsa--gfx950"
.text
.globl interleave_layers__sliding_block_cached__gqa_block_cached__decode_kernel
.p2align 8
.type interleave_layers__sliding_block_cached__gqa_block_cached__decode_kernel,@function
interleave_layers__sliding_block_cached__gqa_block_cached__decode_kernel:
  s_cmp_ge_u32 s2, 256
  s_cbranch_scc1 L_end
  s_load_dwordx16 s[32:47], s[0:1], 0
  s_load_dwordx8 s[48:55], s[0:1], 64
  s_load_dwordx2 s[56:57], s[0:1], 96
  v_lshrrev_b32 v8, 6, v0
  v_and_b32 v0, 63, v0
  v_readfirstlane_b32 s3, v8
  s_and_b32 s63, s2, 7
  s_lshl_b32 s63, s63, 2
  s_lshr_b32 s64, s2, 3
  s_and_b32 s64, s64, 3
  s_add_u32 s58, s63, s64
  s_lshr_b32 s59, s2, 5
  v_mul_u32_u24 v8, 43, v0
  v_lshrrev_b32 v8, 10, v8
  v_mul_u32_u24 v9, 24, v8
  v_sub_u32 v9, v0, v9
  v_mul_u32_u24 v8, 0x3000, v8
  v_lshl_add_u32 v252, v9, 4, v8
  v_add_u32 v10, 60, v0
  v_mul_u32_u24 v8, 43, v10
  v_lshrrev_b32 v8, 10, v8
  v_mul_u32_u24 v9, 24, v8
  v_sub_u32 v9, v10, v9
  v_mul_u32_u24 v8, 0x3000, v8
  v_lshl_add_u32 v253, v9, 4, v8
  s_mul_i32 s63, s59, 983040
  s_mul_i32 s64, s3, 245760
  s_add_u32 s63, s63, s64
  s_mul_i32 s64, s58, 384
  s_add_u32 s91, s63, s64
  s_mul_i32 s63, s58, 245760
  s_mul_i32 s64, s3, 61440
  s_add_u32 s63, s63, s64
  s_mul_i32 s64, s59, 160
  s_add_u32 s92, s63, s64
  s_mul_i32 s93, s3, 7680
  s_mov_b32 s88, -1
  s_mov_b32 s89, 0x0fffffff
  s_mov_b32 s27, 0x20000
  s_mov_b32 s62, 0
  v_and_b32 v8, 15, v0
  v_lshrrev_b32 v9, 4, v0
  v_lshrrev_b32 v10, 1, v8
  v_mul_u32_u24 v10, 384, v10
  v_and_b32 v11, 1, v8
  v_lshl_add_u32 v11, v9, 1, v11
  v_lshl_add_u32 v1, v11, 4, v10
  v_mul_u32_u24 v10, 768, v9
  v_lshl_add_u32 v2, v8, 4, v10
  s_mul_i32 s63, s58, 1572864
  s_mul_i32 s64, s59, 49152
  s_add_u32 s64, s64, s63
  s_mul_i32 s65, s3, 12288
  s_add_u32 s64, s64, s65
  s_add_u32 s72, s64, 1179648
  s_mul_i32 s64, s59, 196608
  s_add_u32 s64, s64, s63
  s_mul_i32 s65, s3, 49152
  s_add_u32 s73, s64, s65
  s_mul_i32 s94, s3, 6144
  s_add_u32 s94, s94, 122880
  s_mov_b32 s30, 2560
  s_mov_b32 s31, 0x20000
  s_mul_i32 s63, s59, 160
  v_lshlrev_b32 v7, 2, v0
  v_min_u32 v7, 156, v7
  s_sub_u32 s6, 100663296, s72
  s_mov_b32 s7, 0x20000
  s_sub_u32 s10, 100663296, s72
  s_mov_b32 s11, 0x20000
  s_sub_u32 s14, 100663296, s73
  s_mov_b32 s15, 0x20000
  s_sub_u32 s18, 100663296, s73
  s_mov_b32 s19, 0x20000
  s_mov_b32 s22, 434115584
  s_mov_b32 s23, 0x20000
  s_mul_i32 s67, s58, 16384
  s_mul_i32 s64, s59, 2048
  s_add_u32 s66, s67, s64
  s_mul_i32 s69, s58, 4096
  s_add_u32 s69, s69, 4194304
  s_mul_i32 s64, s59, 384
  s_add_u32 s68, s69, s64
  s_mul_i32 s71, s59, 6144
  s_add_u32 s71, s71, 5242880
  s_mul_i32 s64, s58, 192
  s_add_u32 s70, s71, s64
  v_mov_b32 v16, -1
  v_mov_b32 v17, -1
  v_mov_b32 v18, -1
  v_mov_b32 v19, -1
  v_lshlrev_b32 v14, 4, v0
  s_add_u32 s64, s66, 0
  s_mov_b32 s0, -1
  s_add_u32 s65, s66, 0
  s_mov_b32 s1, -1
  s_add_u32 s61, s66, 1024
  s_cmp_eq_u32 s3, 1
  s_cselect_b32 s64, s61, s64
  s_cselect_b32 s0, -1, s0
  s_add_u32 s61, s66, 1024
  s_cmp_eq_u32 s3, 1
  s_cselect_b32 s65, s61, s65
  s_cselect_b32 s1, -1, s1
  s_add_u32 s61, s66, 2097152
  s_cmp_eq_u32 s3, 2
  s_cselect_b32 s64, s61, s64
  s_cselect_b32 s0, -1, s0
  s_add_u32 s61, s66, 2097152
  s_cmp_eq_u32 s3, 2
  s_cselect_b32 s65, s61, s65
  s_cselect_b32 s1, -1, s1
  s_add_u32 s61, s68, 0
  s_cmp_eq_u32 s3, 3
  s_cselect_b32 s64, s61, s64
  s_cselect_b32 s0, 33554431, s0
  s_add_u32 s61, s70, 4294966784
  s_cmp_eq_u32 s3, 3
  s_cselect_b32 s65, s61, s65
  s_cselect_b32 s1, 4095, s1
  v_mov_b32 v15, s64
  v_mov_b32 v20, s65
  v_cmp_lt_u32 vcc, 31, v0
  s_nop 1
  v_cndmask_b32 v15, v15, v20, vcc
  v_add_u32 v15, v15, v14
  s_mov_b32 s64, 0
  s_mov_b32 s65, 0
  s_cmp_eq_u32 s3, 3
  s_cselect_b32 s64, 0x1000000, s64
  s_mul_i32 s61, s59, -368
  s_add_u32 s61, s61, 2688
  v_add_u32 v20, s61, v15
  v_cndmask_b32 v15, v15, v20, s[64:65]
  s_waitcnt lgkmcnt(0)
  s_add_u32 s4, s34, s72
  s_addc_u32 s5, s35, 0
  s_mov_b32 s61, 0
  buffer_load_dwordx4 a[0:3], v1, s[4:7], s61 offen offset:0 nt
  buffer_load_dwordx4 a[4:7], v1, s[4:7], s61 offen offset:128 nt
  buffer_load_dwordx4 a[8:11], v1, s[4:7], s61 offen offset:256 nt
  s_mov_b32 s61, 3072
  buffer_load_dwordx4 a[12:15], v1, s[4:7], s61 offen offset:0 nt
  buffer_load_dwordx4 a[16:19], v1, s[4:7], s61 offen offset:128 nt
  buffer_load_dwordx4 a[20:23], v1, s[4:7], s61 offen offset:256 nt
  s_mov_b32 s61, 6144
  buffer_load_dwordx4 a[24:27], v1, s[4:7], s61 offen offset:0 nt
  buffer_load_dwordx4 a[28:31], v1, s[4:7], s61 offen offset:128 nt
  buffer_load_dwordx4 a[32:35], v1, s[4:7], s61 offen offset:256 nt
  s_mov_b32 s61, 9216
  buffer_load_dwordx4 a[36:39], v1, s[4:7], s61 offen offset:0 nt
  buffer_load_dwordx4 a[40:43], v1, s[4:7], s61 offen offset:128 nt
  buffer_load_dwordx4 a[44:47], v1, s[4:7], s61 offen offset:256 nt
  s_add_u32 s8, s36, s72
  s_addc_u32 s9, s37, 0
  s_add_u32 s12, s44, s73
  s_addc_u32 s13, s45, 0
  s_add_u32 s16, s46, s73
  s_addc_u32 s17, s47, 0
  s_mov_b32 s20, s56
  s_mov_b32 s21, s57
  s_mov_b32 s28, s32
  s_mov_b32 s29, s33
  s_mov_b64 exec, s[0:1]
  buffer_store_dwordx4 v[16:19], v15, s[20:23], 0 offen sc1
  s_mov_b64 exec, -1
  buffer_load_dword v12, v7, s[28:31], s63 offen
  buffer_load_dword v13, v7, s[28:31], s63 offen offset:1280
  s_add_u32 s24, s38, s91
  s_addc_u32 s25, s39, 0
  s_sub_u32 s26, 7864320, s91
  s_add_u32 m0, s93, 0
  s_mov_b32 s61, 0
  s_mov_b64 exec, s[88:89]
  buffer_load_dwordx4 v252, s[24:27], s61 offen nt lds
  s_mov_b64 exec, -1
  s_add_u32 m0, s93, 960
  s_mov_b32 s61, 0
  s_mov_b64 exec, s[88:89]
  buffer_load_dwordx4 v253, s[24:27], s61 offen nt lds
  s_mov_b64 exec, -1
  s_add_u32 m0, s93, 1920
  s_mov_b32 s61, 61440
  s_mov_b64 exec, s[88:89]
  buffer_load_dwordx4 v252, s[24:27], s61 offen nt lds
  s_mov_b64 exec, -1
  s_add_u32 m0, s93, 2880
  s_mov_b32 s61, 61440
  s_mov_b64 exec, s[88:89]
  buffer_load_dwordx4 v253, s[24:27], s61 offen nt lds
  s_mov_b64 exec, -1
  s_add_u32 m0, s93, 3840
  s_mov_b32 s61, 122880
  s_mov_b64 exec, s[88:89]
  buffer_load_dwordx4 v252, s[24:27], s61 offen nt lds
  s_mov_b64 exec, -1
  s_add_u32 m0, s93, 4800
  s_mov_b32 s61, 122880
  s_mov_b64 exec, s[88:89]
  buffer_load_dwordx4 v253, s[24:27], s61 offen nt lds
  s_mov_b64 exec, -1
  s_add_u32 m0, s93, 5760
  s_mov_b32 s61, 184320
  s_mov_b64 exec, s[88:89]
  buffer_load_dwordx4 v252, s[24:27], s61 offen nt lds
  s_mov_b64 exec, -1
  s_add_u32 m0, s93, 6720
  s_mov_b32 s61, 184320
  s_mov_b64 exec, s[88:89]
  buffer_load_dwordx4 v253, s[24:27], s61 offen nt lds
  s_mov_b64 exec, -1
  s_mov_b32 s61, 0
  buffer_load_dwordx4 a[48:51], v2, s[8:11], s61 offen offset:0 nt
  buffer_load_dwordx4 a[52:55], v2, s[8:11], s61 offen offset:256 nt
  buffer_load_dwordx4 a[56:59], v2, s[8:11], s61 offen offset:512 nt
  s_mov_b32 s61, 3072
  buffer_load_dwordx4 a[60:63], v2, s[8:11], s61 offen offset:0 nt
  v_mul_u32_u24 v10, 26, v0
  v_lshrrev_b32 v10, 8, v10
  v_mul_u32_u24 v11, 10, v10
  v_sub_u32 v11, v0, v11
  v_mul_u32_u24 v10, 1280, v10
  v_lshl_add_u32 v254, v11, 4, v10
  v_and_b32 v10, 1, v0
  v_cmp_eq_u32 vcc, 1, v10
  v_mov_b32 v11, 0xffff
  v_mov_b32 v20, 0xffff0000
  v_cndmask_b32 v11, v11, v20, vcc
  v_bfe_u32 v10, v0, 1, 2
  v_cmp_eq_u32 vcc, 0, v10
  s_nop 1
  v_cndmask_b32 v3, 0, v11, vcc
  v_cmp_eq_u32 vcc, 1, v10
  s_nop 1
  v_cndmask_b32 v4, 0, v11, vcc
  v_cmp_eq_u32 vcc, 2, v10
  s_nop 1
  v_cndmask_b32 v5, 0, v11, vcc
  v_cmp_eq_u32 vcc, 3, v10
  s_nop 1
  v_cndmask_b32 v6, 0, v11, vcc
  s_mov_b32 s74, 0xaaaaaaaa
  s_mov_b32 s75, 0xaaaaaaaa
  s_mov_b32 s82, 0xffff0000
  s_mov_b32 s83, 0x0
  s_mov_b32 s84, 0x0
  s_mov_b32 s85, 0xffff
  s_mov_b32 s86, 0x0
  s_mov_b32 s87, 0xffff0000
  s_mov_b32 s80, 0x5555
  s_mov_b32 s81, 0x5555
  s_mov_b32 s32, 0x3ff03ff
  s_mov_b32 s33, 0x3ff03ff
  s_mov_b32 s100, 0xcccccccc
  s_mov_b32 s101, 0xcccccccc
  s_mov_b32 s36, 0x0
  s_mov_b32 s37, 0x80000000
  s_mov_b32 s98, 0xffffffff
  s_mov_b32 s99, 0xff
  s_cmp_eq_u32 s3, 3
  s_cselect_b64 s[42:43], -1, 0
  s_min_u32 s95, s3, 2
  s_lshl_b32 s95, s95, 6
  s_mul_i32 s63, s59, -368
  s_add_u32 s63, s63, 3072
  s_lshl_b32 s44, s3, 7
  s_cmp_eq_u32 s3, 3
  s_cselect_b32 s44, s63, s44
  s_mov_b32 s46, 0x55555555
  s_cselect_b32 s47, 0, s46
  s_cselect_b32 s46, 0x55, s46
  s_getreg_b32 s90, hwreg(HW_REG_XCC_ID, 0, 4)
  s_add_u32 s90, s90, 1
  s_mul_i32 s45, s3, 160
  s_add_u32 s45, s45, 156224
  s_mul_i32 s56, s3, 320
  s_add_u32 s56, s56, 153664
  s_mul_i32 s57, s3, 96
  s_add_u32 s57, s57, 157664
  v_add_u32 v10, s45, v7
  v_add_u32 v11, 157504, v7
  v_mov_b32 v20, 0x3f803f80
  ds_write_b32 v11, v20
  s_waitcnt vmcnt(13)
  ds_write_b32 v10, v12
  s_waitcnt vmcnt(12)
  ds_write_b32 v10, v13 offset:640
  s_mov_b32 s28, s52
  s_mov_b32 s29, s53
L_pf0:
  s_waitcnt lgkmcnt(0)
  s_barrier
  s_cmp_lg_u32 s3, 0
  s_cbranch_scc1 Ls1
  s_and_b32 s63, s2, 3
  s_lshl_b32 s63, s63, 3
  s_lshl_b32 s63, s90, s63
  s_and_b32 s64, s2, 0xfc
  v_mov_b32 v8, s64
  v_mov_b32 v9, s63
  s_mov_b64 exec, 1
  global_atomic_add v8, v9, s[54:55] sc1
  s_mov_b64 exec, -1
Ls1:
  s_waitcnt vmcnt(8)
  buffer_load_dwordx4 a[64:67], v2, s[8:11], s61 offen offset:256 nt
  s_waitcnt vmcnt(8)
  buffer_load_dwordx4 a[68:71], v2, s[8:11], s61 offen offset:512 nt
  s_waitcnt vmcnt(8)
  s_add_u32 m0, s94, 0
  s_mov_b32 s61, 6144
  buffer_load_dwordx4 v2, s[8:11], s61 offen nt lds
  s_waitcnt vmcnt(8)
  s_add_u32 m0, s94, 1024
  s_mov_b32 s61, 6400
  buffer_load_dwordx4 v2, s[8:11], s61 offen nt lds
  s_waitcnt vmcnt(8)
  s_add_u32 m0, s94, 2048
  s_mov_b32 s61, 6656
  buffer_load_dwordx4 v2, s[8:11], s61 offen nt lds
  s_waitcnt vmcnt(8)
  s_add_u32 m0, s94, 3072
  s_mov_b32 s61, 9216
  buffer_load_dwordx4 v2, s[8:11], s61 offen nt lds
  s_barrier
  v_bfe_u32 v7, v0, 2, 2
  v_lshrrev_b32 v9, 4, v0
  v_lshl_add_u32 v8, v9, 3, v7
  v_lshl_add_u32 v7, v9, 2, v7
  v_and_b32 v9, 3, v0
  v_lshlrev_b32 v9, 3, v9
  s_mul_i32 s63, s3, 96
  s_add_u32 s63, s63, 0
  v_add_u32 v9, s63, v9
  s_movk_i32 s63, 384
  v_mad_u32_u24 v8, v8, s63, v9
  v_mad_u32_u24 v7, v7, s63, v9
  ds_read_b64_tr_b16 v[24:25], v8 offset:0
  ds_read_b64_tr_b16 v[26:27], v8 offset:1536
  ds_read_b64_tr_b16 v[28:29], v8 offset:12288
  ds_read_b64_tr_b16 v[30:31], v8 offset:13824
  ds_read_b64_tr_b16 v[32:33], v7 offset:24576
  ds_read_b64_tr_b16 v[34:35], v8 offset:32
  ds_read_b64_tr_b16 v[36:37], v8 offset:1568
  ds_read_b64_tr_b16 v[38:39], v8 offset:12320
  ds_read_b64_tr_b16 v[40:41], v8 offset:13856
  ds_read_b64_tr_b16 v[42:43], v7 offset:24608
  ds_read_b64_tr_b16 v[44:45], v8 offset:64
  ds_read_b64_tr_b16 v[46:47], v8 offset:1600
  ds_read_b64_tr_b16 v[48:49], v8 offset:12352
  ds_read_b64_tr_b16 v[50:51], v8 offset:13888
  ds_read_b64_tr_b16 v[52:53], v7 offset:24640
  v_mov_b32 v22, s45
  v_mov_b32 v23, 157504
  v_cndmask_b32 v23, v22, v23, s[74:75]
  v_lshrrev_b32 v21, 4, v0
  v_lshl_add_u32 v22, v21, 4, v23
  v_lshl_add_u32 v23, v21, 3, v23
  ds_read_b128 v[12:15], v22 offset:0
  ds_read_b128 v[16:19], v22 offset:64
  ds_read_b64 v[20:21], v23 offset:128
  s_lshl_b32 s63, s3, 8
  v_lshl_add_u32 v7, v0, 2, s63
  s_add_u32 s73, s66, 0
  s_waitcnt lgkmcnt(2)
  v_mfma_f32_16x16x32_bf16 v[8:11], v[12:15], v[24:27], 0
  s_add_u32 m0, s94, 4096
  s_mov_b32 s61, 9472
  buffer_load_dwordx4 v2, s[8:11], s61 offen nt lds
  s_waitcnt lgkmcnt(1)
  v_mfma_f32_16x16x32_bf16 v[8:11], v[16:19], v[28:31], v[8:11]
  v_mfma_f32_16x16x32_bf16 v[24:27], v[12:15], v[34:37], 0
  v_mfma_f32_16x16x32_bf16 v[24:27], v[16:19], v[38:41], v[24:27]
  v_mfma_f32_16x16x32_bf16 v[28:31], v[12:15], v[44:47], 0
  v_mfma_f32_16x16x32_bf16 v[28:31], v[16:19], v[48:51], v[28:31]
  v_mfma_f32_16x16x32_bf16 v[34:37], v[12:15], v[12:15], 0
  v_mfma_f32_16x16x32_bf16 v[34:37], v[16:19], v[16:19], v[34:37]
  s_waitcnt lgkmcnt(0)
  v_mfma_f32_16x16x16_bf16 v[8:11], v[20:21], v[32:33], v[8:11]
  v_mfma_f32_16x16x16_bf16 v[24:27], v[20:21], v[42:43], v[24:27]
  s_nop 0
  v_mfma_f32_16x16x16_bf16 v[28:31], v[20:21], v[52:53], v[28:31]
  s_nop 0
  v_mfma_f32_16x16x16_bf16 v[34:37], v[20:21], v[20:21], v[34:37]
  s_nop 3
  v_cndmask_b32 v22, v8, v24, s[82:83]
  s_nop 0
  v_cndmask_b32 v22, v22, v28, s[84:85]
  s_nop 0
  v_cndmask_b32 v22, v22, v34, s[86:87]
  v_min_u32 v22, -2, v22
  buffer_store_dword v22, v7, s[20:23], s73 offen offset:0 sc1
  v_cndmask_b32 v23, v9, v25, s[82:83]
  s_add_u32 m0, s94, 5120
  s_mov_b32 s61, 9728
  buffer_load_dwordx4 v2, s[8:11], s61 offen nt lds
  v_cndmask_b32 v23, v23, v29, s[84:85]
  v_cndmask_b32 v23, v23, v34, s[86:87]
  v_min_u32 v23, -2, v23
  buffer_store_dword v23, v7, s[20:23], s73 offen offset:1024 sc1
  s_waitcnt vmcnt(8)
  s_add_u32 s24, s40, s92
  s_addc_u32 s25, s41, 0
  s_sub_u32 s26, 7864320, s92
  s_add_u32 m0, s93, 30720
  s_mov_b32 s61, 0
  s_mov_b64 exec, s[88:89]
  buffer_load_dwordx4 v254, s[24:27], s61 offen nt lds
  s_mov_b64 exec, -1
  s_waitcnt vmcnt(8)
  s_add_u32 m0, s93, 31680
  s_mov_b32 s61, 7680
  s_mov_b64 exec, s[88:89]
  buffer_load_dwordx4 v254, s[24:27], s61 offen nt lds
  s_mov_b64 exec, -1
  s_waitcnt vmcnt(8)
  s_add_u32 m0, s93, 32640
  s_mov_b32 s61, 15360
  s_mov_b64 exec, s[88:89]
  buffer_load_dwordx4 v254, s[24:27], s61 offen nt lds
  s_mov_b64 exec, -1
  s_waitcnt vmcnt(8)
  s_add_u32 m0, s93, 33600
  s_mov_b32 s61, 23040
  s_mov_b64 exec, s[88:89]
  buffer_load_dwordx4 v254, s[24:27], s61 offen nt lds
  s_mov_b64 exec, -1
  v_bfe_u32 v7, v0, 2, 2
  v_lshrrev_b32 v9, 4, v0
  v_lshl_add_u32 v8, v9, 3, v7
  v_lshl_add_u32 v7, v9, 2, v7
  v_and_b32 v9, 3, v0
  v_lshlrev_b32 v9, 3, v9
  s_mul_i32 s63, s3, 96
  s_add_u32 s63, s63, 0
  v_add_u32 v9, s63, v9
  s_movk_i32 s63, 384
  v_mad_u32_u24 v8, v8, s63, v9
  v_mad_u32_u24 v7, v7, s63, v9
  ds_read_b64_tr_b16 v[24:25], v8 offset:0
  ds_read_b64_tr_b16 v[26:27], v8 offset:1536
  ds_read_b64_tr_b16 v[28:29], v8 offset:12288
  ds_read_b64_tr_b16 v[30:31], v8 offset:13824
  ds_read_b64_tr_b16 v[32:33], v7 offset:24576
  ds_read_b64_tr_b16 v[34:35], v8 offset:32
  ds_read_b64_tr_b16 v[36:37], v8 offset:1568
  ds_read_b64_tr_b16 v[38:39], v8 offset:12320
  ds_read_b64_tr_b16 v[40:41], v8 offset:13856
  ds_read_b64_tr_b16 v[42:43], v7 offset:24608
  ds_read_b64_tr_b16 v[44:45], v8 offset:64
  ds_read_b64_tr_b16 v[46:47], v8 offset:1600
  ds_read_b64_tr_b16 v[48:49], v8 offset:12352
  ds_read_b64_tr_b16 v[50:51], v8 offset:13888
  ds_read_b64_tr_b16 v[52:53], v7 offset:24640
  v_mov_b32 v22, s45
  v_mov_b32 v23, 156864
  v_cndmask_b32 v23, v22, v23, s[74:75]
  v_lshrrev_b32 v21, 4, v0
  v_lshl_add_u32 v22, v21, 4, v23
  v_lshl_add_u32 v23, v21, 3, v23
  ds_read_b128 v[12:15], v22 offset:640
  ds_read_b128 v[16:19], v22 offset:704
  ds_read_b64 v[20:21], v23 offset:768
  s_lshl_b32 s63, s3, 8
  v_lshl_add_u32 v7, v0, 2, s63
  s_add_u32 s73, s66, 2097152
  s_waitcnt lgkmcnt(2)
  v_mfma_f32_16x16x32_bf16 v[8:11], v[12:15], v[24:27], 0
  s_waitcnt lgkmcnt(1)
  v_mfma_f32_16x16x32_bf16 v[8:11], v[16:19], v[28:31], v[8:11]
  s_add_u32 m0, s93, 34560
  s_mov_b32 s61, 30720
  s_mov_b64 exec, s[88:89]
  buffer_load_dwordx4 v254, s[24:27], s61 offen nt lds
  s_mov_b64 exec, -1
  v_mfma_f32_16x16x32_bf16 v[24:27], v[12:15], v[34:37], 0
  v_mfma_f32_16x16x32_bf16 v[24:27], v[16:19], v[38:41], v[24:27]
  v_mfma_f32_16x16x32_bf16 v[28:31], v[12:15], v[44:47], 0
  v_mfma_f32_16x16x32_bf16 v[28:31], v[16:19], v[48:51], v[28:31]
  v_mfma_f32_16x16x32_bf16 v[34:37], v[12:15], v[12:15], 0
  v_mfma_f32_16x16x32_bf16 v[34:37], v[16:19], v[16:19], v[34:37]
  s_waitcnt lgkmcnt(0)
  v_mfma_f32_16x16x16_bf16 v[8:11], v[20:21], v[32:33], v[8:11]
  v_mfma_f32_16x16x16_bf16 v[24:27], v[20:21], v[42:43], v[24:27]
  s_nop 0
  v_mfma_f32_16x16x16_bf16 v[28:31], v[20:21], v[52:53], v[28:31]
  s_nop 0
  v_mfma_f32_16x16x16_bf16 v[34:37], v[20:21], v[20:21], v[34:37]
  s_nop 3
  v_cndmask_b32 v22, v8, v24, s[82:83]
  s_nop 0
  v_cndmask_b32 v22, v22, v28, s[84:85]
  s_nop 0
  v_cndmask_b32 v22, v22, v34, s[86:87]
  v_min_u32 v22, -2, v22
  buffer_store_dword v22, v7, s[20:23], s73 offen offset:0 sc1
  s_waitcnt vmcnt(8)
  s_add_u32 m0, s93, 35520
  s_mov_b32 s61, 38400
  s_mov_b64 exec, s[88:89]
  buffer_load_dwordx4 v254, s[24:27], s61 offen nt lds
  s_mov_b64 exec, -1
  s_waitcnt vmcnt(8)
  s_add_u32 m0, s93, 36480
  s_mov_b32 s61, 46080
  s_mov_b64 exec, s[88:89]
  buffer_load_dwordx4 v254, s[24:27], s61 offen nt lds
  s_mov_b64 exec, -1
  s_waitcnt vmcnt(8)
  s_add_u32 m0, s93, 37440
  s_mov_b32 s61, 53760
  s_mov_b64 exec, s[88:89]
  buffer_load_dwordx4 v254, s[24:27], s61 offen nt lds
  s_mov_b64 exec, -1
  s_waitcnt vmcnt(8)
  s_add_u32 s24, s48, s91
  s_addc_u32 s25, s49, 0
  s_sub_u32 s26, 7864320, s91
  s_add_u32 m0, s93, 61440
  s_mov_b32 s61, 0
  s_mov_b64 exec, s[88:89]
  buffer_load_dwordx4 v252, s[24:27], s61 offen nt lds
  s_mov_b64 exec, -1
  s_waitcnt vmcnt(8)
  s_add_u32 m0, s93, 62400
  s_mov_b32 s61, 0
  s_mov_b64 exec, s[88:89]
  buffer_load_dwordx4 v253, s[24:27], s61 offen nt lds
  s_mov_b64 exec, -1
  s_waitcnt vmcnt(8)
  s_add_u32 m0, s93, 63360
  s_mov_b32 s61, 61440
  s_mov_b64 exec, s[88:89]
  buffer_load_dwordx4 v252, s[24:27], s61 offen nt lds
  s_mov_b64 exec, -1
  s_waitcnt vmcnt(8)
  s_add_u32 m0, s93, 64320
  s_mov_b32 s61, 61440
  s_mov_b64 exec, s[88:89]
  buffer_load_dwordx4 v253, s[24:27], s61 offen nt lds
  s_mov_b64 exec, -1
  v_lshlrev_b32 v7, 2, v0
  global_load_dword v8, v7, s[54:55] sc1
  s_waitcnt vmcnt(8)
  s_add_u32 m0, s93, 65280
  s_mov_b32 s61, 122880
  s_mov_b64 exec, s[88:89]
  buffer_load_dwordx4 v252, s[24:27], s61 offen nt lds
  s_mov_b64 exec, -1
  s_waitcnt vmcnt(8)
  s_add_u32 m0, s93, 66240
  s_mov_b32 s61, 122880
  s_mov_b64 exec, s[88:89]
  buffer_load_dwordx4 v253, s[24:27], s61 offen nt lds
  s_mov_b64 exec, -1
  s_waitcnt vmcnt(8)
  s_add_u32 m0, s93, 67200
  s_mov_b32 s61, 184320
  s_mov_b64 exec, s[88:89]
  buffer_load_dwordx4 v252, s[24:27], s61 offen nt lds
  s_mov_b64 exec, -1
  s_waitcnt vmcnt(8)
  s_add_u32 m0, s93, 68160
  s_mov_b32 s61, 184320
  s_mov_b64 exec, s[88:89]
  buffer_load_dwordx4 v253, s[24:27], s61 offen nt lds
  s_mov_b64 exec, -1
  s_waitcnt vmcnt(8)
  s_and_b32 s48, s59, 3
  s_lshl_b32 s49, s3, 2
  s_or_b32 s48, s48, s49
  s_xor_b32 s61, s48, 0
  s_mul_i32 s61, s61, 3072
  buffer_load_dwordx4 a[72:75], v1, s[12:15], s61 offen offset:0 nt
  s_waitcnt vmcnt(8)
  buffer_load_dwordx4 a[76:79], v1, s[12:15], s61 offen offset:128 nt
  s_waitcnt vmcnt(8)
  buffer_load_dwordx4 a[80:83], v1, s[12:15], s61 offen offset:256 nt
  s_waitcnt vmcnt(8)
  s_xor_b32 s61, s48, 1
  s_mul_i32 s61, s61, 3072
  buffer_load_dwordx4 a[84:87], v1, s[12:15], s61 offen offset:0 nt
  s_waitcnt vmcnt(8)
  buffer_load_dwordx4 a[88:91], v1, s[12:15], s61 offen offset:128 nt
Lc2:
  v_subrev_u32 v9, 0x01010101, v8
  v_not_b32 v10, v8
  v_and_b32 v9, v9, v10
  v_and_b32 v9, 0x80808080, v9
  v_cmp_ne_u32 vcc, 0, v9
  s_cbranch_vccnz Lr3
  s_and_b32 s63, s2, 3
  s_lshl_b32 s63, s63, 3
  v_lshrrev_b32 v8, s63, v8
  v_and_b32 v8, 0xff, v8
  s_bfe_u32 s63, s2, 0x30002
  v_and_b32 v9, 7, v0
  v_cmp_eq_u32 s[64:65], s63, v9
  v_cmp_ne_u32 vcc, s90, v8
  s_nop 0
  s_and_b64 vcc, vcc, s[64:65]
  s_cmp_eq_u64 vcc, 0
  s_cselect_b32 s60, 1, 0
  s_mul_i32 s38, s3, 256
  s_add_u32 s38, s38, 158432
  s_mul_i32 s39, s3, 1536
  s_add_u32 s39, s39, 147456
  s_mul_i32 s54, s3, 4
  s_add_u32 s54, s54, 153600
  s_mul_i32 s55, s3, 256
  s_add_u32 s55, s55, 147456
  s_lshl_b32 s96, s3, 8
  s_add_u32 s96, s96, s67
  v_mov_b32 v16, -1
  v_mov_b32 v17, -1
  v_mov_b32 v18, -1
  v_mov_b32 v19, -1
  v_lshlrev_b32 v14, 4, v0
  s_add_u32 s64, s66, 524288
  s_mov_b32 s0, -1
  s_add_u32 s65, s66, 524288
  s_mov_b32 s1, -1
  s_add_u32 s61, s66, 525312
  s_cmp_eq_u32 s3, 1
  s_cselect_b32 s64, s61, s64
  s_cselect_b32 s0, -1, s0
  s_add_u32 s61, s66, 525312
  s_cmp_eq_u32 s3, 1
  s_cselect_b32 s65, s61, s65
  s_cselect_b32 s1, -1, s1
  s_add_u32 s61, s66, 1048576
  s_cmp_eq_u32 s3, 2
  s_cselect_b32 s64, s61, s64
  s_cselect_b32 s0, -1, s0
  s_add_u32 s61, s66, 1048576
  s_cmp_eq_u32 s3, 2
  s_cselect_b32 s65, s61, s65
  s_cselect_b32 s1, -1, s1
  s_add_u32 s61, s68, 131072
  s_cmp_eq_u32 s3, 3
  s_cselect_b32 s64, s61, s64
  s_cselect_b32 s0, 33554431, s0
  s_add_u32 s61, s70, 48640
  s_cmp_eq_u32 s3, 3
  s_cselect_b32 s65, s61, s65
  s_cselect_b32 s1, 4095, s1
  v_mov_b32 v15, s64
  v_mov_b32 v20, s65
  v_cmp_lt_u32 vcc, 31, v0
  s_nop 1
  v_cndmask_b32 v15, v15, v20, vcc
  v_add_u32 v15, v15, v14
  s_mov_b32 s64, 0
  s_mov_b32 s65, 0
  s_cmp_eq_u32 s3, 3
  s_cselect_b32 s64, 0x1000000, s64
  s_mul_i32 s61, s59, -368
  s_add_u32 s61, s61, 2688
  v_add_u32 v20, s61, v15
  v_cndmask_b32 v15, v15, v20, s[64:65]
  s_mov_b64 exec, s[0:1]
  buffer_store_dwordx4 v[16:19], v15, s[20:23], 0 offen sc1
  s_mov_b64 exec, -1
  s_waitcnt vmcnt(8)
  s_xor_b32 s61, s48, 1
  s_mul_i32 s61, s61, 3072
  buffer_load_dwordx4 a[92:95], v1, s[12:15], s61 offen offset:256 nt
  v_mov_b32 v16, -1
  v_mov_b32 v17, -1
  v_mov_b32 v18, -1
  v_mov_b32 v19, -1
  v_lshlrev_b32 v14, 4, v0
  s_add_u32 s64, s70, 98304
  s_mov_b32 s0, 4095
  s_add_u32 s65, s70, 146944
  s_mov_b32 s1, 4095
  s_add_u32 s61, s70, 196608
  s_cmp_eq_u32 s3, 1
  s_cselect_b32 s64, s61, s64
  s_cselect_b32 s0, 4095, s0
  s_add_u32 s61, s70, 245248
  s_cmp_eq_u32 s3, 1
  s_cselect_b32 s65, s61, s65
  s_cselect_b32 s1, 4095, s1
  s_add_u32 s61, s70, 294912
  s_cmp_eq_u32 s3, 2
  s_cselect_b32 s64, s61, s64
  s_cselect_b32 s0, 4095, s0
  s_add_u32 s61, s70, 343552
  s_cmp_eq_u32 s3, 2
  s_cselect_b32 s65, s61, s65
  s_cselect_b32 s1, 4095, s1
  s_add_u32 s61, s70, 294912
  s_cmp_eq_u32 s3, 3
  s_cselect_b32 s64, s61, s64
  s_cselect_b32 s0, 4095, s0
  s_add_u32 s61, s70, 343552
  s_cmp_eq_u32 s3, 3
  s_cselect_b32 s65, s61, s65
  s_cselect_b32 s1, 4095, s1
  v_mov_b32 v15, s64
  v_mov_b32 v20, s65
  v_cmp_lt_u32 vcc, 31, v0
  s_nop 1
  v_cndmask_b32 v15, v15, v20, vcc
  v_add_u32 v15, v15, v14
  s_mov_b64 exec, s[0:1]
  buffer_store_dwordx4 v[16:19], v15, s[20:23], 0 offen sc1
  s_mov_b64 exec, -1
  s_waitcnt vmcnt(8)
  s_xor_b32 s61, s48, 2
  s_mul_i32 s61, s61, 3072
  buffer_load_dwordx4 a[96:99], v1, s[12:15], s61 offen offset:0 nt
  v_and_b32 v23, 15, v0
  v_lshrrev_b32 v54, 4, v0
  v_mul_u32_u24 v54, 2048, v54
  v_lshl_add_u32 v54, v23, 4, v54
  s_add_u32 s72, s96, 0
  s_add_u32 s35, s72, 8192
  buffer_load_dwordx4 v[12:15], v54, s[20:23], s72 offen sc1
  buffer_load_dwordx4 v[16:19], v54, s[20:23], s35 offen sc1
  buffer_load_dwordx4 v[20:23], v54, s[20:23], s72 offen offset:1024 sc1
  buffer_load_dwordx4 v[24:27], v54, s[20:23], s35 offen offset:1024 sc1
  v_and_b32 v32, 15, v0
  v_lshrrev_b32 v33, 4, v0
  v_and_b32 v34, 1, v33
  v_lshlrev_b32 v34, 1, v34
  v_lshrrev_b32 v28, 1, v33
  v_or_b32 v34, v34, v28
  v_lshl_add_u32 v34, v32, 2, v34
  v_lshl_add_u32 v34, v34, 1, s57
  v_lshl_add_u32 v29, v0, 2, s38
  v_and_b32 v30, 1, v0
  v_lshrrev_b32 v31, 4, v0
  v_lshlrev_b32 v31, 5, v31
  v_lshl_add_u32 v30, v30, 4, v31
  v_add_u32 v30, 157664, v30
  v_mov_b32 v35, 0x3c75e03e
  v_mov_b32 v32, 0x3e13985d
  v_mov_b32 v33, 0x3a71d1e6
  s_waitcnt vmcnt(8)
  buffer_load_dwordx4 a[100:103], v1, s[12:15], s61 offen offset:128 nt
  s_waitcnt vmcnt(8)
  buffer_load_dwordx4 a[104:107], v1, s[12:15], s61 offen offset:256 nt
  s_waitcnt vmcnt(8)
  s_xor_b32 s61, s48, 3
  s_mul_i32 s61, s61, 3072
  buffer_load_dwordx4 a[108:111], v1, s[12:15], s61 offen offset:0 nt
  s_waitcnt vmcnt(8)
  buffer_load_dwordx4 a[112:115], v1, s[12:15], s61 offen offset:128 nt
  s_waitcnt vmcnt(8)
  buffer_load_dwordx4 a[116:119], v1, s[12:15], s61 offen offset:256 nt
  s_waitcnt vmcnt(8)
  s_xor_b32 s61, s48, 4
  s_mul_i32 s61, s61, 3072
  buffer_load_dwordx4 a[120:123], v1, s[12:15], s61 offen offset:0 nt
  s_waitcnt vmcnt(8)
  buffer_load_dwordx4 a[124:127], v1, s[12:15], s61 offen offset:128 nt
  s_waitcnt vmcnt(8)
  buffer_load_dwordx4 a[128:131], v1, s[12:15], s61 offen offset:256 nt
  s_waitcnt vmcnt(8)
  s_xor_b32 s61, s48, 5
  s_mul_i32 s61, s61, 3072
  buffer_load_dwordx4 a[132:135], v1, s[12:15], s61 offen offset:0 nt
Lc4:
  v_max3_u32 v28, v12, v13, v14
  v_max3_u32 v28, v28, v15, v16
  v_max3_u32 v28, v28, v17, v18
  v_max3_u32 v28, v28, v19, v20
  v_max3_u32 v28, v28, v21, v22
  v_max3_u32 v28, v28, v23, v24
  v_max3_u32 v28, v28, v25, v26
  v_max_u32 v28, v28, v27
  v_cmp_eq_u32 vcc, -1, v28
  s_cbranch_vccnz Lr5
  v_pk_add_f32 v[12:13], v[12:13], v[16:17]
  v_pk_add_f32 v[14:15], v[14:15], v[18:19]
  s_nop 0
  v_permlane32_swap_b32 v12, v13
  v_permlane32_swap_b32 v14, v15
  v_add_f32 v12, v12, v13
  v_add_f32 v14, v14, v15
  s_nop 1
  v_permlane16_swap_b32 v12, v14
  v_add_f32 v12, v12, v14
  s_nop 0
  v_readlane_b32 s63, v12, 12
  v_readlane_b32 s64, v12, 44
  v_pk_add_f32 v[20:21], v[20:21], v[24:25]
  v_pk_add_f32 v[22:23], v[22:23], v[26:27]
  s_nop 0
  v_permlane32_swap_b32 v20, v21
  v_permlane32_swap_b32 v22, v23
  v_add_f32 v20, v20, v21
  v_add_f32 v22, v22, v23
  s_nop 1
  v_permlane16_swap_b32 v20, v22
  v_add_f32 v20, v20, v22
  v_mul_f32 v20, 0x3dd53b95, v20
  ds_write_b32 v29, v20 offset:0
  s_mov_b32 exec_lo, 0x0fff0fff
  s_mov_b32 exec_hi, 0x0fff0fff
  v_mul_f32 v15, s64, v35
  v_fma_f32 v14, s63, v32, v33
  v_fma_f32 v14, -v15, v15, v14
  v_max_f32 v14, v33, v14
  v_rsq_f32 v14, v14
  v_fma_f32 v12, -v15, v20, v12
  v_mul_f32 v12, v12, v14
  v_cvt_pk_bf16_f32 v12, v12, v12
  ds_write_b16 v34, v12 offset:0
  s_mov_b64 exec, -1
  s_waitcnt lgkmcnt(0)
  s_barrier
  v_and_b32 v30, 1, v0
  buffer_load_dwordx4 a[136:139], v1, s[12:15], s61 offen offset:128 nt
  v_lshrrev_b32 v31, 4, v0
  v_lshlrev_b32 v31, 5, v31
  v_lshl_add_u32 v30, v30, 4, v31
  v_add_u32 v30, 157664, v30
  ds_read_b128 v[12:15], v30 offset:0
  ds_read_b128 v[16:19], v30 offset:128
  ds_read_b128 v[20:23], v30 offset:256
  v_and_b32 v50, 15, v0
  v_lshlrev_b32 v50, 5, v50
  v_and_b32 v51, 16, v0
  v_add3_u32 v50, v50, v51, s39
  v_mov_b32 v51, s54
  v_bfe_u32 v8, v0, 1, 3
  v_lshrrev_b32 v9, 4, v0
  v_and_b32 v7, 1, v0
  s_waitcnt lgkmcnt(2)
  v_mfma_f32_16x16x32_bf16 v[24:27], a[0:3], v[12:15], 0
  v_lshl_add_u32 v7, v9, 1, v7
  v_lshlrev_b32 v7, 4, v7
  s_waitcnt lgkmcnt(1)
  v_mfma_f32_16x16x32_bf16 v[24:27], a[4:7], v[16:19], v[24:27]
  s_movk_i32 s63, 384
  v_mad_u32_u24 v7, v8, s63, v7
  s_waitcnt lgkmcnt(0)
  v_mfma_f32_16x16x32_bf16 v[24:27], a[8:11], v[20:23], v[24:27]
  buffer_load_dwordx4 a[140:143], v1, s[12:15], s61 offen offset:256 nt
  v_lshl_add_u32 v8, v9, 1, v8
  v_and_b32 v8, 7, v8
  v_mfma_f32_16x16x32_bf16 v[28:31], a[12:15], v[12:15], 0
  v_mul_u32_u24 v8, 16, v8
  s_add_u32 s76, s69, 0
  v_mfma_f32_16x16x32_bf16 v[28:31], a[16:19], v[16:19], v[28:31]
  v_mov_b32 v9, 153600
  v_lshl_add_u32 v10, v0, 2, s55
  v_mfma_f32_16x16x32_bf16 v[28:31], a[20:23], v[20:23], v[28:31]
  v_lshl_add_u32 v11, v0, 1, s44
  s_add_u32 s73, s68, 0
  v_mfma_f32_16x16x32_bf16 v[32:35], a[24:27], v[12:15], 0
  v_mfma_f32_16x16x32_bf16 v[32:35], a[28:31], v[16:19], v[32:35]
  v_add_f32_dpp v36, v24, v25 quad_perm:[0,0,2,2] row_mask:0xf bank_mask:0x1
  v_mfma_f32_16x16x32_bf16 v[32:35], a[32:35], v[20:23], v[32:35]
  s_nop 0
  v_add_f32_dpp v36, v26, v27 quad_perm:[0,0,2,2] row_mask:0xf bank_mask:0x4
  v_mfma_f32_16x16x32_bf16 v[24:27], a[36:39], v[12:15], 0
  v_mfma_f32_16x16x32_bf16 v[24:27], a[40:43], v[16:19], v[24:27]
  v_add_f32_dpp v36, v28, v29 quad_perm:[0,0,2,2] row_mask:0xf bank_mask:0x2
  v_mfma_f32_16x16x32_bf16 v[24:27], a[44:47], v[20:23], v[24:27]
  s_nop 0
  v_add_f32_dpp v36, v30, v31 quad_perm:[0,0,2,2] row_mask:0xf bank_mask:0x8
  v_add_f32_dpp v37, v32, v33 quad_perm:[0,0,2,2] row_mask:0xf bank_mask:0x1
  s_nop 1
  v_add_f32_dpp v37, v34, v35 quad_perm:[0,0,2,2] row_mask:0xf bank_mask:0x4
  s_nop 1
  v_add_f32_dpp v37, v24, v25 quad_perm:[0,0,2,2] row_mask:0xf bank_mask:0x2
  s_nop 1
  v_add_f32_dpp v37, v26, v27 quad_perm:[0,0,2,2] row_mask:0xf bank_mask:0x8
  v_max_f32 v52, v36, v37
  v_mov_b32_dpp v36, v36 quad_perm:[1,1,3,3] row_mask:0xf bank_mask:0xf
  v_mov_b32_dpp v37, v37 quad_perm:[1,1,3,3] row_mask:0xf bank_mask:0xf
  v_max_f32_dpp v52, v52, v52 row_ror:8 row_mask:0xf bank_mask:0xf
  s_nop 1
  v_max_f32_dpp v52, v52, v52 row_ror:4 row_mask:0xf bank_mask:0xf
  s_nop 1
  v_max_f32_dpp v52, v52, v52 row_bcast:15 row_mask:0xa bank_mask:0xf
  s_nop 1
  v_max_f32_dpp v52, v52, v52 row_bcast:31 row_mask:0xc bank_mask:0xf
  s_nop 0
  v_readlane_b32 s34, v52, 63
  s_nop 1
  v_subrev_f32 v36, s34, v36
  v_exp_f32 v36, v36
  v_subrev_f32 v37, s34, v37
  v_mov_b32 v53, v36
  v_cvt_pk_bf16_f32 v36, v36, v36
  v_exp_f32 v37, v37
  v_and_b32 v12, v36, v3
  s_xor_b32 s61, s48, 6
  s_mul_i32 s61, s61, 3072
  buffer_load_dwordx4 a[144:147], v1, s[12:15], s61 offen offset:0 nt
  v_and_b32 v13, v36, v4
  v_and_b32_dpp v14, v36, v5 row_shr:4 row_mask:0xf bank_mask:0xf bound_ctrl:0
  v_and_b32_dpp v15, v36, v6 row_shr:4 row_mask:0xf bank_mask:0xf bound_ctrl:0
  v_mov_b32 v52, s34
  ds_write_b32 v51, v52
  v_mfma_f32_16x16x32_bf16 v[24:27], v[12:15], a[48:51], 0
  v_and_b32 v18, v36, v5
  v_and_b32 v19, v36, v6
  v_mfma_f32_16x16x32_bf16 v[28:31], v[12:15], a[52:55], 0
  v_and_b32_dpp v16, v36, v3 row_shl:4 row_mask:0xf bank_mask:0xf bound_ctrl:0
  v_and_b32_dpp v17, v36, v4 row_shl:4 row_mask:0xf bank_mask:0xf bound_ctrl:0
  v_mfma_f32_16x16x32_bf16 v[32:35], v[12:15], a[56:59], 0
  v_add_f32 v53, v53, v37
  v_cvt_pk_bf16_f32 v37, v37, v37
  v_mfma_f32_16x16x32_bf16 v[24:27], v[16:19], a[60:63], v[24:27]
  v_and_b32 v12, v37, v3
  v_and_b32 v13, v37, v4
  v_mfma_f32_16x16x32_bf16 v[28:31], v[16:19], a[64:67], v[28:31]
  v_and_b32_dpp v14, v37, v5 row_shr:4 row_mask:0xf bank_mask:0xf bound_ctrl:0
  v_and_b32_dpp v15, v37, v6 row_shr:4 row_mask:0xf bank_mask:0xf bound_ctrl:0
  v_mfma_f32_16x16x32_bf16 v[32:35], v[16:19], a[68:71], v[32:35]
  v_lshl_add_u32 v54, v0, 4, s94
  ds_read_b128 v[38:41], v54 offset:0
  ds_read_b128 v[42:45], v54 offset:1024
  ds_read_b128 v[46:49], v54 offset:2048
  s_waitcnt lgkmcnt(2)
  v_mfma_f32_16x16x32_bf16 v[24:27], v[12:15], v[38:41], v[24:27]
  v_and_b32 v18, v37, v5
  v_and_b32 v19, v37, v6
  v_add_f32_dpp v53, v53, v53 row_ror:8 row_mask:0xf bank_mask:0xf
  s_waitcnt lgkmcnt(1)
  v_mfma_f32_16x16x32_bf16 v[28:31], v[12:15], v[42:45], v[28:31]
  buffer_load_dwordx4 a[148:151], v1, s[12:15], s61 offen offset:128 nt
  v_and_b32_dpp v16, v37, v3 row_shl:4 row_mask:0xf bank_mask:0xf bound_ctrl:0
  v_and_b32_dpp v17, v37, v4 row_shl:4 row_mask:0xf bank_mask:0xf bound_ctrl:0
  v_add_f32_dpp v53, v53, v53 row_ror:4 row_mask:0xf bank_mask:0xf
  s_waitcnt lgkmcnt(0)
  v_mfma_f32_16x16x32_bf16 v[32:35], v[12:15], v[46:49], v[32:35]
  v_add_f32_dpp v53, v53, v53 row_bcast:15 row_mask:0xa bank_mask:0xf
  v_lshl_add_u32 v54, v0, 4, s94
  ds_read_b128 v[38:41], v54 offset:3072
  ds_read_b128 v[42:45], v54 offset:4096
  ds_read_b128 v[46:49], v54 offset:5120
  s_waitcnt lgkmcnt(2)
  v_mfma_f32_16x16x32_bf16 v[24:27], v[16:19], v[38:41], v[24:27]
  v_add_f32_dpp v53, v53, v53 row_bcast:31 row_mask:0xc bank_mask:0xf
  s_waitcnt lgkmcnt(1)
  v_mfma_f32_16x16x32_bf16 v[28:31], v[16:19], v[42:45], v[28:31]
  s_mov_b64 exec, s[36:37]
  ds_write_b32 v51, v53 offset:16
  s_mov_b64 exec, -1
  s_waitcnt lgkmcnt(1)
  v_mfma_f32_16x16x32_bf16 v[32:35], v[16:19], v[46:49], v[32:35]
  s_mov_b32 exec_lo, 0xffffffff
  s_mov_b32 exec_hi, 0x0
  ds_write_b128 v50, v[24:27] offset:0
  s_mov_b32 exec_lo, 0xff00ff
  s_mov_b32 exec_hi, 0xff00ff00
  ds_write_b128 v50, v[28:31] offset:512
  s_mov_b32 exec_lo, 0x0
  s_mov_b32 exec_hi, 0xffffffff
  ds_write_b128 v50, v[32:35] offset:1024
  s_mov_b64 exec, -1
  s_waitcnt lgkmcnt(0)
  s_barrier
  ds_read_b128 v[44:47], v9
  ds_read_b128 v[48:51], v9 offset:16
  ds_read2st64_b32 v[12:13], v10 offset0:0 offset1:3
  ds_read2st64_b32 v[14:15], v10 offset0:6 offset1:9
  ds_read2st64_b32 v[16:17], v10 offset0:12 offset1:15
  ds_read2st64_b32 v[18:19], v10 offset0:18 offset1:21
  s_waitcnt lgkmcnt(5)
  v_max3_f32 v52, v44, v45, v46
  v_max_f32 v52, v52, v47
  v_sub_f32 v44, v44, v52
  v_sub_f32 v45, v45, v52
  v_sub_f32 v46, v46, v52
  v_sub_f32 v47, v47, v52
  v_exp_f32 v44, v44
  v_exp_f32 v45, v45
  v_exp_f32 v46, v46
  v_exp_f32 v47, v47
  s_waitcnt lgkmcnt(3)
  v_add_f32 v12, v12, v13
  s_waitcnt lgkmcnt(2)
  v_add_f32 v14, v14, v15
  s_waitcnt lgkmcnt(1)
  v_add_f32 v16, v16, v17
  s_waitcnt lgkmcnt(0)
  v_add_f32 v18, v18, v19
  v_mul_f32 v20, v44, v12
  v_fmac_f32 v20, v45, v14
  v_fmac_f32 v20, v46, v16
  v_fmac_f32 v20, v47, v18
  v_mul_f32 v53, v44, v48
  v_fmac_f32 v53, v45, v49
  v_mov_b32_dpp v21, v20 quad_perm:[1,1,3,3] row_mask:0xf bank_mask:0xf
  v_fmac_f32 v53, v46, v50
  v_fmac_f32 v53, v47, v51
  v_cvt_pk_bf16_f32 v20, v20, v21
  v_cndmask_b32 v52, v52, v53, s[100:101]
  v_cndmask_b32 v20, v20, v52, s[42:43]
  v_min_u32 v20, -2, v20
  s_mov_b64 exec, s[46:47]
  s_cmp_lg_u32 s60, 0
  s_cbranch_scc0 Le6
  buffer_store_dword v20, v11, s[20:23], s73 offen
Lf7:
  s_mov_b64 exec, -1
  v_and_b32 v23, 15, v0
  v_lshrrev_b32 v54, 4, v0
  v_mul_u32_u24 v54, 2048, v54
  v_lshl_add_u32 v54, v23, 4, v54
  s_add_u32 s72, s96, 2097152
  s_add_u32 s35, s72, 8192
  buffer_load_dwordx4 v[12:15], v54, s[20:23], s72 offen sc1
  buffer_load_dwordx4 v[16:19], v54, s[20:23], s35 offen sc1
  v_and_b32 v32, 15, v0
  v_lshrrev_b32 v33, 4, v0
  v_and_b32 v34, 1, v33
  v_lshlrev_b32 v34, 1, v34
  v_lshrrev_b32 v28, 1, v33
  v_or_b32 v34, v34, v28
  v_lshl_add_u32 v34, v32, 2, v34
  v_lshl_add_u32 v34, v34, 1, s57
  v_lshl_add_u32 v29, v0, 2, s38
  ds_read_b32 v20, v29 offset:0
  v_and_b32 v30, 1, v0
  v_lshrrev_b32 v31, 4, v0
  v_lshlrev_b32 v31, 5, v31
  v_lshl_add_u32 v30, v30, 4, v31
  v_add_u32 v30, 158048, v30
  v_mov_b32 v35, 0x3c75e03e
  v_mov_b32 v32, 0x3e13985d
  v_mov_b32 v33, 0x3a71d1e6
  s_waitcnt vmcnt(8)
  buffer_load_dwordx4 a[152:155], v1, s[12:15], s61 offen offset:256 nt
  s_waitcnt vmcnt(8)
  s_xor_b32 s61, s48, 7
  s_mul_i32 s61, s61, 3072
  buffer_load_dwordx4 a[156:159], v1, s[12:15], s61 offen offset:0 nt
  s_waitcnt vmcnt(8)
  buffer_load_dwordx4 a[160:163], v1, s[12:15], s61 offen offset:128 nt
  s_waitcnt vmcnt(8)
  buffer_load_dwordx4 a[164:167], v1, s[12:15], s61 offen offset:256 nt
  s_waitcnt vmcnt(8)
  s_xor_b32 s61, s48, 8
  s_mul_i32 s61, s61, 3072
  buffer_load_dwordx4 a[168:171], v1, s[12:15], s61 offen offset:0 nt
  s_waitcnt vmcnt(8)
  buffer_load_dwordx4 a[172:175], v1, s[12:15], s61 offen offset:128 nt
  s_waitcnt vmcnt(8)
  buffer_load_dwordx4 a[176:179], v1, s[12:15], s61 offen offset:256 nt
  s_waitcnt vmcnt(8)
  s_xor_b32 s61, s48, 9
  s_mul_i32 s61, s61, 3072
  buffer_load_dwordx4 a[180:183], v1, s[12:15], s61 offen offset:0 nt
  s_waitcnt vmcnt(8)
  buffer_load_dwordx4 a[184:187], v1, s[12:15], s61 offen offset:128 nt
Lc8:
  v_max3_u32 v28, v12, v13, v14
  v_max3_u32 v28, v28, v15, v16
  v_max3_u32 v28, v28, v17, v18
  v_max_u32 v28, v28, v19
  v_cmp_eq_u32 vcc, -1, v28
  s_cbranch_vccnz Lr9
  v_pk_add_f32 v[12:13], v[12:13], v[16:17]
  v_pk_add_f32 v[14:15], v[14:15], v[18:19]
  s_nop 0
  v_permlane32_swap_b32 v12, v13
  v_permlane32_swap_b32 v14, v15
  v_add_f32 v12, v12, v13
  v_add_f32 v14, v14, v15
  s_nop 1
  v_permlane16_swap_b32 v12, v14
  v_add_f32 v12, v12, v14
  s_nop 0
  v_readlane_b32 s63, v12, 12
  v_readlane_b32 s64, v12, 44
  s_mov_b32 exec_lo, 0x0fff0fff
  s_mov_b32 exec_hi, 0x0fff0fff
  v_mul_f32 v15, s64, v35
  v_fma_f32 v14, s63, v32, v33
  v_fma_f32 v14, -v15, v15, v14
  v_max_f32 v14, v33, v14
  v_rsq_f32 v14, v14
  s_waitcnt lgkmcnt(0)
  v_fma_f32 v12, -v15, v20, v12
  v_mul_f32 v12, v12, v14
  v_cvt_pk_bf16_f32 v12, v12, v12
  ds_write_b16 v34, v12 offset:384
  s_mov_b64 exec, -1
  s_waitcnt lgkmcnt(0)
  s_barrier
  s_waitcnt vmcnt(8)
  buffer_load_dwordx4 a[188:191], v1, s[12:15], s61 offen offset:256 nt
  s_waitcnt vmcnt(8)
  s_xor_b32 s61, s48, 10
  s_mul_i32 s61, s61, 3072
  buffer_load_dwordx4 a[192:195], v1, s[12:15], s61 offen offset:0 nt
  s_waitcnt vmcnt(8)
  buffer_load_dwordx4 a[196:199], v1, s[12:15], s61 offen offset:128 nt
  v_bfe_u32 v8, v0, 1, 3
  v_lshrrev_b32 v9, 4, v0
  v_and_b32 v7, 1, v0
  v_lshl_add_u32 v7, v9, 1, v7
  v_lshlrev_b32 v7, 4, v7
  s_movk_i32 s63, 384
  v_mad_u32_u24 v7, v8, s63, v7
  v_lshl_add_u32 v8, v9, 1, v8
  v_and_b32 v8, 7, v8
  v_mul_u32_u24 v8, 16, v8
  s_add_u32 s76, s69, 0
  buffer_load_dwordx2 v[52:53], v8, s[20:23], s76 offen offset:3072 sc1
  buffer_load_dwordx4 v[12:15], v7, s[20:23], s76 offen offset:0 sc1
  buffer_load_dwordx4 v[16:19], v7, s[20:23], s76 offen offset:128 sc1
  buffer_load_dwordx4 v[20:23], v7, s[20:23], s76 offen offset:256 sc1
  v_bfe_u32 v10, v0, 2, 2
  v_and_b32 v11, 48, v0
  v_add_u32 v10, v10, v11
  v_mul_u32_u24 v10, 160, v10
  v_and_b32 v11, 3, v0
  v_lshl_add_u32 v10, v11, 3, v10
  s_add_u32 s64, s95, 30720
  v_add_u32 v10, s64, v10
  ds_read_b64_tr_b16 v[24:25], v10 offset:0
  ds_read_b64_tr_b16 v[26:27], v10 offset:640
  ds_read_b64_tr_b16 v[28:29], v10 offset:1280
  ds_read_b64_tr_b16 v[30:31], v10 offset:1920
  ds_read_b64_tr_b16 v[32:33], v10 offset:10240
  ds_read_b64_tr_b16 v[34:35], v10 offset:10880
  ds_read_b64_tr_b16 v[36:37], v10 offset:11520
  ds_read_b64_tr_b16 v[38:39], v10 offset:12160
  ds_read_b64_tr_b16 v[40:41], v10 offset:20480
  ds_read_b64_tr_b16 v[42:43], v10 offset:21120
  ds_read_b64_tr_b16 v[44:45], v10 offset:21760
  ds_read_b64_tr_b16 v[46:47], v10 offset:22400
  v_and_b32 v11, 15, v0
  v_lshlrev_b32 v11, 1, v11
  v_and_b32 v9, 32, v0
  v_add3_u32 v11, v11, v9, s95
  s_add_u32 s73, s70, 0
  s_waitcnt vmcnt(8)
  buffer_load_dwordx4 a[200:203], v1, s[12:15], s61 offen offset:256 nt
  s_waitcnt vmcnt(8)
  s_xor_b32 s61, s48, 11
  s_mul_i32 s61, s61, 3072
  buffer_load_dwordx4 a[204:207], v1, s[12:15], s61 offen offset:0 nt
  s_waitcnt vmcnt(8)
  buffer_load_dwordx4 a[208:211], v1, s[12:15], s61 offen offset:128 nt
  s_waitcnt vmcnt(8)
  buffer_load_dwordx4 a[212:215], v1, s[12:15], s61 offen offset:256 nt
  s_waitcnt vmcnt(8)
  s_xor_b32 s61, s48, 12
  s_mul_i32 s61, s61, 3072
  buffer_load_dwordx4 a[216:219], v1, s[12:15], s61 offen offset:0 nt
  s_waitcnt vmcnt(8)
  buffer_load_dwordx4 a[220:223], v1, s[12:15], s61 offen offset:128 nt
  s_waitcnt vmcnt(8)
  buffer_load_dwordx4 a[224:227], v1, s[12:15], s61 offen offset:256 nt
  s_waitcnt vmcnt(8)
  s_xor_b32 s61, s48, 13
  s_mul_i32 s61, s61, 3072
  buffer_load_dwordx4 a[228:231], v1, s[12:15], s61 offen offset:0 nt
  s_waitcnt vmcnt(8)
  buffer_load_dwordx4 a[232:235], v1, s[12:15], s61 offen offset:128 nt
Lc10:
  s_waitcnt lgkmcnt(10)
  v_mfma_f32_16x16x32_bf16 v[48:51], v[12:15], v[24:27], 0
  v_max3_u32 v9, v52, v53, v12
  v_max3_u32 v9, v9, v13, v14
  v_max3_u32 v9, v9, v15, v16
  s_waitcnt lgkmcnt(6)
  v_mfma_f32_16x16x32_bf16 v[48:51], v[16:19], v[32:35], v[48:51]
  v_max3_u32 v9, v9, v17, v18
  v_max3_u32 v9, v9, v19, v20
  v_max3_u32 v9, v9, v21, v22
  s_waitcnt lgkmcnt(2)
  v_mfma_f32_16x16x32_bf16 v[48:51], v[20:23], v[40:43], v[48:51]
  v_max_u32 v9, v9, v23
  v_cmp_eq_u32 vcc, -1, v9
  s_cbranch_vccnz Lr11
  v_max_f32_dpp v9, v52, v52 row_ror:8 row_mask:0xf bank_mask:0xf
  v_mfma_f32_16x16x32_bf16 v[24:27], v[12:15], v[28:31], 0
  ds_read_b64_tr_b16 v[32:33], v10 offset:32
  ds_read_b64_tr_b16 v[34:35], v10 offset:672
  v_max_f32_dpp v9, v9, v9 row_ror:4 row_mask:0xf bank_mask:0xf
  v_mfma_f32_16x16x32_bf16 v[24:27], v[16:19], v[36:39], v[24:27]
  buffer_load_dwordx4 a[236:239], v1, s[12:15], s61 offen offset:256 nt
  ds_read_b64_tr_b16 v[40:41], v10 offset:10272
  ds_read_b64_tr_b16 v[42:43], v10 offset:10912
  v_max_f32_dpp v9, v9, v9 row_ror:2 row_mask:0xf bank_mask:0xf
  s_waitcnt lgkmcnt(4)
  v_mfma_f32_16x16x32_bf16 v[24:27], v[20:23], v[44:47], v[24:27]
  v_sub_f32 v52, v52, v9
  v_exp_f32 v52, v52
  ds_read_b64_tr_b16 v[28:29], v10 offset:20512
  ds_read_b64_tr_b16 v[30:31], v10 offset:21152
  v_mul_f32 v53, v52, v53
  ds_read_b64_tr_b16 v[36:37], v10 offset:1312
  ds_read_b64_tr_b16 v[38:39], v10 offset:1952
  v_add_f32_dpp v53, v53, v53 row_ror:8 row_mask:0xf bank_mask:0xf
  ds_read_b64_tr_b16 v[44:45], v10 offset:11552
  ds_read_b64_tr_b16 v[46:47], v10 offset:12192
  v_add_f32_dpp v53, v53, v53 row_ror:4 row_mask:0xf bank_mask:0xf
  v_add_f32 v48, v48, v25
  v_add_f32 v50, v50, v27
  v_add_f32_dpp v53, v53, v53 row_ror:2 row_mask:0xf bank_mask:0xf
  v_mov_b32 v7, v48
  v_mov_b32 v8, v50
  v_rcp_f32 v53, v53
  s_waitcnt lgkmcnt(8)
  v_mfma_f32_16x16x32_bf16 v[48:51], v[12:15], v[32:35], 0
  ds_read_b64_tr_b16 v[32:33], v10 offset:21792
  ds_read_b64_tr_b16 v[34:35], v10 offset:22432
  v_mul_f32 v9, v52, v53
  s_waitcnt lgkmcnt(8)
  v_mfma_f32_16x16x32_bf16 v[48:51], v[16:19], v[40:43], v[48:51]
  s_xor_b32 s61, s48, 14
  s_mul_i32 s61, s61, 3072
  buffer_load_dwordx4 a[240:243], v1, s[12:15], s61 offen offset:0 nt
  s_waitcnt lgkmcnt(6)
  v_mfma_f32_16x16x32_bf16 v[48:51], v[20:23], v[28:31], v[48:51]
  v_mul_f32_dpp v52, v9, v7 row_newbcast:0 row_mask:0xf bank_mask:0xf
  s_waitcnt lgkmcnt(4)
  v_mfma_f32_16x16x32_bf16 v[24:27], v[12:15], v[36:39], 0
  v_mov_b32_dpp v7, v9 row_newbcast:0 row_mask:0xf bank_mask:0xf
  s_waitcnt lgkmcnt(2)
  v_mfma_f32_16x16x32_bf16 v[24:27], v[16:19], v[44:47], v[24:27]
  v_fmac_f32_dpp v52, v9, v8 row_newbcast:2 row_mask:0xf bank_mask:0xf
  s_waitcnt lgkmcnt(0)
  v_mfma_f32_16x16x32_bf16 v[24:27], v[20:23], v[32:35], v[24:27]
  buffer_load_dwordx4 a[244:247], v1, s[12:15], s61 offen offset:128 nt
  v_mov_b32_dpp v8, v9 row_newbcast:2 row_mask:0xf bank_mask:0xf
  s_nop 5
  v_add_f32 v48, v48, v25
  v_add_f32 v50, v50, v27
  v_mul_f32 v53, v7, v48
  v_fmac_f32 v53, v8, v50
  s_nop 1
  v_permlane32_swap_b32 v52, v53
  v_add_f32 v52, v52, v53
  v_mov_b32 v53, v52
  s_nop 1
  v_permlane16_swap_b32 v52, v53
  v_add_f32 v52, v52, v53
  s_nop 1
  v_mov_b32_dpp v53, v52 quad_perm:[1,1,3,3] row_mask:0xf bank_mask:0xf
  v_cvt_pk_bf16_f32 v52, v52, v53
  v_min_u32 v52, -2, v52
  s_mov_b64 exec, s[80:81]
  buffer_store_dword v52, v11, s[20:23], s73 offen sc1
  s_mov_b64 exec, -1
  s_waitcnt vmcnt(8)
  buffer_load_dwordx4 a[248:251], v1, s[12:15], s61 offen offset:256 nt
  s_waitcnt vmcnt(8)
  s_xor_b32 s61, s48, 15
  s_mul_i32 s61, s61, 3072
  buffer_load_dwordx4 a[252:255], v1, s[12:15], s61 offen offset:0 nt
  s_waitcnt vmcnt(8)
  buffer_load_dwordx4 v[56:59], v1, s[12:15], s61 offen offset:128 nt
  s_waitcnt vmcnt(8)
  buffer_load_dwordx4 v[60:63], v1, s[12:15], s61 offen offset:256 nt
  s_waitcnt vmcnt(8)
  s_add_u32 s24, s50, s92
  s_addc_u32 s25, s51, 0
  s_sub_u32 s26, 7864320, s92
  s_add_u32 m0, s93, 92160
  s_mov_b32 s61, 0
  s_mov_b64 exec, s[88:89]
  buffer_load_dwordx4 v254, s[24:27], s61 offen nt lds
  s_mov_b64 exec, -1
  s_waitcnt vmcnt(8)
  s_add_u32 m0, s93, 93120
  s_mov_b32 s61, 7680
  s_mov_b64 exec, s[88:89]
  buffer_load_dwordx4 v254, s[24:27], s61 offen nt lds
  s_mov_b64 exec, -1
  s_waitcnt vmcnt(8)
  s_add_u32 m0, s93, 94080
  s_mov_b32 s61, 15360
  s_mov_b64 exec, s[88:89]
  buffer_load_dwordx4 v254, s[24:27], s61 offen nt lds
  s_mov_b64 exec, -1
  s_waitcnt vmcnt(8)
  s_add_u32 m0, s93, 95040
  s_mov_b32 s61, 23040
  s_mov_b64 exec, s[88:89]
  buffer_load_dwordx4 v254, s[24:27], s61 offen nt lds
  s_mov_b64 exec, -1
  s_waitcnt vmcnt(8)
  s_add_u32 m0, s93, 96000
  s_mov_b32 s61, 30720
  s_mov_b64 exec, s[88:89]
  buffer_load_dwordx4 v254, s[24:27], s61 offen nt lds
  s_mov_b64 exec, -1
  s_waitcnt vmcnt(8)
  s_add_u32 m0, s93, 96960
  s_mov_b32 s61, 38400
  s_mov_b64 exec, s[88:89]
  buffer_load_dwordx4 v254, s[24:27], s61 offen nt lds
  s_mov_b64 exec, -1
  s_waitcnt vmcnt(8)
  s_add_u32 m0, s93, 97920
  s_mov_b32 s61, 46080
  s_mov_b64 exec, s[88:89]
  buffer_load_dwordx4 v254, s[24:27], s61 offen nt lds
  s_mov_b64 exec, -1
  s_waitcnt vmcnt(8)
  s_add_u32 m0, s93, 98880
  s_mov_b32 s61, 53760
  s_mov_b64 exec, s[88:89]
  buffer_load_dwordx4 v254, s[24:27], s61 offen nt lds
  s_mov_b64 exec, -1
  s_waitcnt vmcnt(8)
  s_xor_b32 s61, s48, 0
  s_mul_i32 s61, s61, 3072
  buffer_load_dwordx4 v[64:67], v2, s[16:19], s61 offen offset:0 nt
  s_waitcnt vmcnt(8)
  buffer_load_dwordx4 v[68:71], v2, s[16:19], s61 offen offset:256 nt
  v_lshrrev_b32 v54, 4, v0
  v_mul_u32_u24 v54, 192, v54
  v_and_b32 v9, 15, v0
  v_lshl_add_u32 v54, v9, 4, v54
  s_mul_i32 s63, s3, 1536
  s_add_u32 s72, s71, s63
  s_add_u32 s72, s72, 0
  s_add_u32 s35, s72, 768
  v_and_b32 v16, 0x3f803f80, v3
  v_and_b32 v17, 0x3f803f80, v4
  v_and_b32 v18, 0x3f803f80, v5
  v_and_b32 v19, 0x3f803f80, v6
  v_mov_b32 v8, 0
  v_mov_b32 v9, 0
  v_mov_b32 v10, 0
  v_mov_b32 v11, 0
  v_mov_b32 v12, 0
  v_mov_b32 v13, 0
  v_mov_b32 v14, 0
  v_mov_b32 v15, 0
  s_mov_b64 exec, s[32:33]
  buffer_load_dwordx4 v[8:11], v54, s[20:23], s72 offen sc1
  buffer_load_dwordx4 v[12:15], v54, s[20:23], s35 offen sc1
  s_mov_b64 exec, -1
  s_waitcnt vmcnt(8)
  buffer_load_dwordx4 v[72:75], v2, s[16:19], s61 offen offset:512 nt
  s_waitcnt vmcnt(8)
  s_xor_b32 s61, s48, 1
  s_mul_i32 s61, s61, 3072
  buffer_load_dwordx4 v[76:79], v2, s[16:19], s61 offen offset:0 nt
  s_waitcnt vmcnt(8)
  buffer_load_dwordx4 v[80:83], v2, s[16:19], s61 offen offset:256 nt
  s_waitcnt vmcnt(8)
  buffer_load_dwordx4 v[84:87], v2, s[16:19], s61 offen offset:512 nt
  s_waitcnt vmcnt(8)
  s_xor_b32 s61, s48, 2
  s_mul_i32 s61, s61, 3072
  buffer_load_dwordx4 v[88:91], v2, s[16:19], s61 offen offset:0 nt
  s_waitcnt vmcnt(8)
  buffer_load_dwordx4 v[92:95], v2, s[16:19], s61 offen offset:256 nt
  s_waitcnt vmcnt(8)
  buffer_load_dwordx4 v[96:99], v2, s[16:19], s61 offen offset:512 nt
  s_waitcnt vmcnt(8)
  s_xor_b32 s61, s48, 3
  s_mul_i32 s61, s61, 3072
  buffer_load_dwordx4 v[100:103], v2, s[16:19], s61 offen offset:0 nt
  s_waitcnt vmcnt(8)
  buffer_load_dwordx4 v[104:107], v2, s[16:19], s61 offen offset:256 nt
Lc12:
  v_mfma_f32_16x16x32_bf16 v[20:23], v[16:19], v[8:11], 0
  v_max3_u32 v7, v8, v9, v10
  v_max3_u32 v7, v7, v11, v12
  v_max3_u32 v7, v7, v13, v14
  v_mfma_f32_16x16x32_bf16 v[20:23], v[16:19], v[12:15], v[20:23]
  v_max_u32 v7, v7, v15
  v_cmp_eq_u32 vcc, -1, v7
  s_cbranch_vccnz Lr13
  v_and_b32 v7, 15, v0
  v_lshlrev_b32 v7, 5, v7
  v_and_b32 v54, 16, v0
  v_add3_u32 v7, v7, v54, s56
  s_mov_b32 exec_lo, s32
  s_mov_b32 exec_hi, 0
  ds_write_b128 v7, v[20:23] offset:0
  s_mov_b64 exec, -1
  v_lshl_add_u32 v7, v0, 2, s45
  ds_read_b32 v54, v7 offset:0
  v_lshlrev_b32 v14, 3, v0
  v_add_u32 v14, 153664, v14
  v_mov_b32 v22, s45
  v_mov_b32 v23, 157504
  v_cndmask_b32 v23, v22, v23, s[74:75]
  v_lshrrev_b32 v21, 4, v0
  v_lshl_add_u32 v22, v21, 4, v23
  v_lshl_add_u32 v23, v21, 3, v23
  s_waitcnt lgkmcnt(0)
  s_barrier
  s_mov_b32 exec_hi, 0xff
  ds_read2_b64 v[8:11], v14 offset0:0 offset1:40
  ds_read2_b64 v[12:15], v14 offset0:80 offset1:120
  v_lshlrev_b32 v16, 16, v54
  v_and_b32 v17, 0xffff0000, v54
  s_waitcnt lgkmcnt(1)
  v_pk_add_f32 v[8:9], v[8:9], v[10:11]
  s_waitcnt lgkmcnt(0)
  v_pk_add_f32 v[12:13], v[12:13], v[14:15]
  v_pk_add_f32 v[8:9], v[8:9], v[12:13]
  v_cvt_pk_bf16_f32 v8, v8, v9
  v_and_b32 v9, 0xffff0000, v8
  v_lshlrev_b32 v8, 16, v8
  v_pk_add_f32 v[8:9], v[8:9], v[16:17]
  v_cvt_pk_bf16_f32 v8, v8, v9
  ds_write_b32 v7, v8 offset:0
  s_mov_b64 exec, -1
  v_bfe_u32 v7, v0, 2, 2
  buffer_load_dwordx4 v[108:111], v2, s[16:19], s61 offen offset:512 nt
  v_lshrrev_b32 v9, 4, v0
  v_lshl_add_u32 v8, v9, 3, v7
  v_lshl_add_u32 v7, v9, 2, v7
  v_and_b32 v9, 3, v0
  v_lshlrev_b32 v9, 3, v9
  s_mul_i32 s63, s3, 96
  s_add_u32 s63, s63, 61440
  v_add_u32 v9, s63, v9
  s_movk_i32 s63, 384
  v_mad_u32_u24 v8, v8, s63, v9
  v_mad_u32_u24 v7, v7, s63, v9
  ds_read_b64_tr_b16 v[24:25], v8 offset:0
  ds_read_b64_tr_b16 v[26:27], v8 offset:1536
  ds_read_b64_tr_b16 v[28:29], v8 offset:12288
  ds_read_b64_tr_b16 v[30:31], v8 offset:13824
  ds_read_b64_tr_b16 v[32:33], v7 offset:24576
  ds_read_b64_tr_b16 v[34:35], v8 offset:32
  ds_read_b64_tr_b16 v[36:37], v8 offset:1568
  ds_read_b64_tr_b16 v[38:39], v8 offset:12320
  ds_read_b64_tr_b16 v[40:41], v8 offset:13856
  ds_read_b64_tr_b16 v[42:43], v7 offset:24608
  ds_read_b64_tr_b16 v[44:45], v8 offset:64
  ds_read_b64_tr_b16 v[46:47], v8 offset:1600
  ds_read_b64_tr_b16 v[48:49], v8 offset:12352
  ds_read_b64_tr_b16 v[50:51], v8 offset:13888
  ds_read_b64_tr_b16 v[52:53], v7 offset:24640
  ds_read_b128 v[12:15], v22 offset:0
  ds_read_b128 v[16:19], v22 offset:64
  ds_read_b64 v[20:21], v23 offset:128
  v_lshl_add_u32 v7, v0, 2, s55
  s_add_u32 s73, s66, 376832
  s_waitcnt lgkmcnt(2)
  v_mfma_f32_16x16x32_bf16 v[8:11], v[12:15], v[24:27], 0
  s_waitcnt lgkmcnt(1)
  v_mfma_f32_16x16x32_bf16 v[8:11], v[16:19], v[28:31], v[8:11]
  s_xor_b32 s61, s48, 4
  s_mul_i32 s61, s61, 3072
  buffer_load_dwordx4 v[112:115], v2, s[16:19], s61 offen offset:0 nt
  v_mfma_f32_16x16x32_bf16 v[24:27], v[12:15], v[34:37], 0
  v_mfma_f32_16x16x32_bf16 v[24:27], v[16:19], v[38:41], v[24:27]
  v_mfma_f32_16x16x32_bf16 v[28:31], v[12:15], v[44:47], 0
  v_mfma_f32_16x16x32_bf16 v[28:31], v[16:19], v[48:51], v[28:31]
  v_mfma_f32_16x16x32_bf16 v[34:37], v[12:15], v[12:15], 0
  v_mfma_f32_16x16x32_bf16 v[34:37], v[16:19], v[16:19], v[34:37]
  s_waitcnt lgkmcnt(0)
  v_mfma_f32_16x16x16_bf16 v[8:11], v[20:21], v[32:33], v[8:11]
  v_mfma_f32_16x16x16_bf16 v[24:27], v[20:21], v[42:43], v[24:27]
  s_nop 0
  v_mfma_f32_16x16x16_bf16 v[28:31], v[20:21], v[52:53], v[28:31]
  s_nop 0
  v_mfma_f32_16x16x16_bf16 v[34:37], v[20:21], v[20:21], v[34:37]
  s_nop 3
  v_cndmask_b32 v22, v8, v24, s[82:83]
  s_nop 0
  v_cndmask_b32 v22, v22, v28, s[84:85]
  s_nop 0
  v_cndmask_b32 v22, v22, v34, s[86:87]
  v_min_u32 v22, -2, v22
  s_cmp_lg_u32 s60, 0
  s_cbranch_scc0 Le14
  buffer_store_dword v22, v7, s[20:23], s73 offen offset:0
Lf15:
  v_cndmask_b32 v23, v9, v25, s[82:83]
  v_cndmask_b32 v23, v23, v29, s[84:85]
  v_cndmask_b32 v23, v23, v34, s[86:87]
  v_min_u32 v23, -2, v23
  s_cmp_lg_u32 s60, 0
  s_cbranch_scc0 Le16
  buffer_store_dword v23, v7, s[20:23], s73 offen offset:1024
Lf17:
  buffer_load_dwordx4 v[116:119], v2, s[16:19], s61 offen offset:256 nt
  buffer_load_dwordx4 v[120:123], v2, s[16:19], s61 offen offset:512 nt
  s_xor_b32 s61, s48, 5
  s_mul_i32 s61, s61, 3072
  buffer_load_dwordx4 v[124:127], v2, s[16:19], s61 offen offset:0 nt
  s_cmp_lg_u32 s3, 3
  s_cbranch_scc1 Ls18
  s_call_b64 s[78:79], Lst0
  s_call_b64 s[78:79], Lst1
  s_call_b64 s[78:79], Lst2
  s_call_b64 s[78:79], LstR
Ls18:
  s_waitcnt vmcnt(8)
  buffer_load_dwordx4 v[128:131], v2, s[16:19], s61 offen offset:256 nt
  s_waitcnt vmcnt(8)
  buffer_load_dwordx4 v[132:135], v2, s[16:19], s61 offen offset:512 nt
  s_waitcnt vmcnt(8)
  s_xor_b32 s61, s48, 6
  s_mul_i32 s61, s61, 3072
  buffer_load_dwordx4 v[136:139], v2, s[16:19], s61 offen offset:0 nt
  s_waitcnt vmcnt(8)
  buffer_load_dwordx4 v[140:143], v2, s[16:19], s61 offen offset:256 nt
  s_waitcnt vmcnt(8)
  buffer_load_dwordx4 v[144:147], v2, s[16:19], s61 offen offset:512 nt
  s_waitcnt vmcnt(8)
  s_xor_b32 s61, s48, 7
  s_mul_i32 s61, s61, 3072
  buffer_load_dwordx4 v[148:151], v2, s[16:19], s61 offen offset:0 nt
  s_waitcnt vmcnt(8)
  buffer_load_dwordx4 v[152:155], v2, s[16:19], s61 offen offset:256 nt
  s_waitcnt vmcnt(8)
  buffer_load_dwordx4 v[156:159], v2, s[16:19], s61 offen offset:512 nt
  s_waitcnt vmcnt(8)
  s_xor_b32 s61, s48, 8
  s_mul_i32 s61, s61, 3072
  buffer_load_dwordx4 v[160:163], v2, s[16:19], s61 offen offset:0 nt
  s_waitcnt vmcnt(8)
  buffer_load_dwordx4 v[164:167], v2, s[16:19], s61 offen offset:256 nt
  v_and_b32 v23, 15, v0
  v_lshrrev_b32 v54, 4, v0
  v_mul_u32_u24 v54, 2048, v54
  v_lshl_add_u32 v54, v23, 4, v54
  s_add_u32 s72, s96, 524288
  s_add_u32 s35, s72, 8192
  buffer_load_dwordx4 v[12:15], v54, s[20:23], s72 offen sc1
  buffer_load_dwordx4 v[16:19], v54, s[20:23], s35 offen sc1
  buffer_load_dwordx4 v[20:23], v54, s[20:23], s72 offen offset:1024 sc1
  buffer_load_dwordx4 v[24:27], v54, s[20:23], s35 offen offset:1024 sc1
  v_and_b32 v32, 15, v0
  v_lshrrev_b32 v33, 4, v0
  v_and_b32 v34, 1, v33
  v_lshlrev_b32 v34, 1, v34
  v_lshrrev_b32 v28, 1, v33
  v_or_b32 v34, v34, v28
  v_lshl_add_u32 v34, v32, 2, v34
  v_lshl_add_u32 v34, v34, 1, s57
  v_lshl_add_u32 v29, v0, 2, s38
  v_and_b32 v30, 1, v0
  v_lshrrev_b32 v31, 4, v0
  v_lshlrev_b32 v31, 5, v31
  v_lshl_add_u32 v30, v30, 4, v31
  v_add_u32 v30, 157664, v30
  v_mov_b32 v35, 0x3c75e03e
  v_mov_b32 v32, 0x3e13985d
  v_mov_b32 v33, 0x3a71d1e6
  s_waitcnt vmcnt(8)
  buffer_load_dwordx4 v[168:171], v2, s[16:19], s61 offen offset:512 nt
  s_waitcnt vmcnt(8)
  s_xor_b32 s61, s48, 9
  s_mul_i32 s61, s61, 3072
  buffer_load_dwordx4 v[172:175], v2, s[16:19], s61 offen offset:0 nt
  s_waitcnt vmcnt(8)
  buffer_load_dwordx4 v[176:179], v2, s[16:19], s61 offen offset:256 nt
  s_waitcnt vmcnt(8)
  buffer_load_dwordx4 v[180:183], v2, s[16:19], s61 offen offset:512 nt
  s_waitcnt vmcnt(8)
  s_xor_b32 s61, s48, 10
  s_mul_i32 s61, s61, 3072
  buffer_load_dwordx4 v[184:187], v2, s[16:19], s61 offen offset:0 nt
  s_waitcnt vmcnt(8)
  buffer_load_dwordx4 v[188:191], v2, s[16:19], s61 offen offset:256 nt
  s_waitcnt vmcnt(8)
  buffer_load_dwordx4 v[192:195], v2, s[16:19], s61 offen offset:512 nt
  s_waitcnt vmcnt(8)
  s_xor_b32 s61, s48, 11
  s_mul_i32 s61, s61, 3072
  buffer_load_dwordx4 v[196:199], v2, s[16:19], s61 offen offset:0 nt
  s_waitcnt vmcnt(8)
  buffer_load_dwordx4 v[200:203], v2, s[16:19], s61 offen offset:256 nt
Lc19:
  v_max3_u32 v28, v12, v13, v14
  v_max3_u32 v28, v28, v15, v16
  v_max3_u32 v28, v28, v17, v18
  v_max3_u32 v28, v28, v19, v20
  v_max3_u32 v28, v28, v21, v22
  v_max3_u32 v28, v28, v23, v24
  v_max3_u32 v28, v28, v25, v26
  v_max_u32 v28, v28, v27
  v_cmp_eq_u32 vcc, -1, v28
  s_cbranch_vccnz Lr20
  v_pk_add_f32 v[12:13], v[12:13], v[16:17]
  v_pk_add_f32 v[14:15], v[14:15], v[18:19]
  s_nop 0
  v_permlane32_swap_b32 v12, v13
  v_permlane32_swap_b32 v14, v15
  v_add_f32 v12, v12, v13
  v_add_f32 v14, v14, v15
  s_nop 1
  v_permlane16_swap_b32 v12, v14
  v_add_f32 v12, v12, v14
  s_nop 0
  v_readlane_b32 s63, v12, 12
  v_readlane_b32 s64, v12, 44
  v_pk_add_f32 v[20:21], v[20:21], v[24:25]
  v_pk_add_f32 v[22:23], v[22:23], v[26:27]
  s_nop 0
  v_permlane32_swap_b32 v20, v21
  v_permlane32_swap_b32 v22, v23
  v_add_f32 v20, v20, v21
  v_add_f32 v22, v22, v23
  s_nop 1
  v_permlane16_swap_b32 v20, v22
  v_add_f32 v20, v20, v22
  v_mul_f32 v20, 0x3dd53b95, v20
  ds_write_b32 v29, v20 offset:1024
  s_mov_b32 exec_lo, 0x0fff0fff
  s_mov_b32 exec_hi, 0x0fff0fff
  v_mul_f32 v15, s64, v35
  v_fma_f32 v14, s63, v32, v33
  v_fma_f32 v14, -v15, v15, v14
  v_max_f32 v14, v33, v14
  v_rsq_f32 v14, v14
  v_fma_f32 v12, -v15, v20, v12
  v_mul_f32 v12, v12, v14
  v_cvt_pk_bf16_f32 v12, v12, v12
  ds_write_b16 v34, v12 offset:0
  s_mov_b64 exec, -1
  s_waitcnt lgkmcnt(0)
  s_barrier
L_pf1:
  ds_read_b128 v[12:15], v30 offset:0
  buffer_load_dwordx4 v[204:207], v2, s[16:19], s61 offen offset:512 nt
  ds_read_b128 v[16:19], v30 offset:128
  ds_read_b128 v[20:23], v30 offset:256
  v_and_b32 v50, 15, v0
  v_lshlrev_b32 v50, 5, v50
  v_and_b32 v51, 16, v0
  v_add3_u32 v50, v50, v51, s39
  v_mov_b32 v51, s54
  v_bfe_u32 v8, v0, 1, 3
  v_lshrrev_b32 v9, 4, v0
  v_and_b32 v7, 1, v0
  s_waitcnt lgkmcnt(2)
  v_mfma_f32_16x16x32_bf16 v[24:27], a[72:75], v[12:15], 0
  v_lshl_add_u32 v7, v9, 1, v7
  v_lshlrev_b32 v7, 4, v7
  s_waitcnt lgkmcnt(1)
  v_mfma_f32_16x16x32_bf16 v[24:27], a[76:79], v[16:19], v[24:27]
  s_movk_i32 s63, 384
  v_mad_u32_u24 v7, v8, s63, v7
  s_waitcnt lgkmcnt(0)
  v_mfma_f32_16x16x32_bf16 v[24:27], a[80:83], v[20:23], v[24:27]
  v_lshl_add_u32 v8, v9, 1, v8
  v_and_b32 v8, 7, v8
  v_mfma_f32_16x16x32_bf16 v[28:31], a[84:87], v[12:15], 0
  s_xor_b32 s61, s48, 12
  s_mul_i32 s61, s61, 3072
  buffer_load_dwordx4 v[208:211], v2, s[16:19], s61 offen offset:0 nt
  v_mul_u32_u24 v8, 16, v8
  s_add_u32 s76, s69, 131072
  v_mfma_f32_16x16x32_bf16 v[28:31], a[88:91], v[16:19], v[28:31]
  v_mov_b32 v9, 153600
  v_lshl_add_u32 v10, v0, 2, s55
  v_mfma_f32_16x16x32_bf16 v[28:31], a[92:95], v[20:23], v[28:31]
  v_lshl_add_u32 v11, v0, 1, s44
  s_add_u32 s73, s68, 131072
  v_mfma_f32_16x16x32_bf16 v[32:35], a[96:99], v[12:15], 0
  v_mfma_f32_16x16x32_bf16 v[32:35], a[100:103], v[16:19], v[32:35]
  v_add_f32_dpp v36, v24, v25 quad_perm:[0,0,2,2] row_mask:0xf bank_mask:0x1
  v_mfma_f32_16x16x32_bf16 v[32:35], a[104:107], v[20:23], v[32:35]
  s_nop 0
  v_add_f32_dpp v36, v26, v27 quad_perm:[0,0,2,2] row_mask:0xf bank_mask:0x4
  v_mfma_f32_16x16x32_bf16 v[24:27], a[108:111], v[12:15], 0
  v_mfma_f32_16x16x32_bf16 v[24:27], a[112:115], v[16:19], v[24:27]
  v_add_f32_dpp v36, v28, v29 quad_perm:[0,0,2,2] row_mask:0xf bank_mask:0x2
  v_mfma_f32_16x16x32_bf16 v[24:27], a[116:119], v[20:23], v[24:27]
  s_waitcnt vmcnt(8)
  buffer_load_dwordx4 v[212:215], v2, s[16:19], s61 offen offset:256 nt
  v_add_f32_dpp v36, v30, v31 quad_perm:[0,0,2,2] row_mask:0xf bank_mask:0x8
  v_mfma_f32_16x16x32_bf16 v[28:31], a[120:123], v[12:15], 0
  s_nop 0
  v_mov_b32_dpp v36, v36 quad_perm:[1,1,3,3] row_mask:0xf bank_mask:0xf
  v_mfma_f32_16x16x32_bf16 v[28:31], a[124:127], v[16:19], v[28:31]
  v_add_f32_dpp v37, v32, v33 quad_perm:[0,0,2,2] row_mask:0xf bank_mask:0x1
  v_mfma_f32_16x16x32_bf16 v[28:31], a[128:131], v[20:23], v[28:31]
  s_nop 0
  v_add_f32_dpp v37, v34, v35 quad_perm:[0,0,2,2] row_mask:0xf bank_mask:0x4
  v_mfma_f32_16x16x32_bf16 v[32:35], a[132:135], v[12:15], 0
  v_mfma_f32_16x16x32_bf16 v[32:35], a[136:139], v[16:19], v[32:35]
  v_add_f32_dpp v37, v24, v25 quad_perm:[0,0,2,2] row_mask:0xf bank_mask:0x2
  v_mfma_f32_16x16x32_bf16 v[32:35], a[140:143], v[20:23], v[32:35]
  s_nop 0
  v_add_f32_dpp v37, v26, v27 quad_perm:[0,0,2,2] row_mask:0xf bank_mask:0x8
  v_mfma_f32_16x16x32_bf16 v[24:27], a[144:147], v[12:15], 0
  s_nop 0
  v_mov_b32_dpp v37, v37 quad_perm:[1,1,3,3] row_mask:0xf bank_mask:0xf
  v_mfma_f32_16x16x32_bf16 v[24:27], a[148:151], v[16:19], v[24:27]
  v_add_f32_dpp v38, v28, v29 quad_perm:[0,0,2,2] row_mask:0xf bank_mask:0x1
  v_mfma_f32_16x16x32_bf16 v[24:27], a[152:155], v[20:23], v[24:27]
  s_nop 0
  v_add_f32_dpp v38, v30, v31 quad_perm:[0,0,2,2] row_mask:0xf bank_mask:0x4
  v_mfma_f32_16x16x32_bf16 v[28:31], a[156:159], v[12:15], 0
  v_mfma_f32_16x16x32_bf16 v[28:31], a[160:163], v[16:19], v[28:31]
  v_add_f32_dpp v38, v32, v33 quad_perm:[0,0,2,2] row_mask:0xf bank_mask:0x2
  v_mfma_f32_16x16x32_bf16 v[28:31], a[164:167], v[20:23], v[28:31]
  s_waitcnt vmcnt(8)
  buffer_load_dwordx4 v[216:219], v2, s[16:19], s61 offen offset:512 nt
  v_add_f32_dpp v38, v34, v35 quad_perm:[0,0,2,2] row_mask:0xf bank_mask:0x8
  v_mfma_f32_16x16x32_bf16 v[32:35], a[168:171], v[12:15], 0
  s_nop 0
  v_mov_b32_dpp v38, v38 quad_perm:[1,1,3,3] row_mask:0xf bank_mask:0xf
  v_mfma_f32_16x16x32_bf16 v[32:35], a[172:175], v[16:19], v[32:35]
  v_add_f32_dpp v39, v24, v25 quad_perm:[0,0,2,2] row_mask:0xf bank_mask:0x1
  v_mfma_f32_16x16x32_bf16 v[32:35], a[176:179], v[20:23], v[32:35]
  s_nop 0
  v_add_f32_dpp v39, v26, v27 quad_perm:[0,0,2,2] row_mask:0xf bank_mask:0x4
  v_mfma_f32_16x16x32_bf16 v[24:27], a[180:183], v[12:15], 0
  v_mfma_f32_16x16x32_bf16 v[24:27], a[184:187], v[16:19], v[24:27]
  v_add_f32_dpp v39, v28, v29 quad_perm:[0,0,2,2] row_mask:0xf bank_mask:0x2
  v_mfma_f32_16x16x32_bf16 v[24:27], a[188:191], v[20:23], v[24:27]
  s_nop 0
  v_add_f32_dpp v39, v30, v31 quad_perm:[0,0,2,2] row_mask:0xf bank_mask:0x8
  v_mfma_f32_16x16x32_bf16 v[28:31], a[192:195], v[12:15], 0
  s_nop 0
  v_mov_b32_dpp v39, v39 quad_perm:[1,1,3,3] row_mask:0xf bank_mask:0xf
  v_mfma_f32_16x16x32_bf16 v[28:31], a[196:199], v[16:19], v[28:31]
  v_add_f32_dpp v40, v32, v33 quad_perm:[0,0,2,2] row_mask:0xf bank_mask:0x1
  v_mfma_f32_16x16x32_bf16 v[28:31], a[200:203], v[20:23], v[28:31]
  s_nop 0
  v_add_f32_dpp v40, v34, v35 quad_perm:[0,0,2,2] row_mask:0xf bank_mask:0x4
  v_mfma_f32_16x16x32_bf16 v[32:35], a[204:207], v[12:15], 0
  v_mfma_f32_16x16x32_bf16 v[32:35], a[208:211], v[16:19], v[32:35]
  v_add_f32_dpp v40, v24, v25 quad_perm:[0,0,2,2] row_mask:0xf bank_mask:0x2
  v_mfma_f32_16x16x32_bf16 v[32:35], a[212:215], v[20:23], v[32:35]
  s_waitcnt vmcnt(8)
  s_xor_b32 s61, s48, 13
  s_mul_i32 s61, s61, 3072
  buffer_load_dwordx4 v[220:223], v2, s[16:19], s61 offen offset:0 nt
  v_add_f32_dpp v40, v26, v27 quad_perm:[0,0,2,2] row_mask:0xf bank_mask:0x8
  v_mfma_f32_16x16x32_bf16 v[24:27], a[216:219], v[12:15], 0
  s_nop 0
  v_mov_b32_dpp v40, v40 quad_perm:[1,1,3,3] row_mask:0xf bank_mask:0xf
  v_mfma_f32_16x16x32_bf16 v[24:27], a[220:223], v[16:19], v[24:27]
  v_add_f32_dpp v41, v28, v29 quad_perm:[0,0,2,2] row_mask:0xf bank_mask:0x1
  v_mfma_f32_16x16x32_bf16 v[24:27], a[224:227], v[20:23], v[24:27]
  s_nop 0
  v_add_f32_dpp v41, v30, v31 quad_perm:[0,0,2,2] row_mask:0xf bank_mask:0x4
  v_mfma_f32_16x16x32_bf16 v[28:31], a[228:231], v[12:15], 0
  v_mfma_f32_16x16x32_bf16 v[28:31], a[232:235], v[16:19], v[28:31]
  v_add_f32_dpp v41, v32, v33 quad_perm:[0,0,2,2] row_mask:0xf bank_mask:0x2
  v_mfma_f32_16x16x32_bf16 v[28:31], a[236:239], v[20:23], v[28:31]
  s_nop 0
  v_add_f32_dpp v41, v34, v35 quad_perm:[0,0,2,2] row_mask:0xf bank_mask:0x8
  v_mfma_f32_16x16x32_bf16 v[32:35], a[240:243], v[12:15], 0
  s_nop 0
  v_mov_b32_dpp v41, v41 quad_perm:[1,1,3,3] row_mask:0xf bank_mask:0xf
  v_mfma_f32_16x16x32_bf16 v[32:35], a[244:247], v[16:19], v[32:35]
  v_add_f32_dpp v42, v24, v25 quad_perm:[0,0,2,2] row_mask:0xf bank_mask:0x1
  v_mfma_f32_16x16x32_bf16 v[32:35], a[248:251], v[20:23], v[32:35]
  s_nop 0
  v_add_f32_dpp v42, v26, v27 quad_perm:[0,0,2,2] row_mask:0xf bank_mask:0x4
  v_mfma_f32_16x16x32_bf16 v[24:27], a[252:255], v[12:15], 0
  v_mfma_f32_16x16x32_bf16 v[24:27], v[56:59], v[16:19], v[24:27]
  v_add_f32_dpp v42, v28, v29 quad_perm:[0,0,2,2] row_mask:0xf bank_mask:0x2
  v_mfma_f32_16x16x32_bf16 v[24:27], v[60:63], v[20:23], v[24:27]
  s_waitcnt vmcnt(8)
  buffer_load_dwordx4 v[224:227], v2, s[16:19], s61 offen offset:256 nt
  v_add_f32_dpp v42, v30, v31 quad_perm:[0,0,2,2] row_mask:0xf bank_mask:0x8
  v_add_f32_dpp v43, v32, v33 quad_perm:[0,0,2,2] row_mask:0xf bank_mask:0x1
  s_nop 1
  v_add_f32_dpp v43, v34, v35 quad_perm:[0,0,2,2] row_mask:0xf bank_mask:0x4
  s_nop 1
  v_add_f32_dpp v43, v24, v25 quad_perm:[0,0,2,2] row_mask:0xf bank_mask:0x2
  v_max3_f32 v52, v36, v37, v38
  v_max3_f32 v52, v52, v39, v40
  v_add_f32_dpp v43, v26, v27 quad_perm:[0,0,2,2] row_mask:0xf bank_mask:0x8
  v_max3_f32 v52, v52, v41, v42
  v_max_f32 v52, v52, v43
  v_mov_b32_dpp v42, v42 quad_perm:[1,1,3,3] row_mask:0xf bank_mask:0xf
  v_mov_b32_dpp v43, v43 quad_perm:[1,1,3,3] row_mask:0xf bank_mask:0xf
  v_max_f32_dpp v52, v52, v52 row_ror:8 row_mask:0xf bank_mask:0xf
  s_nop 1
  v_max_f32_dpp v52, v52, v52 row_ror:4 row_mask:0xf bank_mask:0xf
  s_nop 1
  v_max_f32_dpp v52, v52, v52 row_bcast:15 row_mask:0xa bank_mask:0xf
  s_nop 1
  v_max_f32_dpp v52, v52, v52 row_bcast:31 row_mask:0xc bank_mask:0xf
  s_nop 0
  v_readlane_b32 s34, v52, 63
  s_nop 1
  v_subrev_f32 v36, s34, v36
  v_exp_f32 v36, v36
  v_subrev_f32 v37, s34, v37
  v_mov_b32 v53, v36
  v_cvt_pk_bf16_f32 v36, v36, v36
  v_exp_f32 v37, v37
  v_and_b32 v12, v36, v3
  v_and_b32 v13, v36, v4
  v_and_b32_dpp v14, v36, v5 row_shr:4 row_mask:0xf bank_mask:0xf bound_ctrl:0
  v_and_b32_dpp v15, v36, v6 row_shr:4 row_mask:0xf bank_mask:0xf bound_ctrl:0
  v_mov_b32 v52, s34
  ds_write_b32 v51, v52
  v_mfma_f32_16x16x32_bf16 v[24:27], v[12:15], v[64:67], 0
  v_and_b32 v18, v36, v5
  v_and_b32 v19, v36, v6
  v_mfma_f32_16x16x32_bf16 v[28:31], v[12:15], v[68:71], 0
  v_and_b32_dpp v16, v36, v3 row_shl:4 row_mask:0xf bank_mask:0xf bound_ctrl:0
  v_and_b32_dpp v17, v36, v4 row_shl:4 row_mask:0xf bank_mask:0xf bound_ctrl:0
  v_mfma_f32_16x16x32_bf16 v[32:35], v[12:15], v[72:75], 0
  v_add_f32 v53, v53, v37
  v_cvt_pk_bf16_f32 v37, v37, v37
  s_branch Lpg0
.p2align 12
Lst0:
  s_setpc_b64 s[78:79]
Lpg0:
  v_mfma_f32_16x16x32_bf16 v[24:27], v[16:19], v[76:79], v[24:27]
  v_and_b32 v12, v37, v3
  v_and_b32 v13, v37, v4
  v_mfma_f32_16x16x32_bf16 v[28:31], v[16:19], v[80:83], v[28:31]
  v_and_b32_dpp v14, v37, v5 row_shr:4 row_mask:0xf bank_mask:0xf bound_ctrl:0
  v_and_b32_dpp v15, v37, v6 row_shr:4 row_mask:0xf bank_mask:0xf bound_ctrl:0
  v_mfma_f32_16x16x32_bf16 v[32:35], v[16:19], v[84:87], v[32:35]
  v_subrev_f32 v38, s34, v38
  v_exp_f32 v38, v38
  v_mfma_f32_16x16x32_bf16 v[24:27], v[12:15], v[88:91], v[24:27]
  buffer_load_dwordx4 v[228:231], v2, s[16:19], s61 offen offset:512 nt
  v_and_b32 v18, v37, v5
  v_and_b32 v19, v37, v6
  v_mfma_f32_16x16x32_bf16 v[28:31], v[12:15], v[92:95], v[28:31]
  v_and_b32_dpp v16, v37, v3 row_shl:4 row_mask:0xf bank_mask:0xf bound_ctrl:0
  v_and_b32_dpp v17, v37, v4 row_shl:4 row_mask:0xf bank_mask:0xf bound_ctrl:0
  v_mfma_f32_16x16x32_bf16 v[32:35], v[12:15], v[96:99], v[32:35]
  v_add_f32 v53, v53, v38
  v_cvt_pk_bf16_f32 v38, v38, v38
  v_mfma_f32_16x16x32_bf16 v[24:27], v[16:19], v[100:103], v[24:27]
  v_and_b32 v12, v38, v3
  v_and_b32 v13, v38, v4
  v_mfma_f32_16x16x32_bf16 v[28:31], v[16:19], v[104:107], v[28:31]
  v_and_b32_dpp v14, v38, v5 row_shr:4 row_mask:0xf bank_mask:0xf bound_ctrl:0
  v_and_b32_dpp v15, v38, v6 row_shr:4 row_mask:0xf bank_mask:0xf bound_ctrl:0
  v_mfma_f32_16x16x32_bf16 v[32:35], v[16:19], v[108:111], v[32:35]
  v_subrev_f32 v39, s34, v39
  v_exp_f32 v39, v39
  v_mfma_f32_16x16x32_bf16 v[24:27], v[12:15], v[112:115], v[24:27]
  v_and_b32 v18, v38, v5
  v_and_b32 v19, v38, v6
  v_mfma_f32_16x16x32_bf16 v[28:31], v[12:15], v[116:119], v[28:31]
  v_and_b32_dpp v16, v38, v3 row_shl:4 row_mask:0xf bank_mask:0xf bound_ctrl:0
  v_and_b32_dpp v17, v38, v4 row_shl:4 row_mask:0xf bank_mask:0xf bound_ctrl:0
  v_mfma_f32_16x16x32_bf16 v[32:35], v[12:15], v[120:123], v[32:35]
  v_add_f32 v53, v53, v39
  v_cvt_pk_bf16_f32 v39, v39, v39
  v_mfma_f32_16x16x32_bf16 v[24:27], v[16:19], v[124:127], v[24:27]
  v_and_b32 v12, v39, v3
  v_and_b32 v13, v39, v4
  v_mfma_f32_16x16x32_bf16 v[28:31], v[16:19], v[128:131], v[28:31]
  v_and_b32_dpp v14, v39, v5 row_shr:4 row_mask:0xf bank_mask:0xf bound_ctrl:0
  v_and_b32_dpp v15, v39, v6 row_shr:4 row_mask:0xf bank_mask:0xf bound_ctrl:0
  v_mfma_f32_16x16x32_bf16 v[32:35], v[16:19], v[132:135], v[32:35]
  v_subrev_f32 v40, s34, v40
  v_exp_f32 v40, v40
  v_mfma_f32_16x16x32_bf16 v[24:27], v[12:15], v[136:139], v[24:27]
  v_and_b32 v18, v39, v5
  v_and_b32 v19, v39, v6
  v_mfma_f32_16x16x32_bf16 v[28:31], v[12:15], v[140:143], v[28:31]
  v_and_b32_dpp v16, v39, v3 row_shl:4 row_mask:0xf bank_mask:0xf bound_ctrl:0
  v_and_b32_dpp v17, v39, v4 row_shl:4 row_mask:0xf bank_mask:0xf bound_ctrl:0
  v_mfma_f32_16x16x32_bf16 v[32:35], v[12:15], v[144:147], v[32:35]
  v_add_f32 v53, v53, v40
  v_cvt_pk_bf16_f32 v40, v40, v40
  v_mfma_f32_16x16x32_bf16 v[24:27], v[16:19], v[148:151], v[24:27]
  v_and_b32 v12, v40, v3
  v_and_b32 v13, v40, v4
  s_xor_b32 s61, s48, 14
  s_mul_i32 s61, s61, 3072
  buffer_load_dwordx4 v[232:235], v2, s[16:19], s61 offen offset:0 nt
  v_mfma_f32_16x16x32_bf16 v[28:31], v[16:19], v[152:155], v[28:31]
  v_and_b32_dpp v14, v40, v5 row_shr:4 row_mask:0xf bank_mask:0xf bound_ctrl:0
  v_and_b32_dpp v15, v40, v6 row_shr:4 row_mask:0xf bank_mask:0xf bound_ctrl:0
  v_mfma_f32_16x16x32_bf16 v[32:35], v[16:19], v[156:159], v[32:35]
  v_subrev_f32 v41, s34, v41
  v_exp_f32 v41, v41
  v_mfma_f32_16x16x32_bf16 v[24:27], v[12:15], v[160:163], v[24:27]
  v_and_b32 v18, v40, v5
  v_and_b32 v19, v40, v6
  v_mfma_f32_16x16x32_bf16 v[28:31], v[12:15], v[164:167], v[28:31]
  v_and_b32_dpp v16, v40, v3 row_shl:4 row_mask:0xf bank_mask:0xf bound_ctrl:0
  v_and_b32_dpp v17, v40, v4 row_shl:4 row_mask:0xf bank_mask:0xf bound_ctrl:0
  v_mfma_f32_16x16x32_bf16 v[32:35], v[12:15], v[168:171], v[32:35]
  v_add_f32 v53, v53, v41
  v_cvt_pk_bf16_f32 v41, v41, v41
  v_mfma_f32_16x16x32_bf16 v[24:27], v[16:19], v[172:175], v[24:27]
  v_and_b32 v12, v41, v3
  v_and_b32 v13, v41, v4
  v_mfma_f32_16x16x32_bf16 v[28:31], v[16:19], v[176:179], v[28:31]
  v_and_b32_dpp v14, v41, v5 row_shr:4 row_mask:0xf bank_mask:0xf bound_ctrl:0
  v_and_b32_dpp v15, v41, v6 row_shr:4 row_mask:0xf bank_mask:0xf bound_ctrl:0
  v_mfma_f32_16x16x32_bf16 v[32:35], v[16:19], v[180:183], v[32:35]
  v_subrev_f32 v42, s34, v42
  v_exp_f32 v42, v42
  v_mfma_f32_16x16x32_bf16 v[24:27], v[12:15], v[184:187], v[24:27]
  v_and_b32 v18, v41, v5
  v_and_b32 v19, v41, v6
  v_mfma_f32_16x16x32_bf16 v[28:31], v[12:15], v[188:191], v[28:31]
  v_and_b32_dpp v16, v41, v3 row_shl:4 row_mask:0xf bank_mask:0xf bound_ctrl:0
  v_and_b32_dpp v17, v41, v4 row_shl:4 row_mask:0xf bank_mask:0xf bound_ctrl:0
  s_waitcnt vmcnt(10)
  v_mfma_f32_16x16x32_bf16 v[32:35], v[12:15], v[192:195], v[32:35]
  v_add_f32 v53, v53, v42
  v_cvt_pk_bf16_f32 v42, v42, v42
  s_waitcnt vmcnt(9)
  v_mfma_f32_16x16x32_bf16 v[24:27], v[16:19], v[196:199], v[24:27]
  v_and_b32 v12, v42, v3
  v_and_b32 v13, v42, v4
  s_waitcnt vmcnt(8)
  v_mfma_f32_16x16x32_bf16 v[28:31], v[16:19], v[200:203], v[28:31]
  v_and_b32_dpp v14, v42, v5 row_shr:4 row_mask:0xf bank_mask:0xf bound_ctrl:0
  v_and_b32_dpp v15, v42, v6 row_shr:4 row_mask:0xf bank_mask:0xf bound_ctrl:0
  s_waitcnt vmcnt(7)
  v_mfma_f32_16x16x32_bf16 v[32:35], v[16:19], v[204:207], v[32:35]
  v_subrev_f32 v43, s34, v43
  v_exp_f32 v43, v43
  buffer_load_dwordx4 v[236:239], v2, s[16:19], s61 offen offset:256 nt
  buffer_load_dwordx4 v[240:243], v2, s[16:19], s61 offen offset:512 nt
  s_waitcnt vmcnt(8)
  v_mfma_f32_16x16x32_bf16 v[24:27], v[12:15], v[208:211], v[24:27]
  v_and_b32 v18, v42, v5
  v_and_b32 v19, v42, v6
  s_waitcnt vmcnt(7)
  v_mfma_f32_16x16x32_bf16 v[28:31], v[12:15], v[212:215], v[28:31]
  v_and_b32_dpp v16, v42, v3 row_shl:4 row_mask:0xf bank_mask:0xf bound_ctrl:0
  v_and_b32_dpp v17, v42, v4 row_shl:4 row_mask:0xf bank_mask:0xf bound_ctrl:0
  s_waitcnt vmcnt(6)
  v_mfma_f32_16x16x32_bf16 v[32:35], v[12:15], v[216:219], v[32:35]
  v_add_f32 v53, v53, v43
  v_cvt_pk_bf16_f32 v43, v43, v43
  s_xor_b32 s61, s48, 15
  s_mul_i32 s61, s61, 3072
  buffer_load_dwordx4 v[244:247], v2, s[16:19], s61 offen offset:0 nt
  buffer_load_dwordx4 v[248:251], v2, s[16:19], s61 offen offset:256 nt
  buffer_load_dwordx4 v[252:255], v2, s[16:19], s61 offen offset:512 nt
  s_waitcnt vmcnt(8)
  v_mfma_f32_16x16x32_bf16 v[24:27], v[16:19], v[220:223], v[24:27]
  v_and_b32 v12, v43, v3
  v_and_b32 v13, v43, v4
  s_waitcnt vmcnt(7)
  v_mfma_f32_16x16x32_bf16 v[28:31], v[16:19], v[224:227], v[28:31]
  v_and_b32_dpp v14, v43, v5 row_shr:4 row_mask:0xf bank_mask:0xf bound_ctrl:0
  v_and_b32_dpp v15, v43, v6 row_shr:4 row_mask:0xf bank_mask:0xf bound_ctrl:0
  s_waitcnt vmcnt(6)
  v_mfma_f32_16x16x32_bf16 v[32:35], v[16:19], v[228:231], v[32:35]
  s_waitcnt vmcnt(5)
  v_mfma_f32_16x16x32_bf16 v[24:27], v[12:15], v[232:235], v[24:27]
  v_and_b32 v18, v43, v5
  v_and_b32 v19, v43, v6
  v_add_f32_dpp v53, v53, v53 row_ror:8 row_mask:0xf bank_mask:0xf
  s_waitcnt vmcnt(4)
  v_mfma_f32_16x16x32_bf16 v[28:31], v[12:15], v[236:239], v[28:31]
  v_and_b32_dpp v16, v43, v3 row_shl:4 row_mask:0xf bank_mask:0xf bound_ctrl:0
  v_and_b32_dpp v17, v43, v4 row_shl:4 row_mask:0xf bank_mask:0xf bound_ctrl:0
  v_add_f32_dpp v53, v53, v53 row_ror:4 row_mask:0xf bank_mask:0xf
  s_waitcnt vmcnt(3)
  v_mfma_f32_16x16x32_bf16 v[32:35], v[12:15], v[240:243], v[32:35]
  v_add_f32_dpp v53, v53, v53 row_bcast:15 row_mask:0xa bank_mask:0xf
  s_waitcnt vmcnt(2)
  v_mfma_f32_16x16x32_bf16 v[24:27], v[16:19], v[244:247], v[24:27]
  v_add_f32_dpp v53, v53, v53 row_bcast:31 row_mask:0xc bank_mask:0xf
  s_waitcnt vmcnt(1)
  v_mfma_f32_16x16x32_bf16 v[28:31], v[16:19], v[248:251], v[28:31]
  s_mov_b64 exec, s[36:37]
  ds_write_b32 v51, v53 offset:16
  s_mov_b64 exec, -1
  s_waitcnt vmcnt(0)
  v_mfma_f32_16x16x32_bf16 v[32:35], v[16:19], v[252:255], v[32:35]
  s_mov_b32 exec_lo, 0xffffffff
  s_mov_b32 exec_hi, 0x0
  ds_write_b128 v50, v[24:27] offset:0
  s_mov_b32 exec_lo, 0xff00ff
  s_mov_b32 exec_hi, 0xff00ff00
  ds_write_b128 v50, v[28:31] offset:512
  s_mov_b32 exec_lo, 0x0
  s_mov_b32 exec_hi, 0xffffffff
  ds_write_b128 v50, v[32:35] offset:1024
  s_mov_b64 exec, -1
  s_waitcnt lgkmcnt(0)
  s_barrier
  ds_read_b128 v[44:47], v9
  ds_read_b128 v[48:51], v9 offset:16
  ds_read2st64_b32 v[12:13], v10 offset0:0 offset1:3
  ds_read2st64_b32 v[14:15], v10 offset0:6 offset1:9
  ds_read2st64_b32 v[16:17], v10 offset0:12 offset1:15
  ds_read2st64_b32 v[18:19], v10 offset0:18 offset1:21
  s_waitcnt lgkmcnt(5)
  v_max3_f32 v52, v44, v45, v46
  v_max_f32 v52, v52, v47
  v_sub_f32 v44, v44, v52
  v_sub_f32 v45, v45, v52
  v_sub_f32 v46, v46, v52
  v_sub_f32 v47, v47, v52
  v_exp_f32 v44, v44
  v_exp_f32 v45, v45
  v_exp_f32 v46, v46
  v_exp_f32 v47, v47
  s_waitcnt lgkmcnt(3)
  v_add_f32 v12, v12, v13
  s_waitcnt lgkmcnt(2)
  v_add_f32 v14, v14, v15
  s_waitcnt lgkmcnt(1)
  v_add_f32 v16, v16, v17
  s_waitcnt lgkmcnt(0)
  v_add_f32 v18, v18, v19
  v_mul_f32 v20, v44, v12
  v_fmac_f32 v20, v45, v14
  v_fmac_f32 v20, v46, v16
  v_fmac_f32 v20, v47, v18
  v_mul_f32 v53, v44, v48
  v_fmac_f32 v53, v45, v49
  v_mov_b32_dpp v21, v20 quad_perm:[1,1,3,3] row_mask:0xf bank_mask:0xf
  v_fmac_f32 v53, v46, v50
  v_fmac_f32 v53, v47, v51
  v_cvt_pk_bf16_f32 v20, v20, v21
  v_cndmask_b32 v52, v52, v53, s[100:101]
  v_cndmask_b32 v20, v20, v52, s[42:43]
  v_min_u32 v20, -2, v20
  s_mov_b64 exec, s[46:47]
  s_cmp_lg_u32 s60, 0
  s_cbranch_scc0 Le21
  buffer_store_dword v20, v11, s[20:23], s73 offen
Lf22:
  s_mov_b64 exec, -1
  s_cmp_eq_u32 s3, 3
  s_cbranch_scc1 Ls23
  v_bfe_u32 v10, v0, 2, 2
  v_and_b32 v11, 48, v0
  v_add_u32 v10, v10, v11
  v_mul_u32_u24 v10, 160, v10
  v_and_b32 v11, 3, v0
  v_lshl_add_u32 v10, v11, 3, v10
  s_add_u32 s64, s95, 92160
  v_add_u32 v10, s64, v10
  ds_read_b64_tr_b16 v[24:25], v10 offset:0
  ds_read_b64_tr_b16 v[26:27], v10 offset:640
  ds_read_b64_tr_b16 v[28:29], v10 offset:1280
  ds_read_b64_tr_b16 v[30:31], v10 offset:1920
  ds_read_b64_tr_b16 v[32:33], v10 offset:10240
  ds_read_b64_tr_b16 v[34:35], v10 offset:10880
  ds_read_b64_tr_b16 v[36:37], v10 offset:11520
  ds_read_b64_tr_b16 v[38:39], v10 offset:12160
  ds_read_b64_tr_b16 v[40:41], v10 offset:20480
  ds_read_b64_tr_b16 v[42:43], v10 offset:21120
  ds_read_b64_tr_b16 v[44:45], v10 offset:21760
  ds_read_b64_tr_b16 v[46:47], v10 offset:22400
  v_and_b32 v11, 15, v0
  v_lshlrev_b32 v11, 1, v11
  v_and_b32 v9, 32, v0
  v_add3_u32 v11, v11, v9, s95
  s_add_u32 s73, s70, 49152
  buffer_load_dwordx2 v[52:53], v8, s[20:23], s76 offen offset:3072 sc1
  buffer_load_dwordx4 v[12:15], v7, s[20:23], s76 offen offset:0 sc1
  buffer_load_dwordx4 v[16:19], v7, s[20:23], s76 offen offset:128 sc1
  buffer_load_dwordx4 v[20:23], v7, s[20:23], s76 offen offset:256 sc1
  s_waitcnt vmcnt(0)
Lc24:
  s_waitcnt lgkmcnt(10)
  v_mfma_f32_16x16x32_bf16 v[48:51], v[12:15], v[24:27], 0
  v_max3_u32 v9, v52, v53, v12
  v_max3_u32 v9, v9, v13, v14
  v_max3_u32 v9, v9, v15, v16
  s_waitcnt lgkmcnt(6)
  v_mfma_f32_16x16x32_bf16 v[48:51], v[16:19], v[32:35], v[48:51]
  v_max3_u32 v9, v9, v17, v18
  v_max3_u32 v9, v9, v19, v20
  v_max3_u32 v9, v9, v21, v22
  s_waitcnt lgkmcnt(2)
  v_mfma_f32_16x16x32_bf16 v[48:51], v[20:23], v[40:43], v[48:51]
  v_max_u32 v9, v9, v23
  v_cmp_eq_u32 vcc, -1, v9
  s_cbranch_vccnz Lr25
  v_max_f32_dpp v9, v52, v52 row_ror:8 row_mask:0xf bank_mask:0xf
  v_mfma_f32_16x16x32_bf16 v[24:27], v[12:15], v[28:31], 0
  ds_read_b64_tr_b16 v[32:33], v10 offset:32
  ds_read_b64_tr_b16 v[34:35], v10 offset:672
  v_max_f32_dpp v9, v9, v9 row_ror:4 row_mask:0xf bank_mask:0xf
  v_mfma_f32_16x16x32_bf16 v[24:27], v[16:19], v[36:39], v[24:27]
  ds_read_b64_tr_b16 v[40:41], v10 offset:10272
  ds_read_b64_tr_b16 v[42:43], v10 offset:10912
  v_max_f32_dpp v9, v9, v9 row_ror:2 row_mask:0xf bank_mask:0xf
  s_waitcnt lgkmcnt(4)
  v_mfma_f32_16x16x32_bf16 v[24:27], v[20:23], v[44:47], v[24:27]
  v_sub_f32 v52, v52, v9
  v_exp_f32 v52, v52
  ds_read_b64_tr_b16 v[28:29], v10 offset:20512
  ds_read_b64_tr_b16 v[30:31], v10 offset:21152
  v_mul_f32 v53, v52, v53
  ds_read_b64_tr_b16 v[36:37], v10 offset:1312
  ds_read_b64_tr_b16 v[38:39], v10 offset:1952
  v_add_f32_dpp v53, v53, v53 row_ror:8 row_mask:0xf bank_mask:0xf
  ds_read_b64_tr_b16 v[44:45], v10 offset:11552
  ds_read_b64_tr_b16 v[46:47], v10 offset:12192
  v_add_f32_dpp v53, v53, v53 row_ror:4 row_mask:0xf bank_mask:0xf
  v_add_f32 v48, v48, v25
  v_add_f32 v50, v50, v27
  v_add_f32_dpp v53, v53, v53 row_ror:2 row_mask:0xf bank_mask:0xf
  v_mov_b32 v7, v48
  v_mov_b32 v8, v50
  v_rcp_f32 v53, v53
  s_waitcnt lgkmcnt(8)
  v_mfma_f32_16x16x32_bf16 v[48:51], v[12:15], v[32:35], 0
  ds_read_b64_tr_b16 v[32:33], v10 offset:21792
  ds_read_b64_tr_b16 v[34:35], v10 offset:22432
  v_mul_f32 v9, v52, v53
  s_waitcnt lgkmcnt(8)
  v_mfma_f32_16x16x32_bf16 v[48:51], v[16:19], v[40:43], v[48:51]
  s_waitcnt lgkmcnt(6)
  v_mfma_f32_16x16x32_bf16 v[48:51], v[20:23], v[28:31], v[48:51]
  v_mul_f32_dpp v52, v9, v7 row_newbcast:0 row_mask:0xf bank_mask:0xf
  s_waitcnt lgkmcnt(4)
  v_mfma_f32_16x16x32_bf16 v[24:27], v[12:15], v[36:39], 0
  v_mov_b32_dpp v7, v9 row_newbcast:0 row_mask:0xf bank_mask:0xf
  s_waitcnt lgkmcnt(2)
  v_mfma_f32_16x16x32_bf16 v[24:27], v[16:19], v[44:47], v[24:27]
  v_fmac_f32_dpp v52, v9, v8 row_newbcast:2 row_mask:0xf bank_mask:0xf
  s_waitcnt lgkmcnt(0)
  v_mfma_f32_16x16x32_bf16 v[24:27], v[20:23], v[32:35], v[24:27]
  v_mov_b32_dpp v8, v9 row_newbcast:2 row_mask:0xf bank_mask:0xf
  s_nop 6
  v_add_f32 v48, v48, v25
  v_add_f32 v50, v50, v27
  v_mul_f32 v53, v7, v48
  v_fmac_f32 v53, v8, v50
  s_nop 1
  v_permlane32_swap_b32 v52, v53
  v_add_f32 v52, v52, v53
  v_mov_b32 v53, v52
  s_nop 1
  v_permlane16_swap_b32 v52, v53
  v_add_f32 v52, v52, v53
  s_nop 1
  v_mov_b32_dpp v53, v52 quad_perm:[1,1,3,3] row_mask:0xf bank_mask:0xf
  v_cvt_pk_bf16_f32 v52, v52, v53
  v_min_u32 v52, -2, v52
  s_mov_b64 exec, s[80:81]
  buffer_store_dword v52, v11, s[20:23], s73 offen sc1
  s_mov_b64 exec, -1
Ls23:
  v_lshrrev_b32 v54, 4, v0
  v_mul_u32_u24 v54, 192, v54
  v_and_b32 v9, 15, v0
  v_lshl_add_u32 v54, v9, 4, v54
  v_mov_b32 v16, -1
  v_mov_b32 v17, -1
  v_mov_b32 v18, -1
  v_mov_b32 v19, -1
  v_lshlrev_b32 v14, 4, v0
  s_add_u32 s64, s66, 1572864
  s_mov_b32 s0, -1
  s_add_u32 s65, s66, 1572864
  s_mov_b32 s1, -1
  s_add_u32 s61, s66, 2621440
  s_cmp_eq_u32 s3, 1
  s_cselect_b32 s64, s61, s64
  s_cselect_b32 s0, -1, s0
  s_add_u32 s61, s66, 2621440
  s_cmp_eq_u32 s3, 1
  s_cselect_b32 s65, s61, s65
  s_cselect_b32 s1, -1, s1
  s_add_u32 s61, s66, 3145728
  s_cmp_eq_u32 s3, 2
  s_cselect_b32 s64, s61, s64
  s_cselect_b32 s0, -1, s0
  s_add_u32 s61, s66, 3145728
  s_cmp_eq_u32 s3, 2
  s_cselect_b32 s65, s61, s65
  s_cselect_b32 s1, -1, s1
  s_add_u32 s61, s66, 3670016
  s_cmp_eq_u32 s3, 3
  s_cselect_b32 s64, s61, s64
  s_cselect_b32 s0, -1, s0
  s_add_u32 s61, s66, 3670016
  s_cmp_eq_u32 s3, 3
  s_cselect_b32 s65, s61, s65
  s_cselect_b32 s1, -1, s1
  v_mov_b32 v15, s64
  v_mov_b32 v20, s65
  v_cmp_lt_u32 vcc, 31, v0
  s_nop 1
  v_cndmask_b32 v15, v15, v20, vcc
  v_add_u32 v15, v15, v14
  s_mov_b64 exec, s[0:1]
  buffer_store_dwordx4 v[16:19], v15, s[20:23], 0 offen sc1
  s_mov_b64 exec, -1
  s_nop 0
  v_mov_b32 v16, -1
  v_mov_b32 v17, -1
  v_mov_b32 v18, -1
  v_mov_b32 v19, -1
  v_lshlrev_b32 v14, 4, v0
  s_add_u32 s64, s68, 262144
  s_mov_b32 s0, 33554431
  s_add_u32 s65, s68, 392704
  s_mov_b32 s1, 33554431
  s_add_u32 s61, s68, 524288
  s_cmp_eq_u32 s3, 1
  s_cselect_b32 s64, s61, s64
  s_cselect_b32 s0, 33554431, s0
  s_add_u32 s61, s68, 654848
  s_cmp_eq_u32 s3, 1
  s_cselect_b32 s65, s61, s65
  s_cselect_b32 s1, 33554431, s1
  s_add_u32 s61, s68, 786432
  s_cmp_eq_u32 s3, 2
  s_cselect_b32 s64, s61, s64
  s_cselect_b32 s0, 33554431, s0
  s_add_u32 s61, s68, 916992
  s_cmp_eq_u32 s3, 2
  s_cselect_b32 s65, s61, s65
  s_cselect_b32 s1, 33554431, s1
  s_add_u32 s61, s68, 786432
  s_cmp_eq_u32 s3, 3
  s_cselect_b32 s64, s61, s64
  s_cselect_b32 s0, 33554431, s0
  s_add_u32 s61, s68, 916992
  s_cmp_eq_u32 s3, 3
  s_cselect_b32 s65, s61, s65
  s_cselect_b32 s1, 33554431, s1
  v_mov_b32 v15, s64
  v_mov_b32 v20, s65
  v_cmp_lt_u32 vcc, 31, v0
  s_nop 1
  v_cndmask_b32 v15, v15, v20, vcc
  v_add_u32 v15, v15, v14
  s_mov_b32 s64, 0
  s_mov_b32 s65, 0
  s_cmp_eq_u32 s3, 0
  s_cselect_b32 s64, 0x1000000, s64
  s_cmp_eq_u32 s3, 0
  s_cselect_b32 s65, 0x1000000, s65
  s_cmp_eq_u32 s3, 1
  s_cselect_b32 s64, 0x1000000, s64
  s_cmp_eq_u32 s3, 1
  s_cselect_b32 s65, 0x1000000, s65
  s_cmp_eq_u32 s3, 2
  s_cselect_b32 s64, 0x1000000, s64
  s_cmp_eq_u32 s3, 2
  s_cselect_b32 s65, 0x1000000, s65
  s_cmp_eq_u32 s3, 3
  s_cselect_b32 s64, 0x1000000, s64
  s_cmp_eq_u32 s3, 3
  s_cselect_b32 s65, 0x1000000, s65
  s_mul_i32 s61, s59, -368
  s_add_u32 s61, s61, 2688
  v_add_u32 v20, s61, v15
  v_cndmask_b32 v15, v15, v20, s[64:65]
  s_mov_b64 exec, s[0:1]
  buffer_store_dwordx4 v[16:19], v15, s[20:23], 0 offen sc1
  s_mov_b64 exec, -1
  s_waitcnt vmcnt(2)
  s_waitcnt lgkmcnt(0)
  s_barrier
  v_bfe_u32 v7, v0, 2, 2
  v_lshrrev_b32 v9, 4, v0
  v_lshl_add_u32 v8, v9, 3, v7
  v_lshl_add_u32 v7, v9, 2, v7
  v_and_b32 v9, 3, v0
  v_lshlrev_b32 v9, 3, v9
  s_mul_i32 s63, s3, 96
  s_add_u32 s63, s63, 0
  v_add_u32 v9, s63, v9
  s_movk_i32 s63, 384
  v_mad_u32_u24 v8, v8, s63, v9
  v_mad_u32_u24 v7, v7, s63, v9
  ds_read_b64_tr_b16 v[24:25], v8 offset:0
  ds_read_b64_tr_b16 v[26:27], v8 offset:1536
  ds_read_b64_tr_b16 v[28:29], v8 offset:12288
  ds_read_b64_tr_b16 v[30:31], v8 offset:13824
  ds_read_b64_tr_b16 v[32:33], v7 offset:24576
  ds_read_b64_tr_b16 v[34:35], v8 offset:32
  ds_read_b64_tr_b16 v[36:37], v8 offset:1568
  ds_read_b64_tr_b16 v[38:39], v8 offset:12320
  ds_read_b64_tr_b16 v[40:41], v8 offset:13856
  ds_read_b64_tr_b16 v[42:43], v7 offset:24608
  ds_read_b64_tr_b16 v[44:45], v8 offset:64
  ds_read_b64_tr_b16 v[46:47], v8 offset:1600
  ds_read_b64_tr_b16 v[48:49], v8 offset:12352
  ds_read_b64_tr_b16 v[50:51], v8 offset:13888
  ds_read_b64_tr_b16 v[52:53], v7 offset:24640
  s_mul_i32 s63, s3, 1536
  s_add_u32 s72, s71, s63
  s_add_u32 s72, s72, 49152
  s_add_u32 s35, s72, 768
  v_and_b32 v16, 0x3f803f80, v3
  v_and_b32 v17, 0x3f803f80, v4
  v_and_b32 v18, 0x3f803f80, v5
  v_and_b32 v19, 0x3f803f80, v6
  v_mov_b32 v8, 0
  v_mov_b32 v9, 0
  v_mov_b32 v10, 0
  v_mov_b32 v11, 0
  v_mov_b32 v12, 0
  v_mov_b32 v13, 0
  v_mov_b32 v14, 0
  v_mov_b32 v15, 0
  s_mov_b64 exec, s[32:33]
  buffer_load_dwordx4 v[8:11], v54, s[20:23], s72 offen sc1
  buffer_load_dwordx4 v[12:15], v54, s[20:23], s35 offen sc1
  s_mov_b64 exec, -1
  s_branch Lpg1
.p2align 12
Lst1:
  s_setpc_b64 s[78:79]
Lpg1:
  s_waitcnt vmcnt(0)
Lc26:
  v_mfma_f32_16x16x32_bf16 v[20:23], v[16:19], v[8:11], 0
  v_max3_u32 v7, v8, v9, v10
  v_max3_u32 v7, v7, v11, v12
  v_max3_u32 v7, v7, v13, v14
  v_mfma_f32_16x16x32_bf16 v[20:23], v[16:19], v[12:15], v[20:23]
  v_max_u32 v7, v7, v15
  v_cmp_eq_u32 vcc, -1, v7
  s_cbranch_vccnz Lr27
  v_and_b32 v7, 15, v0
  v_lshlrev_b32 v7, 5, v7
  v_and_b32 v54, 16, v0
  v_add3_u32 v7, v7, v54, s56
  s_mov_b32 exec_lo, s32
  s_mov_b32 exec_hi, 0
  ds_write_b128 v7, v[20:23] offset:0
  s_mov_b64 exec, -1
  v_lshl_add_u32 v7, v0, 2, s45
  ds_read_b32 v54, v7 offset:0
  v_lshlrev_b32 v14, 3, v0
  v_add_u32 v14, 153664, v14
  v_mov_b32 v22, s45
  v_mov_b32 v23, 157504
  v_cndmask_b32 v23, v22, v23, s[74:75]
  v_lshrrev_b32 v21, 4, v0
  v_lshl_add_u32 v22, v21, 4, v23
  v_lshl_add_u32 v23, v21, 3, v23
  s_waitcnt lgkmcnt(0)
  s_barrier
  s_mov_b32 exec_hi, 0xff
  ds_read2_b64 v[8:11], v14 offset0:0 offset1:40
  ds_read2_b64 v[12:15], v14 offset0:80 offset1:120
  v_lshlrev_b32 v16, 16, v54
  v_and_b32 v17, 0xffff0000, v54
  s_waitcnt lgkmcnt(1)
  v_pk_add_f32 v[8:9], v[8:9], v[10:11]
  s_waitcnt lgkmcnt(0)
  v_pk_add_f32 v[12:13], v[12:13], v[14:15]
  v_pk_add_f32 v[8:9], v[8:9], v[12:13]
  v_cvt_pk_bf16_f32 v8, v8, v9
  v_and_b32 v9, 0xffff0000, v8
  v_lshlrev_b32 v8, 16, v8
  v_pk_add_f32 v[8:9], v[8:9], v[16:17]
  v_cvt_pk_bf16_f32 v8, v8, v9
  ds_write_b32 v7, v8 offset:0
  s_mov_b64 exec, -1
  ds_read_b128 v[12:15], v22 offset:0
  ds_read_b128 v[16:19], v22 offset:64
  ds_read_b64 v[20:21], v23 offset:128
  v_lshl_add_u32 v7, v0, 2, s55
  s_add_u32 s73, s66, 901120
  v_and_b32 v23, 15, v0
  v_lshrrev_b32 v54, 4, v0
  v_mul_u32_u24 v54, 2048, v54
  v_lshl_add_u32 v54, v23, 4, v54
  s_add_u32 s72, s96, 1048576
  s_add_u32 s35, s72, 8192
  v_cndmask_b32 v22, 0, v8, s[98:99]
  v_lshlrev_b32 v23, 16, v22
  v_and_b32 v22, 0xffff0000, v22
  v_mul_f32 v9, v22, v22
  v_fmac_f32 v9, v23, v23
  v_add_f32 v23, v22, v23
  v_mov_b32 v22, v9
  s_waitcnt lgkmcnt(2)
  v_mfma_f32_16x16x32_bf16 v[8:11], v[12:15], v[24:27], 0
  v_add_f32_dpp v23, v23, v23 row_ror:8 row_mask:0xf bank_mask:0xf
  v_add_f32_dpp v22, v22, v22 row_ror:8 row_mask:0xf bank_mask:0xf
  s_waitcnt lgkmcnt(1)
  v_mfma_f32_16x16x32_bf16 v[8:11], v[16:19], v[28:31], v[8:11]
  v_add_f32_dpp v23, v23, v23 row_ror:4 row_mask:0xf bank_mask:0xf
  v_add_f32_dpp v22, v22, v22 row_ror:4 row_mask:0xf bank_mask:0xf
  v_mfma_f32_16x16x32_bf16 v[24:27], v[12:15], v[34:37], 0
  v_add_f32_dpp v23, v23, v23 row_ror:2 row_mask:0xf bank_mask:0xf
  v_add_f32_dpp v22, v22, v22 row_ror:2 row_mask:0xf bank_mask:0xf
  v_mfma_f32_16x16x32_bf16 v[24:27], v[16:19], v[38:41], v[24:27]
  v_add_f32_dpp v23, v23, v23 row_ror:1 row_mask:0xf bank_mask:0xf
  v_add_f32_dpp v22, v22, v22 row_ror:1 row_mask:0xf bank_mask:0xf
  v_mfma_f32_16x16x32_bf16 v[28:31], v[12:15], v[44:47], 0
  v_add_f32_dpp v23, v23, v23 row_bcast:15 row_mask:0xa bank_mask:0xf
  v_add_f32_dpp v22, v22, v22 row_bcast:15 row_mask:0xa bank_mask:0xf
  v_mfma_f32_16x16x32_bf16 v[28:31], v[16:19], v[48:51], v[28:31]
  v_add_f32_dpp v23, v23, v23 row_bcast:31 row_mask:0xc bank_mask:0xf
  v_add_f32_dpp v22, v22, v22 row_bcast:31 row_mask:0xc bank_mask:0xf
  s_waitcnt lgkmcnt(0)
  v_mfma_f32_16x16x16_bf16 v[8:11], v[20:21], v[32:33], v[8:11]
  v_cndmask_b32 v23, v22, v23, s[74:75]
  v_mfma_f32_16x16x16_bf16 v[24:27], v[20:21], v[42:43], v[24:27]
  v_mfma_f32_16x16x16_bf16 v[28:31], v[20:21], v[52:53], v[28:31]
  s_cmp_lg_u32 s60, 0
  s_nop 3
  v_cndmask_b32 v22, v8, v23, s[86:87]
  s_nop 0
  v_cndmask_b32 v22, v22, v24, s[82:83]
  v_cndmask_b32 v22, v22, v28, s[84:85]
  v_min_u32 v22, -2, v22
  s_cbranch_scc0 Le28
  buffer_store_dword v22, v7, s[20:23], s73 offen
Lf29:
  v_and_b32 v32, 15, v0
  v_lshrrev_b32 v33, 4, v0
  v_and_b32 v34, 1, v33
  v_lshlrev_b32 v34, 1, v34
  v_lshrrev_b32 v28, 1, v33
  v_or_b32 v34, v34, v28
  v_lshl_add_u32 v34, v32, 2, v34
  v_lshl_add_u32 v34, v34, 1, s57
  v_lshl_add_u32 v29, v0, 2, s38
  ds_read_b32 v20, v29 offset:0
  v_and_b32 v30, 1, v0
  v_lshrrev_b32 v31, 4, v0
  v_lshlrev_b32 v31, 5, v31
  v_lshl_add_u32 v30, v30, 4, v31
  v_add_u32 v30, 157664, v30
  v_mov_b32 v35, 0x3c75e03e
  v_mov_b32 v32, 0x3e13985d
  v_mov_b32 v33, 0x3a71d1e6
  buffer_load_dwordx4 v[12:15], v54, s[20:23], s72 offen sc1
  buffer_load_dwordx4 v[16:19], v54, s[20:23], s35 offen sc1
  v_lshl_add_u32 v37, v0, 4, s94
  ds_read_b128 v[38:41], v37 offset:0
  ds_read_b128 v[42:45], v37 offset:1024
  ds_read_b128 v[46:49], v37 offset:2048
  s_waitcnt vmcnt(0)
Lc30:
  v_max3_u32 v28, v12, v13, v14
  v_max3_u32 v28, v28, v15, v16
  v_max3_u32 v28, v28, v17, v18
  v_max_u32 v28, v28, v19
  v_cmp_eq_u32 vcc, -1, v28
  s_cbranch_vccnz Lr31
  v_pk_add_f32 v[12:13], v[12:13], v[16:17]
  v_pk_add_f32 v[14:15], v[14:15], v[18:19]
  s_nop 0
  v_permlane32_swap_b32 v12, v13
  v_permlane32_swap_b32 v14, v15
  v_add_f32 v12, v12, v13
  v_add_f32 v14, v14, v15
  s_nop 1
  v_permlane16_swap_b32 v12, v14
  v_add_f32 v12, v12, v14
  s_nop 0
  v_readlane_b32 s63, v12, 12
  v_readlane_b32 s64, v12, 44
  s_mov_b32 exec_lo, 0x0fff0fff
  s_mov_b32 exec_hi, 0x0fff0fff
  v_mul_f32 v15, s64, v35
  v_fma_f32 v14, s63, v32, v33
  v_fma_f32 v14, -v15, v15, v14
  v_max_f32 v14, v33, v14
  v_rsq_f32 v14, v14
  s_waitcnt lgkmcnt(3)
  v_fma_f32 v12, -v15, v20, v12
  v_mul_f32 v12, v12, v14
  v_cvt_pk_bf16_f32 v12, v12, v12
  ds_write_b16 v34, v12 offset:0
  s_mov_b64 exec, -1
  s_waitcnt lgkmcnt(0)
  s_barrier
  ds_read_b128 v[12:15], v30 offset:0
  ds_read_b128 v[16:19], v30 offset:128
  ds_read_b128 v[20:23], v30 offset:256
  s_add_u32 s64, s68, 262144
  v_mov_b32 v54, s44
  s_mov_b32 m0, 160480
  s_nop 0
  buffer_load_dword v54, s[20:23], s64 offen sc1 lds
  s_lshl_b32 s63, s3, 8
  v_and_b32 v54, 1, v0
  v_lshl_add_u32 v54, v54, 7, s63
  s_add_u32 s64, s66, 1572864
  s_mov_b32 m0, 160480
  s_nop 0
  buffer_load_dword v54, s[20:23], s64 offen sc1 lds
  s_waitcnt lgkmcnt(2)
  v_mfma_f32_16x16x32_bf16 v[24:27], a[0:3], v[12:15], 0
  v_and_b32 v50, 15, v0
  v_lshlrev_b32 v50, 5, v50
  s_waitcnt lgkmcnt(1)
  v_mfma_f32_16x16x32_bf16 v[24:27], a[4:7], v[16:19], v[24:27]
  v_and_b32 v51, 16, v0
  v_add3_u32 v50, v50, v51, s39
  s_waitcnt lgkmcnt(0)
  v_mfma_f32_16x16x32_bf16 v[24:27], a[8:11], v[20:23], v[24:27]
  v_mov_b32 v51, s54
  v_bfe_u32 v8, v0, 1, 3
  v_mfma_f32_16x16x32_bf16 v[28:31], a[12:15], v[12:15], 0
  v_lshrrev_b32 v9, 4, v0
  v_and_b32 v7, 1, v0
  v_mfma_f32_16x16x32_bf16 v[28:31], a[16:19], v[16:19], v[28:31]
  v_lshl_add_u32 v7, v9, 1, v7
  v_lshlrev_b32 v7, 4, v7
  v_mfma_f32_16x16x32_bf16 v[28:31], a[20:23], v[20:23], v[28:31]
  s_movk_i32 s63, 384
  v_mad_u32_u24 v7, v8, s63, v7
  v_mfma_f32_16x16x32_bf16 v[32:35], a[24:27], v[12:15], 0
  v_lshl_add_u32 v8, v9, 1, v8
  v_and_b32 v8, 7, v8
  v_mfma_f32_16x16x32_bf16 v[32:35], a[28:31], v[16:19], v[32:35]
  v_add_f32_dpp v36, v24, v25 quad_perm:[0,0,2,2] row_mask:0xf bank_mask:0x2
  v_mfma_f32_16x16x32_bf16 v[32:35], a[32:35], v[20:23], v[32:35]
  v_mul_u32_u24 v8, 16, v8
  v_add_f32_dpp v36, v26, v27 quad_perm:[0,0,2,2] row_mask:0xf bank_mask:0x8
  v_mfma_f32_16x16x32_bf16 v[24:27], a[36:39], v[12:15], 0
  s_add_u32 s76, s69, 262144
  v_mov_b32 v9, 153600
  v_mfma_f32_16x16x32_bf16 v[24:27], a[40:43], v[16:19], v[24:27]
  v_add_f32_dpp v37, v28, v29 quad_perm:[0,0,2,2] row_mask:0xf bank_mask:0x1
  v_mfma_f32_16x16x32_bf16 v[24:27], a[44:47], v[20:23], v[24:27]
  v_lshl_add_u32 v10, v0, 2, s55
  v_add_f32_dpp v37, v30, v31 quad_perm:[0,0,2,2] row_mask:0xf bank_mask:0x4
  v_add_f32_dpp v36, v32, v33 quad_perm:[0,0,2,2] row_mask:0xf bank_mask:0x1
  v_lshl_add_u32 v11, v0, 1, s44
  s_add_u32 s73, s68, 262144
  v_add_f32_dpp v36, v34, v35 quad_perm:[0,0,2,2] row_mask:0xf bank_mask:0x4
  s_nop 1
  v_add_f32_dpp v37, v24, v25 quad_perm:[0,0,2,2] row_mask:0xf bank_mask:0x2
  s_nop 1
  v_add_f32_dpp v37, v26, v27 quad_perm:[0,0,2,2] row_mask:0xf bank_mask:0x8
  s_mov_b32 s61, 50331648
  buffer_load_dwordx4 a[0:3], v1, s[4:7], s61 offen offset:0 nt
  buffer_load_dwordx4 a[4:7], v1, s[4:7], s61 offen offset:128 nt
  buffer_load_dwordx4 a[8:11], v1, s[4:7], s61 offen offset:256 nt
  s_mov_b32 s61, 50334720
  buffer_load_dwordx4 a[12:15], v1, s[4:7], s61 offen offset:0 nt
  buffer_load_dwordx4 a[16:19], v1, s[4:7], s61 offen offset:128 nt
  buffer_load_dwordx4 a[20:23], v1, s[4:7], s61 offen offset:256 nt
  v_max_f32 v52, v36, v37
  v_mov_b32_dpp v36, v36 quad_perm:[1,1,3,3] row_mask:0xf bank_mask:0xf
  v_mov_b32_dpp v37, v37 quad_perm:[1,1,3,3] row_mask:0xf bank_mask:0xf
  v_max_f32_dpp v52, v52, v52 row_ror:8 row_mask:0xf bank_mask:0xf
  s_nop 1
  v_max_f32_dpp v52, v52, v52 row_ror:4 row_mask:0xf bank_mask:0xf
  s_nop 1
  v_max_f32_dpp v52, v52, v52 row_bcast:15 row_mask:0xa bank_mask:0xf
  s_nop 1
  v_max_f32_dpp v52, v52, v52 row_bcast:31 row_mask:0xc bank_mask:0xf
  s_nop 0
  v_readlane_b32 s34, v52, 63
  s_nop 1
  v_subrev_f32 v36, s34, v36
  v_exp_f32 v36, v36
  v_subrev_f32 v37, s34, v37
  v_mov_b32 v53, v36
  v_cvt_pk_bf16_f32 v36, v36, v36
  v_exp_f32 v37, v37
  v_and_b32 v12, v36, v3
  v_and_b32 v13, v36, v4
  v_and_b32_dpp v14, v36, v5 row_shr:4 row_mask:0xf bank_mask:0xf bound_ctrl:0
  v_and_b32_dpp v15, v36, v6 row_shr:4 row_mask:0xf bank_mask:0xf bound_ctrl:0
  v_mov_b32 v52, s34
  ds_write_b32 v51, v52
  v_mfma_f32_16x16x32_bf16 v[24:27], v[12:15], v[38:41], 0
  v_and_b32 v18, v36, v5
  v_and_b32 v19, v36, v6
  v_mfma_f32_16x16x32_bf16 v[28:31], v[12:15], v[42:45], 0
  v_and_b32_dpp v16, v36, v3 row_shl:4 row_mask:0xf bank_mask:0xf bound_ctrl:0
  v_and_b32_dpp v17, v36, v4 row_shl:4 row_mask:0xf bank_mask:0xf bound_ctrl:0
  v_mfma_f32_16x16x32_bf16 v[32:35], v[12:15], v[46:49], 0
  v_add_f32 v53, v53, v37
  v_cvt_pk_bf16_f32 v37, v37, v37
  v_lshl_add_u32 v54, v0, 4, s94
  ds_read_b128 v[38:41], v54 offset:3072
  ds_read_b128 v[42:45], v54 offset:4096
  ds_read_b128 v[46:49], v54 offset:5120
  v_mfma_f32_16x16x32_bf16 v[24:27], v[16:19], a[48:51], v[24:27]
  v_and_b32 v12, v37, v3
  v_and_b32 v13, v37, v4
  v_mfma_f32_16x16x32_bf16 v[28:31], v[16:19], a[52:55], v[28:31]
  v_and_b32_dpp v14, v37, v5 row_shr:4 row_mask:0xf bank_mask:0xf bound_ctrl:0
  v_and_b32_dpp v15, v37, v6 row_shr:4 row_mask:0xf bank_mask:0xf bound_ctrl:0
  v_mfma_f32_16x16x32_bf16 v[32:35], v[16:19], a[56:59], v[32:35]
  s_nop 0
  v_mfma_f32_16x16x32_bf16 v[24:27], v[12:15], a[60:63], v[24:27]
  v_and_b32 v18, v37, v5
  v_and_b32 v19, v37, v6
  v_add_f32_dpp v53, v53, v53 row_ror:8 row_mask:0xf bank_mask:0xf
  v_mfma_f32_16x16x32_bf16 v[28:31], v[12:15], a[64:67], v[28:31]
  v_and_b32_dpp v16, v37, v3 row_shl:4 row_mask:0xf bank_mask:0xf bound_ctrl:0
  v_and_b32_dpp v17, v37, v4 row_shl:4 row_mask:0xf bank_mask:0xf bound_ctrl:0
  v_add_f32_dpp v53, v53, v53 row_ror:4 row_mask:0xf bank_mask:0xf
  v_mfma_f32_16x16x32_bf16 v[32:35], v[12:15], a[68:71], v[32:35]
  s_nop 0
  v_add_f32_dpp v53, v53, v53 row_bcast:15 row_mask:0xa bank_mask:0xf
  s_waitcnt lgkmcnt(2)
  v_mfma_f32_16x16x32_bf16 v[24:27], v[16:19], v[38:41], v[24:27]
  v_add_f32_dpp v53, v53, v53 row_bcast:31 row_mask:0xc bank_mask:0xf
  s_waitcnt lgkmcnt(1)
  v_mfma_f32_16x16x32_bf16 v[28:31], v[16:19], v[42:45], v[28:31]
  s_mov_b64 exec, s[36:37]
  ds_write_b32 v51, v53 offset:16
  s_mov_b64 exec, -1
  s_waitcnt lgkmcnt(1)
  v_mfma_f32_16x16x32_bf16 v[32:35], v[16:19], v[46:49], v[32:35]
  s_mov_b32 exec_lo, 0xffffffff
  s_mov_b32 exec_hi, 0x0
  ds_write_b128 v50, v[24:27] offset:0
  s_mov_b32 exec_lo, 0xff00ff
  s_mov_b32 exec_hi, 0xff00ff00
  ds_write_b128 v50, v[28:31] offset:512
  s_mov_b32 exec_lo, 0x0
  s_mov_b32 exec_hi, 0xffffffff
  ds_write_b128 v50, v[32:35] offset:1024
  s_mov_b64 exec, -1
  s_waitcnt lgkmcnt(0)
  s_barrier
  ds_read_b128 v[44:47], v9
  ds_read_b128 v[48:51], v9 offset:16
  ds_read2st64_b32 v[12:13], v10 offset0:0 offset1:3
  ds_read2st64_b32 v[14:15], v10 offset0:6 offset1:9
  ds_read2st64_b32 v[16:17], v10 offset0:12 offset1:15
  ds_read2st64_b32 v[18:19], v10 offset0:18 offset1:21
  s_waitcnt lgkmcnt(5)
  v_max3_f32 v52, v44, v45, v46
  v_max_f32 v52, v52, v47
  v_sub_f32 v44, v44, v52
  v_sub_f32 v45, v45, v52
  v_sub_f32 v46, v46, v52
  v_sub_f32 v47, v47, v52
  v_exp_f32 v44, v44
  v_exp_f32 v45, v45
  v_exp_f32 v46, v46
  v_exp_f32 v47, v47
  s_waitcnt lgkmcnt(3)
  v_add_f32 v12, v12, v13
  s_waitcnt lgkmcnt(2)
  v_add_f32 v14, v14, v15
  s_waitcnt lgkmcnt(1)
  v_add_f32 v16, v16, v17
  s_waitcnt lgkmcnt(0)
  v_add_f32 v18, v18, v19
  v_mul_f32 v20, v44, v12
  v_fmac_f32 v20, v45, v14
  v_fmac_f32 v20, v46, v16
  v_fmac_f32 v20, v47, v18
  v_mul_f32 v53, v44, v48
  v_fmac_f32 v53, v45, v49
  v_mov_b32_dpp v21, v20 quad_perm:[1,1,3,3] row_mask:0xf bank_mask:0xf
  v_fmac_f32 v53, v46, v50
  v_fmac_f32 v53, v47, v51
  v_cvt_pk_bf16_f32 v20, v20, v21
  v_cndmask_b32 v52, v52, v53, s[100:101]
  v_cndmask_b32 v20, v20, v52, s[42:43]
  v_min_u32 v20, -2, v20
  s_mov_b64 exec, s[46:47]
  s_cmp_lg_u32 s60, 0
  s_cbranch_scc0 Le32
  buffer_store_dword v20, v11, s[20:23], s73 offen
Lf33:
  s_mov_b64 exec, -1
  s_cmp_eq_u32 s3, 3
  s_cbranch_scc1 Ls34
  v_bfe_u32 v10, v0, 2, 2
  v_and_b32 v11, 48, v0
  v_add_u32 v10, v10, v11
  v_mul_u32_u24 v10, 160, v10
  v_and_b32 v11, 3, v0
  v_lshl_add_u32 v10, v11, 3, v10
  s_add_u32 s64, s95, 30720
  v_add_u32 v10, s64, v10
  ds_read_b64_tr_b16 v[24:25], v10 offset:0
  ds_read_b64_tr_b16 v[26:27], v10 offset:640
  ds_read_b64_tr_b16 v[28:29], v10 offset:1280
  ds_read_b64_tr_b16 v[30:31], v10 offset:1920
  ds_read_b64_tr_b16 v[32:33], v10 offset:10240
  ds_read_b64_tr_b16 v[34:35], v10 offset:10880
  ds_read_b64_tr_b16 v[36:37], v10 offset:11520
  ds_read_b64_tr_b16 v[38:39], v10 offset:12160
  ds_read_b64_tr_b16 v[40:41], v10 offset:20480
  ds_read_b64_tr_b16 v[42:43], v10 offset:21120
  ds_read_b64_tr_b16 v[44:45], v10 offset:21760
  ds_read_b64_tr_b16 v[46:47], v10 offset:22400
  v_and_b32 v11, 15, v0
  v_lshlrev_b32 v11, 1, v11
  v_and_b32 v9, 32, v0
  v_add3_u32 v11, v11, v9, s95
  s_add_u32 s73, s70, 98304
  buffer_load_dwordx2 v[52:53], v8, s[20:23], s76 offen offset:3072 sc1
  buffer_load_dwordx4 v[12:15], v7, s[20:23], s76 offen offset:0 sc1
  buffer_load_dwordx4 v[16:19], v7, s[20:23], s76 offen offset:128 sc1
  buffer_load_dwordx4 v[20:23], v7, s[20:23], s76 offen offset:256 sc1
  s_waitcnt vmcnt(0)
Lc35:
  s_waitcnt lgkmcnt(10)
  v_mfma_f32_16x16x32_bf16 v[48:51], v[12:15], v[24:27], 0
  v_max3_u32 v9, v52, v53, v12
  v_max3_u32 v9, v9, v13, v14
  v_max3_u32 v9, v9, v15, v16
  s_waitcnt lgkmcnt(6)
  v_mfma_f32_16x16x32_bf16 v[48:51], v[16:19], v[32:35], v[48:51]
  v_max3_u32 v9, v9, v17, v18
  v_max3_u32 v9, v9, v19, v20
  v_max3_u32 v9, v9, v21, v22
  s_waitcnt lgkmcnt(2)
  v_mfma_f32_16x16x32_bf16 v[48:51], v[20:23], v[40:43], v[48:51]
  v_max_u32 v9, v9, v23
  v_cmp_eq_u32 vcc, -1, v9
  s_cbranch_vccnz Lr36
  v_max_f32_dpp v9, v52, v52 row_ror:8 row_mask:0xf bank_mask:0xf
  v_mfma_f32_16x16x32_bf16 v[24:27], v[12:15], v[28:31], 0
  ds_read_b64_tr_b16 v[32:33], v10 offset:32
  ds_read_b64_tr_b16 v[34:35], v10 offset:672
  v_max_f32_dpp v9, v9, v9 row_ror:4 row_mask:0xf bank_mask:0xf
  v_mfma_f32_16x16x32_bf16 v[24:27], v[16:19], v[36:39], v[24:27]
  ds_read_b64_tr_b16 v[40:41], v10 offset:10272
  ds_read_b64_tr_b16 v[42:43], v10 offset:10912
  v_max_f32_dpp v9, v9, v9 row_ror:2 row_mask:0xf bank_mask:0xf
  s_waitcnt lgkmcnt(4)
  v_mfma_f32_16x16x32_bf16 v[24:27], v[20:23], v[44:47], v[24:27]
  v_sub_f32 v52, v52, v9
  v_exp_f32 v52, v52
  ds_read_b64_tr_b16 v[28:29], v10 offset:20512
  ds_read_b64_tr_b16 v[30:31], v10 offset:21152
  v_mul_f32 v53, v52, v53
  ds_read_b64_tr_b16 v[36:37], v10 offset:1312
  ds_read_b64_tr_b16 v[38:39], v10 offset:1952
  v_add_f32_dpp v53, v53, v53 row_ror:8 row_mask:0xf bank_mask:0xf
  ds_read_b64_tr_b16 v[44:45], v10 offset:11552
  ds_read_b64_tr_b16 v[46:47], v10 offset:12192
  v_add_f32_dpp v53, v53, v53 row_ror:4 row_mask:0xf bank_mask:0xf
  v_add_f32 v48, v48, v25
  v_add_f32 v50, v50, v27
  v_add_f32_dpp v53, v53, v53 row_ror:2 row_mask:0xf bank_mask:0xf
  v_mov_b32 v7, v48
  v_mov_b32 v8, v50
  v_rcp_f32 v53, v53
  s_waitcnt lgkmcnt(8)
  v_mfma_f32_16x16x32_bf16 v[48:51], v[12:15], v[32:35], 0
  ds_read_b64_tr_b16 v[32:33], v10 offset:21792
  ds_read_b64_tr_b16 v[34:35], v10 offset:22432
  v_mul_f32 v9, v52, v53
  s_waitcnt lgkmcnt(8)
  v_mfma_f32_16x16x32_bf16 v[48:51], v[16:19], v[40:43], v[48:51]
  s_waitcnt lgkmcnt(6)
  v_mfma_f32_16x16x32_bf16 v[48:51], v[20:23], v[28:31], v[48:51]
  v_mul_f32_dpp v52, v9, v7 row_newbcast:0 row_mask:0xf bank_mask:0xf
  s_waitcnt lgkmcnt(4)
  v_mfma_f32_16x16x32_bf16 v[24:27], v[12:15], v[36:39], 0
  v_mov_b32_dpp v7, v9 row_newbcast:0 row_mask:0xf bank_mask:0xf
  s_waitcnt lgkmcnt(2)
  v_mfma_f32_16x16x32_bf16 v[24:27], v[16:19], v[44:47], v[24:27]
  v_fmac_f32_dpp v52, v9, v8 row_newbcast:2 row_mask:0xf bank_mask:0xf
  s_waitcnt lgkmcnt(0)
  v_mfma_f32_16x16x32_bf16 v[24:27], v[20:23], v[32:35], v[24:27]
  v_mov_b32_dpp v8, v9 row_newbcast:2 row_mask:0xf bank_mask:0xf
  s_nop 6
  v_add_f32 v48, v48, v25
  v_add_f32 v50, v50, v27
  v_mul_f32 v53, v7, v48
  v_fmac_f32 v53, v8, v50
  s_nop 1
  v_permlane32_swap_b32 v52, v53
  v_add_f32 v52, v52, v53
  v_mov_b32 v53, v52
  s_nop 1
  v_permlane16_swap_b32 v52, v53
  v_add_f32 v52, v52, v53
  s_nop 1
  v_mov_b32_dpp v53, v52 quad_perm:[1,1,3,3] row_mask:0xf bank_mask:0xf
  v_cvt_pk_bf16_f32 v52, v52, v53
  v_min_u32 v52, -2, v52
  s_mov_b64 exec, s[80:81]
  buffer_store_dword v52, v11, s[20:23], s73 offen sc1
  s_mov_b64 exec, -1
Ls34:
  v_lshrrev_b32 v54, 4, v0
  v_mul_u32_u24 v54, 192, v54
  v_and_b32 v9, 15, v0
  v_lshl_add_u32 v54, v9, 4, v54
  s_mov_b32 s61, 50337792
  buffer_load_dwordx4 a[24:27], v1, s[4:7], s61 offen offset:0 nt
  buffer_load_dwordx4 a[28:31], v1, s[4:7], s61 offen offset:128 nt
  buffer_load_dwordx4 a[32:35], v1, s[4:7], s61 offen offset:256 nt
  s_mov_b32 s61, 50340864
  buffer_load_dwordx4 a[36:39], v1, s[4:7], s61 offen offset:0 nt
  buffer_load_dwordx4 a[40:43], v1, s[4:7], s61 offen offset:128 nt
  buffer_load_dwordx4 a[44:47], v1, s[4:7], s61 offen offset:256 nt
  s_mov_b32 s61, 50331648
  buffer_load_dwordx4 a[48:51], v2, s[8:11], s61 offen offset:0 nt
  buffer_load_dwordx4 a[52:55], v2, s[8:11], s61 offen offset:256 nt
  buffer_load_dwordx4 a[56:59], v2, s[8:11], s61 offen offset:512 nt
  s_waitcnt vmcnt(9)
  s_waitcnt lgkmcnt(0)
  s_barrier
  v_bfe_u32 v7, v0, 2, 2
  v_lshrrev_b32 v9, 4, v0
  v_lshl_add_u32 v8, v9, 3, v7
  v_lshl_add_u32 v7, v9, 2, v7
  v_and_b32 v9, 3, v0
  v_lshlrev_b32 v9, 3, v9
  s_mul_i32 s63, s3, 96
  s_add_u32 s63, s63, 61440
  v_add_u32 v9, s63, v9
  s_movk_i32 s63, 384
  v_mad_u32_u24 v8, v8, s63, v9
  v_mad_u32_u24 v7, v7, s63, v9
  ds_read_b64_tr_b16 v[24:25], v8 offset:0
  ds_read_b64_tr_b16 v[26:27], v8 offset:1536
  ds_read_b64_tr_b16 v[28:29], v8 offset:12288
  ds_read_b64_tr_b16 v[30:31], v8 offset:13824
  ds_read_b64_tr_b16 v[32:33], v7 offset:24576
  ds_read_b64_tr_b16 v[34:35], v8 offset:32
  ds_read_b64_tr_b16 v[36:37], v8 offset:1568
  ds_read_b64_tr_b16 v[38:39], v8 offset:12320
  ds_read_b64_tr_b16 v[40:41], v8 offset:13856
  ds_read_b64_tr_b16 v[42:43], v7 offset:24608
  ds_read_b64_tr_b16 v[44:45], v8 offset:64
  ds_read_b64_tr_b16 v[46:47], v8 offset:1600
  ds_read_b64_tr_b16 v[48:49], v8 offset:12352
  ds_read_b64_tr_b16 v[50:51], v8 offset:13888
  ds_read_b64_tr_b16 v[52:53], v7 offset:24640
  s_mul_i32 s63, s3, 1536
  s_add_u32 s72, s71, s63
  s_add_u32 s72, s72, 98304
  s_add_u32 s35, s72, 768
  v_and_b32 v16, 0x3f803f80, v3
  v_and_b32 v17, 0x3f803f80, v4
  v_and_b32 v18, 0x3f803f80, v5
  v_and_b32 v19, 0x3f803f80, v6
  v_mov_b32 v8, 0
  v_mov_b32 v9, 0
  v_mov_b32 v10, 0
  v_mov_b32 v11, 0
  v_mov_b32 v12, 0
  v_mov_b32 v13, 0
  v_mov_b32 v14, 0
  v_mov_b32 v15, 0
  s_mov_b64 exec, s[32:33]
  buffer_load_dwordx4 v[8:11], v54, s[20:23], s72 offen sc1
  buffer_load_dwordx4 v[12:15], v54, s[20:23], s35 offen sc1
  s_mov_b64 exec, -1
  s_branch Lpg2
.p2align 12
Lst2:
  s_setpc_b64 s[78:79]
Lpg2:
  s_waitcnt vmcnt(0)
Lc37:
  v_mfma_f32_16x16x32_bf16 v[20:23], v[16:19], v[8:11], 0
  v_max3_u32 v7, v8, v9, v10
  v_max3_u32 v7, v7, v11, v12
  v_max3_u32 v7, v7, v13, v14
  v_mfma_f32_16x16x32_bf16 v[20:23], v[16:19], v[12:15], v[20:23]
  v_max_u32 v7, v7, v15
  v_cmp_eq_u32 vcc, -1, v7
  s_cbranch_vccnz Lr38
  s_mov_b32 s61, 50334720
  buffer_load_dwordx4 a[60:63], v2, s[8:11], s61 offen offset:0 nt
  buffer_load_dwordx4 a[64:67], v2, s[8:11], s61 offen offset:256 nt
  buffer_load_dwordx4 a[68:71], v2, s[8:11], s61 offen offset:512 nt
  v_and_b32 v7, 15, v0
  v_lshlrev_b32 v7, 5, v7
  v_and_b32 v54, 16, v0
  v_add3_u32 v7, v7, v54, s56
  s_mov_b32 exec_lo, s32
  s_mov_b32 exec_hi, 0
  ds_write_b128 v7, v[20:23] offset:0
  s_mov_b64 exec, -1
  v_lshl_add_u32 v7, v0, 2, s45
  ds_read_b32 v54, v7 offset:0
  v_lshlrev_b32 v14, 3, v0
  v_add_u32 v14, 153664, v14
  v_mov_b32 v22, s45
  v_mov_b32 v23, 157504
  v_cndmask_b32 v23, v22, v23, s[74:75]
  v_lshrrev_b32 v21, 4, v0
  v_lshl_add_u32 v22, v21, 4, v23
  v_lshl_add_u32 v23, v21, 3, v23
  s_waitcnt lgkmcnt(0)
  s_barrier
  s_mov_b32 exec_hi, 0xff
  ds_read2_b64 v[8:11], v14 offset0:0 offset1:40
  ds_read2_b64 v[12:15], v14 offset0:80 offset1:120
  v_lshlrev_b32 v16, 16, v54
  v_and_b32 v17, 0xffff0000, v54
  s_waitcnt lgkmcnt(1)
  v_pk_add_f32 v[8:9], v[8:9], v[10:11]
  s_waitcnt lgkmcnt(0)
  v_pk_add_f32 v[12:13], v[12:13], v[14:15]
  v_pk_add_f32 v[8:9], v[8:9], v[12:13]
  v_cvt_pk_bf16_f32 v8, v8, v9
  v_and_b32 v9, 0xffff0000, v8
  v_lshlrev_b32 v8, 16, v8
  v_pk_add_f32 v[8:9], v[8:9], v[16:17]
  v_cvt_pk_bf16_f32 v8, v8, v9
  ds_write_b32 v7, v8 offset:0
  s_mov_b64 exec, -1
  ds_read_b128 v[12:15], v22 offset:0
  ds_read_b128 v[16:19], v22 offset:64
  ds_read_b64 v[20:21], v23 offset:128
  v_lshl_add_u32 v7, v0, 2, s55
  s_add_u32 s73, s66, 1425408
  v_and_b32 v23, 15, v0
  v_lshrrev_b32 v54, 4, v0
  v_mul_u32_u24 v54, 2048, v54
  v_lshl_add_u32 v54, v23, 4, v54
  s_add_u32 s72, s96, 1572864
  s_add_u32 s35, s72, 8192
  v_cndmask_b32 v22, 0, v8, s[98:99]
  v_lshlrev_b32 v23, 16, v22
  v_and_b32 v22, 0xffff0000, v22
  v_mul_f32 v9, v22, v22
  v_fmac_f32 v9, v23, v23
  v_add_f32 v23, v22, v23
  v_mov_b32 v22, v9
  s_waitcnt lgkmcnt(2)
  v_mfma_f32_16x16x32_bf16 v[8:11], v[12:15], v[24:27], 0
  v_add_f32_dpp v23, v23, v23 row_ror:8 row_mask:0xf bank_mask:0xf
  v_add_f32_dpp v22, v22, v22 row_ror:8 row_mask:0xf bank_mask:0xf
  s_waitcnt lgkmcnt(1)
  v_mfma_f32_16x16x32_bf16 v[8:11], v[16:19], v[28:31], v[8:11]
  v_add_f32_dpp v23, v23, v23 row_ror:4 row_mask:0xf bank_mask:0xf
  v_add_f32_dpp v22, v22, v22 row_ror:4 row_mask:0xf bank_mask:0xf
  v_mfma_f32_16x16x32_bf16 v[24:27], v[12:15], v[34:37], 0
  v_add_f32_dpp v23, v23, v23 row_ror:2 row_mask:0xf bank_mask:0xf
  v_add_f32_dpp v22, v22, v22 row_ror:2 row_mask:0xf bank_mask:0xf
  v_mfma_f32_16x16x32_bf16 v[24:27], v[16:19], v[38:41], v[24:27]
  v_add_f32_dpp v23, v23, v23 row_ror:1 row_mask:0xf bank_mask:0xf
  v_add_f32_dpp v22, v22, v22 row_ror:1 row_mask:0xf bank_mask:0xf
  v_mfma_f32_16x16x32_bf16 v[28:31], v[12:15], v[44:47], 0
  v_add_f32_dpp v23, v23, v23 row_bcast:15 row_mask:0xa bank_mask:0xf
  v_add_f32_dpp v22, v22, v22 row_bcast:15 row_mask:0xa bank_mask:0xf
  v_mfma_f32_16x16x32_bf16 v[28:31], v[16:19], v[48:51], v[28:31]
  v_add_f32_dpp v23, v23, v23 row_bcast:31 row_mask:0xc bank_mask:0xf
  v_add_f32_dpp v22, v22, v22 row_bcast:31 row_mask:0xc bank_mask:0xf
  s_waitcnt lgkmcnt(0)
  v_mfma_f32_16x16x16_bf16 v[8:11], v[20:21], v[32:33], v[8:11]
  v_cndmask_b32 v23, v22, v23, s[74:75]
  v_mfma_f32_16x16x16_bf16 v[24:27], v[20:21], v[42:43], v[24:27]
  v_mfma_f32_16x16x16_bf16 v[28:31], v[20:21], v[52:53], v[28:31]
  s_cmp_lg_u32 s60, 0
  s_nop 3
  v_cndmask_b32 v22, v8, v23, s[86:87]
  s_nop 0
  v_cndmask_b32 v22, v22, v24, s[82:83]
  v_cndmask_b32 v22, v22, v28, s[84:85]
  v_min_u32 v22, -2, v22
  s_cbranch_scc0 Le39
  buffer_store_dword v22, v7, s[20:23], s73 offen
Lf40:
  v_and_b32 v32, 15, v0
  v_lshrrev_b32 v33, 4, v0
  v_and_b32 v34, 1, v33
  v_lshlrev_b32 v34, 1, v34
  v_lshrrev_b32 v28, 1, v33
  v_or_b32 v34, v34, v28
  v_lshl_add_u32 v34, v32, 2, v34
  v_lshl_add_u32 v34, v34, 1, s57
  v_lshl_add_u32 v29, v0, 2, s38
  ds_read_b32 v20, v29 offset:1024
  v_and_b32 v30, 1, v0
  v_lshrrev_b32 v31, 4, v0
  v_lshlrev_b32 v31, 5, v31
  v_lshl_add_u32 v30, v30, 4, v31
  v_add_u32 v30, 157664, v30
  v_mov_b32 v35, 0x3c75e03e
  v_mov_b32 v32, 0x3e13985d
  v_mov_b32 v33, 0x3a71d1e6
  buffer_load_dwordx4 v[12:15], v54, s[20:23], s72 offen sc1
  buffer_load_dwordx4 v[16:19], v54, s[20:23], s35 offen sc1
  s_waitcnt vmcnt(0)
Lc41:
  v_max3_u32 v28, v12, v13, v14
  v_max3_u32 v28, v28, v15, v16
  v_max3_u32 v28, v28, v17, v18
  v_max_u32 v28, v28, v19
  v_cmp_eq_u32 vcc, -1, v28
  s_cbranch_vccnz Lr42
  s_add_u32 m0, s94, 0
  s_mov_b32 s61, 50337792
  buffer_load_dwordx4 v2, s[8:11], s61 offen nt lds
  s_add_u32 m0, s94, 1024
  s_mov_b32 s61, 50338048
  buffer_load_dwordx4 v2, s[8:11], s61 offen nt lds
  s_add_u32 m0, s94, 2048
  s_mov_b32 s61, 50338304
  buffer_load_dwordx4 v2, s[8:11], s61 offen nt lds
  s_add_u32 m0, s94, 3072
  s_mov_b32 s61, 50340864
  buffer_load_dwordx4 v2, s[8:11], s61 offen nt lds
  s_add_u32 m0, s94, 4096
  s_mov_b32 s61, 50341120
  buffer_load_dwordx4 v2, s[8:11], s61 offen nt lds
  s_add_u32 m0, s94, 5120
  s_mov_b32 s61, 50341376
  buffer_load_dwordx4 v2, s[8:11], s61 offen nt lds
  v_pk_add_f32 v[12:13], v[12:13], v[16:17]
  v_pk_add_f32 v[14:15], v[14:15], v[18:19]
  s_nop 0
  v_permlane32_swap_b32 v12, v13
  v_permlane32_swap_b32 v14, v15
  v_add_f32 v12, v12, v13
  v_add_f32 v14, v14, v15
  s_nop 1
  v_permlane16_swap_b32 v12, v14
  v_add_f32 v12, v12, v14
  s_nop 0
  v_readlane_b32 s63, v12, 12
  v_readlane_b32 s64, v12, 44
  s_mov_b32 exec_lo, 0x0fff0fff
  s_mov_b32 exec_hi, 0x0fff0fff
  v_mul_f32 v15, s64, v35
  v_fma_f32 v14, s63, v32, v33
  v_fma_f32 v14, -v15, v15, v14
  v_max_f32 v14, v33, v14
  v_rsq_f32 v14, v14
  s_waitcnt lgkmcnt(0)
  v_fma_f32 v12, -v15, v20, v12
  v_mul_f32 v12, v12, v14
  v_cvt_pk_bf16_f32 v12, v12, v12
  ds_write_b16 v34, v12 offset:0
  s_mov_b64 exec, -1
  s_waitcnt lgkmcnt(0)
  s_barrier
  ds_read_b128 v[12:15], v30 offset:0
  ds_read_b128 v[16:19], v30 offset:128
  ds_read_b128 v[20:23], v30 offset:256
  v_and_b32 v50, 15, v0
  v_lshlrev_b32 v50, 5, v50
  v_and_b32 v51, 16, v0
  v_add3_u32 v50, v50, v51, s39
  v_mov_b32 v51, s54
  v_bfe_u32 v8, v0, 1, 3
  v_lshrrev_b32 v9, 4, v0
  v_and_b32 v7, 1, v0
  s_waitcnt lgkmcnt(2)
  v_mfma_f32_16x16x32_bf16 v[24:27], a[72:75], v[12:15], 0
  v_lshl_add_u32 v7, v9, 1, v7
  v_lshlrev_b32 v7, 4, v7
  s_waitcnt lgkmcnt(1)
  v_mfma_f32_16x16x32_bf16 v[24:27], a[76:79], v[16:19], v[24:27]
  s_movk_i32 s63, 384
  v_mad_u32_u24 v7, v8, s63, v7
  s_waitcnt lgkmcnt(0)
  v_mfma_f32_16x16x32_bf16 v[24:27], a[80:83], v[20:23], v[24:27]
  v_lshl_add_u32 v8, v9, 1, v8
  v_and_b32 v8, 7, v8
  s_xor_b32 s61, s48, 0
  s_mul_i32 s61, s61, 3072
  s_add_u32 s61, s61, 50331648
  buffer_load_dwordx4 a[72:75], v1, s[12:15], s61 offen offset:0 nt
  buffer_load_dwordx4 a[76:79], v1, s[12:15], s61 offen offset:128 nt
  buffer_load_dwordx4 a[80:83], v1, s[12:15], s61 offen offset:256 nt
  v_mfma_f32_16x16x32_bf16 v[28:31], a[84:87], v[12:15], 0
  v_mul_u32_u24 v8, 16, v8
  s_add_u32 s76, s69, 393216
  v_mfma_f32_16x16x32_bf16 v[28:31], a[88:91], v[16:19], v[28:31]
  v_mov_b32 v9, 153600
  v_lshl_add_u32 v10, v0, 2, s55
  v_mfma_f32_16x16x32_bf16 v[28:31], a[92:95], v[20:23], v[28:31]
  v_lshl_add_u32 v11, v0, 1, s44
  s_add_u32 s73, s68, 393216
  s_xor_b32 s61, s48, 1
  s_mul_i32 s61, s61, 3072
  s_add_u32 s61, s61, 50331648
  buffer_load_dwordx4 a[84:87], v1, s[12:15], s61 offen offset:0 nt
  buffer_load_dwordx4 a[88:91], v1, s[12:15], s61 offen offset:128 nt
  buffer_load_dwordx4 a[92:95], v1, s[12:15], s61 offen offset:256 nt
  v_mfma_f32_16x16x32_bf16 v[32:35], a[96:99], v[12:15], 0
  v_mfma_f32_16x16x32_bf16 v[32:35], a[100:103], v[16:19], v[32:35]
  v_add_f32_dpp v36, v24, v25 quad_perm:[0,0,2,2] row_mask:0xf bank_mask:0x1
  v_mfma_f32_16x16x32_bf16 v[32:35], a[104:107], v[20:23], v[32:35]
  s_xor_b32 s61, s48, 2
  s_mul_i32 s61, s61, 3072
  s_add_u32 s61, s61, 50331648
  buffer_load_dwordx4 a[96:99], v1, s[12:15], s61 offen offset:0 nt
  buffer_load_dwordx4 a[100:103], v1, s[12:15], s61 offen offset:128 nt
  buffer_load_dwordx4 a[104:107], v1, s[12:15], s61 offen offset:256 nt
  v_add_f32_dpp v36, v26, v27 quad_perm:[0,0,2,2] row_mask:0xf bank_mask:0x4
  v_mfma_f32_16x16x32_bf16 v[24:27], a[108:111], v[12:15], 0
  v_mfma_f32_16x16x32_bf16 v[24:27], a[112:115], v[16:19], v[24:27]
  v_add_f32_dpp v36, v28, v29 quad_perm:[0,0,2,2] row_mask:0xf bank_mask:0x2
  v_mfma_f32_16x16x32_bf16 v[24:27], a[116:119], v[20:23], v[24:27]
  s_nop 0
  v_add_f32_dpp v36, v30, v31 quad_perm:[0,0,2,2] row_mask:0xf bank_mask:0x8
  v_mfma_f32_16x16x32_bf16 v[28:31], a[120:123], v[12:15], 0
  s_nop 0
  v_mov_b32_dpp v36, v36 quad_perm:[1,1,3,3] row_mask:0xf bank_mask:0xf
  v_mfma_f32_16x16x32_bf16 v[28:31], a[124:127], v[16:19], v[28:31]
  v_add_f32_dpp v37, v32, v33 quad_perm:[0,0,2,2] row_mask:0xf bank_mask:0x1
  v_mfma_f32_16x16x32_bf16 v[28:31], a[128:131], v[20:23], v[28:31]
  s_nop 0
  v_add_f32_dpp v37, v34, v35 quad_perm:[0,0,2,2] row_mask:0xf bank_mask:0x4
  v_mfma_f32_16x16x32_bf16 v[32:35], a[132:135], v[12:15], 0
  v_mfma_f32_16x16x32_bf16 v[32:35], a[136:139], v[16:19], v[32:35]
  v_add_f32_dpp v37, v24, v25 quad_perm:[0,0,2,2] row_mask:0xf bank_mask:0x2
  v_mfma_f32_16x16x32_bf16 v[32:35], a[140:143], v[20:23], v[32:35]
  s_nop 0
  v_add_f32_dpp v37, v26, v27 quad_perm:[0,0,2,2] row_mask:0xf bank_mask:0x8
  v_mfma_f32_16x16x32_bf16 v[24:27], a[144:147], v[12:15], 0
  s_nop 0
  v_mov_b32_dpp v37, v37 quad_perm:[1,1,3,3] row_mask:0xf bank_mask:0xf
  v_mfma_f32_16x16x32_bf16 v[24:27], a[148:151], v[16:19], v[24:27]
  v_add_f32_dpp v38, v28, v29 quad_perm:[0,0,2,2] row_mask:0xf bank_mask:0x1
  v_mfma_f32_16x16x32_bf16 v[24:27], a[152:155], v[20:23], v[24:27]
  s_nop 0
  v_add_f32_dpp v38, v30, v31 quad_perm:[0,0,2,2] row_mask:0xf bank_mask:0x4
  v_mfma_f32_16x16x32_bf16 v[28:31], a[156:159], v[12:15], 0
  v_mfma_f32_16x16x32_bf16 v[28:31], a[160:163], v[16:19], v[28:31]
  v_add_f32_dpp v38, v32, v33 quad_perm:[0,0,2,2] row_mask:0xf bank_mask:0x2
  v_mfma_f32_16x16x32_bf16 v[28:31], a[164:167], v[20:23], v[28:31]
  s_nop 0
  v_add_f32_dpp v38, v34, v35 quad_perm:[0,0,2,2] row_mask:0xf bank_mask:0x8
  v_mfma_f32_16x16x32_bf16 v[32:35], a[168:171], v[12:15], 0
  s_nop 0
  v_mov_b32_dpp v38, v38 quad_perm:[1,1,3,3] row_mask:0xf bank_mask:0xf
  v_mfma_f32_16x16x32_bf16 v[32:35], a[172:175], v[16:19], v[32:35]
  v_add_f32_dpp v39, v24, v25 quad_perm:[0,0,2,2] row_mask:0xf bank_mask:0x1
  v_mfma_f32_16x16x32_bf16 v[32:35], a[176:179], v[20:23], v[32:35]
  s_nop 0
  v_add_f32_dpp v39, v26, v27 quad_perm:[0,0,2,2] row_mask:0xf bank_mask:0x4
  v_mfma_f32_16x16x32_bf16 v[24:27], a[180:183], v[12:15], 0
  v_mfma_f32_16x16x32_bf16 v[24:27], a[184:187], v[16:19], v[24:27]
  v_add_f32_dpp v39, v28, v29 quad_perm:[0,0,2,2] row_mask:0xf bank_mask:0x2
  v_mfma_f32_16x16x32_bf16 v[24:27], a[188:191], v[20:23], v[24:27]
  s_nop 0
  v_add_f32_dpp v39, v30, v31 quad_perm:[0,0,2,2] row_mask:0xf bank_mask:0x8
  v_mfma_f32_16x16x32_bf16 v[28:31], a[192:195], v[12:15], 0
  s_nop 0
  v_mov_b32_dpp v39, v39 quad_perm:[1,1,3,3] row_mask:0xf bank_mask:0xf
  v_mfma_f32_16x16x32_bf16 v[28:31], a[196:199], v[16:19], v[28:31]
  v_add_f32_dpp v40, v32, v33 quad_perm:[0,0,2,2] row_mask:0xf bank_mask:0x1
  v_mfma_f32_16x16x32_bf16 v[28:31], a[200:203], v[20:23], v[28:31]
  s_nop 0
  v_add_f32_dpp v40, v34, v35 quad_perm:[0,0,2,2] row_mask:0xf bank_mask:0x4
  v_mfma_f32_16x16x32_bf16 v[32:35], a[204:207], v[12:15], 0
  v_mfma_f32_16x16x32_bf16 v[32:35], a[208:211], v[16:19], v[32:35]
  v_add_f32_dpp v40, v24, v25 quad_perm:[0,0,2,2] row_mask:0xf bank_mask:0x2
  v_mfma_f32_16x16x32_bf16 v[32:35], a[212:215], v[20:23], v[32:35]
  s_nop 0
  v_add_f32_dpp v40, v26, v27 quad_perm:[0,0,2,2] row_mask:0xf bank_mask:0x8
  v_mfma_f32_16x16x32_bf16 v[24:27], a[216:219], v[12:15], 0
  s_nop 0
  v_mov_b32_dpp v40, v40 quad_perm:[1,1,3,3] row_mask:0xf bank_mask:0xf
  v_mfma_f32_16x16x32_bf16 v[24:27], a[220:223], v[16:19], v[24:27]
  v_add_f32_dpp v41, v28, v29 quad_perm:[0,0,2,2] row_mask:0xf bank_mask:0x1
  v_mfma_f32_16x16x32_bf16 v[24:27], a[224:227], v[20:23], v[24:27]
  s_nop 0
  v_add_f32_dpp v41, v30, v31 quad_perm:[0,0,2,2] row_mask:0xf bank_mask:0x4
  v_mfma_f32_16x16x32_bf16 v[28:31], a[228:231], v[12:15], 0
  v_mfma_f32_16x16x32_bf16 v[28:31], a[232:235], v[16:19], v[28:31]
  v_add_f32_dpp v41, v32, v33 quad_perm:[0,0,2,2] row_mask:0xf bank_mask:0x2
  v_mfma_f32_16x16x32_bf16 v[28:31], a[236:239], v[20:23], v[28:31]
  s_nop 0
  v_add_f32_dpp v41, v34, v35 quad_perm:[0,0,2,2] row_mask:0xf bank_mask:0x8
  v_mfma_f32_16x16x32_bf16 v[32:35], a[240:243], v[12:15], 0
  s_nop 0
  v_mov_b32_dpp v41, v41 quad_perm:[1,1,3,3] row_mask:0xf bank_mask:0xf
  v_mfma_f32_16x16x32_bf16 v[32:35], a[244:247], v[16:19], v[32:35]
  v_add_f32_dpp v42, v24, v25 quad_perm:[0,0,2,2] row_mask:0xf bank_mask:0x1
  v_mfma_f32_16x16x32_bf16 v[32:35], a[248:251], v[20:23], v[32:35]
  s_nop 0
  v_add_f32_dpp v42, v26, v27 quad_perm:[0,0,2,2] row_mask:0xf bank_mask:0x4
  v_mfma_f32_16x16x32_bf16 v[24:27], a[252:255], v[12:15], 0
  v_mfma_f32_16x16x32_bf16 v[24:27], v[56:59], v[16:19], v[24:27]
  v_add_f32_dpp v42, v28, v29 quad_perm:[0,0,2,2] row_mask:0xf bank_mask:0x2
  v_mfma_f32_16x16x32_bf16 v[24:27], v[60:63], v[20:23], v[24:27]
  s_nop 0
  v_add_f32_dpp v42, v30, v31 quad_perm:[0,0,2,2] row_mask:0xf bank_mask:0x8
  v_add_f32_dpp v43, v32, v33 quad_perm:[0,0,2,2] row_mask:0xf bank_mask:0x1
  s_nop 1
  v_add_f32_dpp v43, v34, v35 quad_perm:[0,0,2,2] row_mask:0xf bank_mask:0x4
  s_nop 1
  v_add_f32_dpp v43, v24, v25 quad_perm:[0,0,2,2] row_mask:0xf bank_mask:0x2
  v_max3_f32 v52, v36, v37, v38
  v_max3_f32 v52, v52, v39, v40
  v_add_f32_dpp v43, v26, v27 quad_perm:[0,0,2,2] row_mask:0xf bank_mask:0x8
  v_max3_f32 v52, v52, v41, v42
  v_max_f32 v52, v52, v43
  v_mov_b32_dpp v42, v42 quad_perm:[1,1,3,3] row_mask:0xf bank_mask:0xf
  v_mov_b32_dpp v43, v43 quad_perm:[1,1,3,3] row_mask:0xf bank_mask:0xf
  v_max_f32_dpp v52, v52, v52 row_ror:8 row_mask:0xf bank_mask:0xf
  s_nop 1
  v_max_f32_dpp v52, v52, v52 row_ror:4 row_mask:0xf bank_mask:0xf
  s_nop 1
  v_max_f32_dpp v52, v52, v52 row_bcast:15 row_mask:0xa bank_mask:0xf
  s_nop 1
  v_max_f32_dpp v52, v52, v52 row_bcast:31 row_mask:0xc bank_mask:0xf
  s_nop 0
  v_readlane_b32 s34, v52, 63
  s_nop 1
  v_subrev_f32 v36, s34, v36
  v_exp_f32 v36, v36
  v_subrev_f32 v37, s34, v37
  v_mov_b32 v53, v36
  v_cvt_pk_bf16_f32 v36, v36, v36
  v_exp_f32 v37, v37
  v_and_b32 v12, v36, v3
  v_and_b32 v13, v36, v4
  v_and_b32_dpp v14, v36, v5 row_shr:4 row_mask:0xf bank_mask:0xf bound_ctrl:0
  v_and_b32_dpp v15, v36, v6 row_shr:4 row_mask:0xf bank_mask:0xf bound_ctrl:0
  v_mov_b32 v52, s34
  ds_write_b32 v51, v52
  v_mfma_f32_16x16x32_bf16 v[24:27], v[12:15], v[64:67], 0
  v_and_b32 v18, v36, v5
  v_and_b32 v19, v36, v6
  v_mfma_f32_16x16x32_bf16 v[28:31], v[12:15], v[68:71], 0
  v_and_b32_dpp v16, v36, v3 row_shl:4 row_mask:0xf bank_mask:0xf bound_ctrl:0
  v_and_b32_dpp v17, v36, v4 row_shl:4 row_mask:0xf bank_mask:0xf bound_ctrl:0
  v_mfma_f32_16x16x32_bf16 v[32:35], v[12:15], v[72:75], 0
  v_add_f32 v53, v53, v37
  v_cvt_pk_bf16_f32 v37, v37, v37
  v_mfma_f32_16x16x32_bf16 v[24:27], v[16:19], v[76:79], v[24:27]
  v_and_b32 v12, v37, v3
  v_and_b32 v13, v37, v4
  v_mfma_f32_16x16x32_bf16 v[28:31], v[16:19], v[80:83], v[28:31]
  v_and_b32_dpp v14, v37, v5 row_shr:4 row_mask:0xf bank_mask:0xf bound_ctrl:0
  v_and_b32_dpp v15, v37, v6 row_shr:4 row_mask:0xf bank_mask:0xf bound_ctrl:0
  v_mfma_f32_16x16x32_bf16 v[32:35], v[16:19], v[84:87], v[32:35]
  v_subrev_f32 v38, s34, v38
  v_exp_f32 v38, v38
  s_xor_b32 s61, s48, 3
  s_mul_i32 s61, s61, 3072
  s_add_u32 s61, s61, 50331648
  buffer_load_dwordx4 a[108:111], v1, s[12:15], s61 offen offset:0 nt
  v_mfma_f32_16x16x32_bf16 v[24:27], v[12:15], v[88:91], v[24:27]
  v_and_b32 v18, v37, v5
  v_and_b32 v19, v37, v6
  v_mfma_f32_16x16x32_bf16 v[28:31], v[12:15], v[92:95], v[28:31]
  v_and_b32_dpp v16, v37, v3 row_shl:4 row_mask:0xf bank_mask:0xf bound_ctrl:0
  v_and_b32_dpp v17, v37, v4 row_shl:4 row_mask:0xf bank_mask:0xf bound_ctrl:0
  v_mfma_f32_16x16x32_bf16 v[32:35], v[12:15], v[96:99], v[32:35]
  v_add_f32 v53, v53, v38
  v_cvt_pk_bf16_f32 v38, v38, v38
  v_mfma_f32_16x16x32_bf16 v[24:27], v[16:19], v[100:103], v[24:27]
  v_and_b32 v12, v38, v3
  v_and_b32 v13, v38, v4
  v_mfma_f32_16x16x32_bf16 v[28:31], v[16:19], v[104:107], v[28:31]
  v_and_b32_dpp v14, v38, v5 row_shr:4 row_mask:0xf bank_mask:0xf bound_ctrl:0
  v_and_b32_dpp v15, v38, v6 row_shr:4 row_mask:0xf bank_mask:0xf bound_ctrl:0
  v_mfma_f32_16x16x32_bf16 v[32:35], v[16:19], v[108:111], v[32:35]
  v_subrev_f32 v39, s34, v39
  v_exp_f32 v39, v39
  buffer_load_dwordx4 a[112:115], v1, s[12:15], s61 offen offset:128 nt
  v_mfma_f32_16x16x32_bf16 v[24:27], v[12:15], v[112:115], v[24:27]
  v_and_b32 v18, v38, v5
  v_and_b32 v19, v38, v6
  v_mfma_f32_16x16x32_bf16 v[28:31], v[12:15], v[116:119], v[28:31]
  v_and_b32_dpp v16, v38, v3 row_shl:4 row_mask:0xf bank_mask:0xf bound_ctrl:0
  v_and_b32_dpp v17, v38, v4 row_shl:4 row_mask:0xf bank_mask:0xf bound_ctrl:0
  v_mfma_f32_16x16x32_bf16 v[32:35], v[12:15], v[120:123], v[32:35]
  v_add_f32 v53, v53, v39
  v_cvt_pk_bf16_f32 v39, v39, v39
  v_mfma_f32_16x16x32_bf16 v[24:27], v[16:19], v[124:127], v[24:27]
  v_and_b32 v12, v39, v3
  v_and_b32 v13, v39, v4
  v_mfma_f32_16x16x32_bf16 v[28:31], v[16:19], v[128:131], v[28:31]
  v_and_b32_dpp v14, v39, v5 row_shr:4 row_mask:0xf bank_mask:0xf bound_ctrl:0
  v_and_b32_dpp v15, v39, v6 row_shr:4 row_mask:0xf bank_mask:0xf bound_ctrl:0
  v_mfma_f32_16x16x32_bf16 v[32:35], v[16:19], v[132:135], v[32:35]
  v_subrev_f32 v40, s34, v40
  v_exp_f32 v40, v40
  buffer_load_dwordx4 a[116:119], v1, s[12:15], s61 offen offset:256 nt
  v_mfma_f32_16x16x32_bf16 v[24:27], v[12:15], v[136:139], v[24:27]
  v_and_b32 v18, v39, v5
  v_and_b32 v19, v39, v6
  v_mfma_f32_16x16x32_bf16 v[28:31], v[12:15], v[140:143], v[28:31]
  v_and_b32_dpp v16, v39, v3 row_shl:4 row_mask:0xf bank_mask:0xf bound_ctrl:0
  v_and_b32_dpp v17, v39, v4 row_shl:4 row_mask:0xf bank_mask:0xf bound_ctrl:0
  v_mfma_f32_16x16x32_bf16 v[32:35], v[12:15], v[144:147], v[32:35]
  v_add_f32 v53, v53, v40
  v_cvt_pk_bf16_f32 v40, v40, v40
  v_mfma_f32_16x16x32_bf16 v[24:27], v[16:19], v[148:151], v[24:27]
  v_and_b32 v12, v40, v3
  v_and_b32 v13, v40, v4
  v_mfma_f32_16x16x32_bf16 v[28:31], v[16:19], v[152:155], v[28:31]
  v_and_b32_dpp v14, v40, v5 row_shr:4 row_mask:0xf bank_mask:0xf bound_ctrl:0
  v_and_b32_dpp v15, v40, v6 row_shr:4 row_mask:0xf bank_mask:0xf bound_ctrl:0
  v_mfma_f32_16x16x32_bf16 v[32:35], v[16:19], v[156:159], v[32:35]
  v_subrev_f32 v41, s34, v41
  v_exp_f32 v41, v41
  s_xor_b32 s61, s48, 4
  s_mul_i32 s61, s61, 3072
  s_add_u32 s61, s61, 50331648
  buffer_load_dwordx4 a[120:123], v1, s[12:15], s61 offen offset:0 nt
  v_mfma_f32_16x16x32_bf16 v[24:27], v[12:15], v[160:163], v[24:27]
  v_and_b32 v18, v40, v5
  v_and_b32 v19, v40, v6
  v_mfma_f32_16x16x32_bf16 v[28:31], v[12:15], v[164:167], v[28:31]
  v_and_b32_dpp v16, v40, v3 row_shl:4 row_mask:0xf bank_mask:0xf bound_ctrl:0
  v_and_b32_dpp v17, v40, v4 row_shl:4 row_mask:0xf bank_mask:0xf bound_ctrl:0
  v_mfma_f32_16x16x32_bf16 v[32:35], v[12:15], v[168:171], v[32:35]
  v_add_f32 v53, v53, v41
  v_cvt_pk_bf16_f32 v41, v41, v41
  v_mfma_f32_16x16x32_bf16 v[24:27], v[16:19], v[172:175], v[24:27]
  v_and_b32 v12, v41, v3
  v_and_b32 v13, v41, v4
  v_mfma_f32_16x16x32_bf16 v[28:31], v[16:19], v[176:179], v[28:31]
  v_and_b32_dpp v14, v41, v5 row_shr:4 row_mask:0xf bank_mask:0xf bound_ctrl:0
  v_and_b32_dpp v15, v41, v6 row_shr:4 row_mask:0xf bank_mask:0xf bound_ctrl:0
  v_mfma_f32_16x16x32_bf16 v[32:35], v[16:19], v[180:183], v[32:35]
  v_subrev_f32 v42, s34, v42
  v_exp_f32 v42, v42
  buffer_load_dwordx4 a[124:127], v1, s[12:15], s61 offen offset:128 nt
  v_mfma_f32_16x16x32_bf16 v[24:27], v[12:15], v[184:187], v[24:27]
  v_and_b32 v18, v41, v5
  v_and_b32 v19, v41, v6
  v_mfma_f32_16x16x32_bf16 v[28:31], v[12:15], v[188:191], v[28:31]
  v_and_b32_dpp v16, v41, v3 row_shl:4 row_mask:0xf bank_mask:0xf bound_ctrl:0
  v_and_b32_dpp v17, v41, v4 row_shl:4 row_mask:0xf bank_mask:0xf bound_ctrl:0
  v_mfma_f32_16x16x32_bf16 v[32:35], v[12:15], v[192:195], v[32:35]
  v_add_f32 v53, v53, v42
  v_cvt_pk_bf16_f32 v42, v42, v42
  v_mfma_f32_16x16x32_bf16 v[24:27], v[16:19], v[196:199], v[24:27]
  v_and_b32 v12, v42, v3
  v_and_b32 v13, v42, v4
  v_mfma_f32_16x16x32_bf16 v[28:31], v[16:19], v[200:203], v[28:31]
  v_and_b32_dpp v14, v42, v5 row_shr:4 row_mask:0xf bank_mask:0xf bound_ctrl:0
  v_and_b32_dpp v15, v42, v6 row_shr:4 row_mask:0xf bank_mask:0xf bound_ctrl:0
  v_mfma_f32_16x16x32_bf16 v[32:35], v[16:19], v[204:207], v[32:35]
  v_subrev_f32 v43, s34, v43
  v_exp_f32 v43, v43
  buffer_load_dwordx4 a[128:131], v1, s[12:15], s61 offen offset:256 nt
  v_mfma_f32_16x16x32_bf16 v[24:27], v[12:15], v[208:211], v[24:27]
  v_and_b32 v18, v42, v5
  v_and_b32 v19, v42, v6
  v_mfma_f32_16x16x32_bf16 v[28:31], v[12:15], v[212:215], v[28:31]
  v_and_b32_dpp v16, v42, v3 row_shl:4 row_mask:0xf bank_mask:0xf bound_ctrl:0
  v_and_b32_dpp v17, v42, v4 row_shl:4 row_mask:0xf bank_mask:0xf bound_ctrl:0
  v_mfma_f32_16x16x32_bf16 v[32:35], v[12:15], v[216:219], v[32:35]
  v_add_f32 v53, v53, v43
  v_cvt_pk_bf16_f32 v43, v43, v43
  v_mfma_f32_16x16x32_bf16 v[24:27], v[16:19], v[220:223], v[24:27]
  v_and_b32 v12, v43, v3
  v_and_b32 v13, v43, v4
  v_mfma_f32_16x16x32_bf16 v[28:31], v[16:19], v[224:227], v[28:31]
  v_and_b32_dpp v14, v43, v5 row_shr:4 row_mask:0xf bank_mask:0xf bound_ctrl:0
  v_and_b32_dpp v15, v43, v6 row_shr:4 row_mask:0xf bank_mask:0xf bound_ctrl:0
  v_mfma_f32_16x16x32_bf16 v[32:35], v[16:19], v[228:231], v[32:35]
  s_xor_b32 s61, s48, 5
  s_mul_i32 s61, s61, 3072
  s_add_u32 s61, s61, 50331648
  buffer_load_dwordx4 a[132:135], v1, s[12:15], s61 offen offset:0 nt
  v_mfma_f32_16x16x32_bf16 v[24:27], v[12:15], v[232:235], v[24:27]
  v_and_b32 v18, v43, v5
  v_and_b32 v19, v43, v6
  v_add_f32_dpp v53, v53, v53 row_ror:8 row_mask:0xf bank_mask:0xf
  v_mfma_f32_16x16x32_bf16 v[28:31], v[12:15], v[236:239], v[28:31]
  v_and_b32_dpp v16, v43, v3 row_shl:4 row_mask:0xf bank_mask:0xf bound_ctrl:0
  v_and_b32_dpp v17, v43, v4 row_shl:4 row_mask:0xf bank_mask:0xf bound_ctrl:0
  v_add_f32_dpp v53, v53, v53 row_ror:4 row_mask:0xf bank_mask:0xf
  v_mfma_f32_16x16x32_bf16 v[32:35], v[12:15], v[240:243], v[32:35]
  s_nop 0
  v_add_f32_dpp v53, v53, v53 row_bcast:15 row_mask:0xa bank_mask:0xf
  v_mfma_f32_16x16x32_bf16 v[24:27], v[16:19], v[244:247], v[24:27]
  s_nop 0
  v_add_f32_dpp v53, v53, v53 row_bcast:31 row_mask:0xc bank_mask:0xf
  v_mfma_f32_16x16x32_bf16 v[28:31], v[16:19], v[248:251], v[28:31]
  s_mov_b64 exec, s[36:37]
  ds_write_b32 v51, v53 offset:16
  s_mov_b64 exec, -1
  v_mfma_f32_16x16x32_bf16 v[32:35], v[16:19], v[252:255], v[32:35]
  buffer_load_dwordx4 a[136:139], v1, s[12:15], s61 offen offset:128 nt
  s_mov_b32 exec_lo, 0xffffffff
  s_mov_b32 exec_hi, 0x0
  ds_write_b128 v50, v[24:27] offset:0
  s_mov_b32 exec_lo, 0xff00ff
  s_mov_b32 exec_hi, 0xff00ff00
  ds_write_b128 v50, v[28:31] offset:512
  s_mov_b32 exec_lo, 0x0
  s_mov_b32 exec_hi, 0xffffffff
  ds_write_b128 v50, v[32:35] offset:1024
  s_mov_b64 exec, -1
  s_waitcnt lgkmcnt(0)
  s_barrier
  ds_read_b128 v[44:47], v9
  ds_read_b128 v[48:51], v9 offset:16
  ds_read2st64_b32 v[12:13], v10 offset0:0 offset1:3
  ds_read2st64_b32 v[14:15], v10 offset0:6 offset1:9
  ds_read2st64_b32 v[16:17], v10 offset0:12 offset1:15
  ds_read2st64_b32 v[18:19], v10 offset0:18 offset1:21
  s_waitcnt lgkmcnt(5)
  v_max3_f32 v52, v44, v45, v46
  v_max_f32 v52, v52, v47
  v_sub_f32 v44, v44, v52
  v_sub_f32 v45, v45, v52
  v_sub_f32 v46, v46, v52
  v_sub_f32 v47, v47, v52
  v_exp_f32 v44, v44
  v_exp_f32 v45, v45
  v_exp_f32 v46, v46
  v_exp_f32 v47, v47
  s_waitcnt lgkmcnt(3)
  v_add_f32 v12, v12, v13
  s_waitcnt lgkmcnt(2)
  v_add_f32 v14, v14, v15
  s_waitcnt lgkmcnt(1)
  v_add_f32 v16, v16, v17
  s_waitcnt lgkmcnt(0)
  v_add_f32 v18, v18, v19
  v_mul_f32 v20, v44, v12
  v_fmac_f32 v20, v45, v14
  v_fmac_f32 v20, v46, v16
  v_fmac_f32 v20, v47, v18
  v_mul_f32 v53, v44, v48
  v_fmac_f32 v53, v45, v49
  v_mov_b32_dpp v21, v20 quad_perm:[1,1,3,3] row_mask:0xf bank_mask:0xf
  v_fmac_f32 v53, v46, v50
  v_fmac_f32 v53, v47, v51
  v_cvt_pk_bf16_f32 v20, v20, v21
  v_cndmask_b32 v52, v52, v53, s[100:101]
  v_cndmask_b32 v20, v20, v52, s[42:43]
  v_min_u32 v20, -2, v20
  s_mov_b64 exec, s[46:47]
  s_cmp_lg_u32 s60, 0
  s_cbranch_scc0 Le43
  buffer_store_dword v20, v11, s[20:23], s73 offen
Lf44:
  s_mov_b64 exec, -1
L_pf2:
  v_and_b32 v30, 1, v0
  v_lshrrev_b32 v31, 4, v0
  v_lshlrev_b32 v31, 5, v31
  v_lshl_add_u32 v30, v30, 4, v31
  v_add_u32 v30, 158048, v30
  ds_read_b128 v[12:15], v30 offset:0
  ds_read_b128 v[16:19], v30 offset:128
  ds_read_b128 v[20:23], v30 offset:256
  v_and_b32 v50, 15, v0
  v_lshlrev_b32 v50, 5, v50
  v_and_b32 v51, 16, v0
  v_add3_u32 v50, v50, v51, s39
  v_mov_b32 v51, s54
  v_bfe_u32 v8, v0, 1, 3
  v_lshrrev_b32 v9, 4, v0
  v_and_b32 v7, 1, v0
  s_waitcnt lgkmcnt(2)
  v_mfma_f32_16x16x32_bf16 v[24:27], a[0:3], v[12:15], 0
  v_lshl_add_u32 v7, v9, 1, v7
  v_lshlrev_b32 v7, 4, v7
  s_waitcnt lgkmcnt(1)
  v_mfma_f32_16x16x32_bf16 v[24:27], a[4:7], v[16:19], v[24:27]
  s_movk_i32 s63, 384
  v_mad_u32_u24 v7, v8, s63, v7
  s_waitcnt lgkmcnt(0)
  v_mfma_f32_16x16x32_bf16 v[24:27], a[8:11], v[20:23], v[24:27]
  v_lshl_add_u32 v8, v9, 1, v8
  v_and_b32 v8, 7, v8
  v_mfma_f32_16x16x32_bf16 v[28:31], a[12:15], v[12:15], 0
  v_mul_u32_u24 v8, 16, v8
  s_add_u32 s76, s69, 524288
  v_mfma_f32_16x16x32_bf16 v[28:31], a[16:19], v[16:19], v[28:31]
  v_mov_b32 v9, 153600
  v_lshl_add_u32 v10, v0, 2, s55
  v_mfma_f32_16x16x32_bf16 v[28:31], a[20:23], v[20:23], v[28:31]
  v_lshl_add_u32 v11, v0, 1, s44
  s_add_u32 s73, s68, 524288
  v_mfma_f32_16x16x32_bf16 v[32:35], a[24:27], v[12:15], 0
  v_mfma_f32_16x16x32_bf16 v[32:35], a[28:31], v[16:19], v[32:35]
  v_add_f32_dpp v36, v24, v25 quad_perm:[0,0,2,2] row_mask:0xf bank_mask:0x1
  v_mfma_f32_16x16x32_bf16 v[32:35], a[32:35], v[20:23], v[32:35]
  s_nop 0
  v_add_f32_dpp v36, v26, v27 quad_perm:[0,0,2,2] row_mask:0xf bank_mask:0x4
  v_mfma_f32_16x16x32_bf16 v[24:27], a[36:39], v[12:15], 0
  v_mfma_f32_16x16x32_bf16 v[24:27], a[40:43], v[16:19], v[24:27]
  v_add_f32_dpp v36, v28, v29 quad_perm:[0,0,2,2] row_mask:0xf bank_mask:0x2
  v_mfma_f32_16x16x32_bf16 v[24:27], a[44:47], v[20:23], v[24:27]
  s_nop 0
  v_add_f32_dpp v36, v30, v31 quad_perm:[0,0,2,2] row_mask:0xf bank_mask:0x8
  v_add_f32_dpp v37, v32, v33 quad_perm:[0,0,2,2] row_mask:0xf bank_mask:0x1
  s_nop 1
  v_add_f32_dpp v37, v34, v35 quad_perm:[0,0,2,2] row_mask:0xf bank_mask:0x4
  s_nop 1
  v_add_f32_dpp v37, v24, v25 quad_perm:[0,0,2,2] row_mask:0xf bank_mask:0x2
  s_nop 1
  v_add_f32_dpp v37, v26, v27 quad_perm:[0,0,2,2] row_mask:0xf bank_mask:0x8
  v_max_f32 v52, v36, v37
  v_mov_b32_dpp v36, v36 quad_perm:[1,1,3,3] row_mask:0xf bank_mask:0xf
  v_mov_b32_dpp v37, v37 quad_perm:[1,1,3,3] row_mask:0xf bank_mask:0xf
  v_max_f32_dpp v52, v52, v52 row_ror:8 row_mask:0xf bank_mask:0xf
  s_nop 1
  v_max_f32_dpp v52, v52, v52 row_ror:4 row_mask:0xf bank_mask:0xf
  s_nop 1
  v_max_f32_dpp v52, v52, v52 row_bcast:15 row_mask:0xa bank_mask:0xf
  s_nop 1
  v_max_f32_dpp v52, v52, v52 row_bcast:31 row_mask:0xc bank_mask:0xf
  s_nop 0
  v_readlane_b32 s34, v52, 63
  s_nop 1
  v_subrev_f32 v36, s34, v36
  v_exp_f32 v36, v36
  v_subrev_f32 v37, s34, v37
  v_mov_b32 v53, v36
  v_cvt_pk_bf16_f32 v36, v36, v36
  v_exp_f32 v37, v37
  v_and_b32 v12, v36, v3
  v_and_b32 v13, v36, v4
  v_and_b32_dpp v14, v36, v5 row_shr:4 row_mask:0xf bank_mask:0xf bound_ctrl:0
  v_and_b32_dpp v15, v36, v6 row_shr:4 row_mask:0xf bank_mask:0xf bound_ctrl:0
  s_barrier
  v_mov_b32 v52, s34
  ds_write_b32 v51, v52
  v_mfma_f32_16x16x32_bf16 v[24:27], v[12:15], a[48:51], 0
  v_and_b32 v18, v36, v5
  v_and_b32 v19, v36, v6
  v_mfma_f32_16x16x32_bf16 v[28:31], v[12:15], a[52:55], 0
  v_and_b32_dpp v16, v36, v3 row_shl:4 row_mask:0xf bank_mask:0xf bound_ctrl:0
  v_and_b32_dpp v17, v36, v4 row_shl:4 row_mask:0xf bank_mask:0xf bound_ctrl:0
  v_mfma_f32_16x16x32_bf16 v[32:35], v[12:15], a[56:59], 0
  v_add_f32 v53, v53, v37
  v_cvt_pk_bf16_f32 v37, v37, v37
  s_waitcnt vmcnt(8)
  buffer_load_dwordx4 a[140:143], v1, s[12:15], s61 offen offset:256 nt
  s_waitcnt vmcnt(8)
  s_xor_b32 s61, s48, 6
  s_mul_i32 s61, s61, 3072
  s_add_u32 s61, s61, 50331648
  buffer_load_dwordx4 a[144:147], v1, s[12:15], s61 offen offset:0 nt
  v_mfma_f32_16x16x32_bf16 v[24:27], v[16:19], a[60:63], v[24:27]
  v_and_b32 v12, v37, v3
  v_and_b32 v13, v37, v4
  v_mfma_f32_16x16x32_bf16 v[28:31], v[16:19], a[64:67], v[28:31]
  v_and_b32_dpp v14, v37, v5 row_shr:4 row_mask:0xf bank_mask:0xf bound_ctrl:0
  v_and_b32_dpp v15, v37, v6 row_shr:4 row_mask:0xf bank_mask:0xf bound_ctrl:0
  v_mfma_f32_16x16x32_bf16 v[32:35], v[16:19], a[68:71], v[32:35]
  s_waitcnt vmcnt(8)
  buffer_load_dwordx4 a[148:151], v1, s[12:15], s61 offen offset:128 nt
  s_waitcnt vmcnt(8)
  buffer_load_dwordx4 a[152:155], v1, s[12:15], s61 offen offset:256 nt
  v_lshl_add_u32 v54, v0, 4, s94
  ds_read_b128 v[38:41], v54 offset:0
  ds_read_b128 v[42:45], v54 offset:1024
  ds_read_b128 v[46:49], v54 offset:2048
  s_waitcnt lgkmcnt(2)
  v_mfma_f32_16x16x32_bf16 v[24:27], v[12:15], v[38:41], v[24:27]
  v_and_b32 v18, v37, v5
  v_and_b32 v19, v37, v6
  v_add_f32_dpp v53, v53, v53 row_ror:8 row_mask:0xf bank_mask:0xf
  s_waitcnt lgkmcnt(1)
  v_mfma_f32_16x16x32_bf16 v[28:31], v[12:15], v[42:45], v[28:31]
  v_and_b32_dpp v16, v37, v3 row_shl:4 row_mask:0xf bank_mask:0xf bound_ctrl:0
  v_and_b32_dpp v17, v37, v4 row_shl:4 row_mask:0xf bank_mask:0xf bound_ctrl:0
  v_add_f32_dpp v53, v53, v53 row_ror:4 row_mask:0xf bank_mask:0xf
  s_waitcnt lgkmcnt(0)
  v_mfma_f32_16x16x32_bf16 v[32:35], v[12:15], v[46:49], v[32:35]
  v_add_f32_dpp v53, v53, v53 row_bcast:15 row_mask:0xa bank_mask:0xf
  s_waitcnt vmcnt(8)
  s_xor_b32 s61, s48, 7
  s_mul_i32 s61, s61, 3072
  s_add_u32 s61, s61, 50331648
  buffer_load_dwordx4 a[156:159], v1, s[12:15], s61 offen offset:0 nt
  s_waitcnt vmcnt(8)
  buffer_load_dwordx4 a[160:163], v1, s[12:15], s61 offen offset:128 nt
  v_lshl_add_u32 v54, v0, 4, s94
  ds_read_b128 v[38:41], v54 offset:3072
  ds_read_b128 v[42:45], v54 offset:4096
  ds_read_b128 v[46:49], v54 offset:5120
  s_waitcnt lgkmcnt(2)
  v_mfma_f32_16x16x32_bf16 v[24:27], v[16:19], v[38:41], v[24:27]
  v_add_f32_dpp v53, v53, v53 row_bcast:31 row_mask:0xc bank_mask:0xf
  s_waitcnt lgkmcnt(1)
  v_mfma_f32_16x16x32_bf16 v[28:31], v[16:19], v[42:45], v[28:31]
  s_mov_b64 exec, s[36:37]
  ds_write_b32 v51, v53 offset:16
  s_mov_b64 exec, -1
  s_waitcnt lgkmcnt(1)
  v_mfma_f32_16x16x32_bf16 v[32:35], v[16:19], v[46:49], v[32:35]
  s_waitcnt vmcnt(8)
  buffer_load_dwordx4 a[164:167], v1, s[12:15], s61 offen offset:256 nt
  s_waitcnt vmcnt(8)
  s_xor_b32 s61, s48, 8
  s_mul_i32 s61, s61, 3072
  s_add_u32 s61, s61, 50331648
  buffer_load_dwordx4 a[168:171], v1, s[12:15], s61 offen offset:0 nt
  s_mov_b32 exec_lo, 0xffffffff
  s_mov_b32 exec_hi, 0x0
  ds_write_b128 v50, v[24:27] offset:0
  s_mov_b32 exec_lo, 0xff00ff
  s_mov_b32 exec_hi, 0xff00ff00
  ds_write_b128 v50, v[28:31] offset:512
  s_mov_b32 exec_lo, 0x0
  s_mov_b32 exec_hi, 0xffffffff
  ds_write_b128 v50, v[32:35] offset:1024
  s_mov_b64 exec, -1
  s_waitcnt lgkmcnt(0)
  s_barrier
  ds_read_b128 v[44:47], v9
  ds_read_b128 v[48:51], v9 offset:16
  ds_read2st64_b32 v[12:13], v10 offset0:0 offset1:3
  ds_read2st64_b32 v[14:15], v10 offset0:6 offset1:9
  ds_read2st64_b32 v[16:17], v10 offset0:12 offset1:15
  ds_read2st64_b32 v[18:19], v10 offset0:18 offset1:21
  s_waitcnt lgkmcnt(5)
  v_max3_f32 v52, v44, v45, v46
  v_max_f32 v52, v52, v47
  v_sub_f32 v44, v44, v52
  v_sub_f32 v45, v45, v52
  v_sub_f32 v46, v46, v52
  v_sub_f32 v47, v47, v52
  buffer_load_dwordx4 a[172:175], v1, s[12:15], s61 offen offset:128 nt
  v_exp_f32 v44, v44
  v_exp_f32 v45, v45
  v_exp_f32 v46, v46
  v_exp_f32 v47, v47
  s_waitcnt lgkmcnt(3)
  v_add_f32 v12, v12, v13
  s_waitcnt lgkmcnt(2)
  v_add_f32 v14, v14, v15
  s_waitcnt lgkmcnt(1)
  v_add_f32 v16, v16, v17
  s_waitcnt lgkmcnt(0)
  v_add_f32 v18, v18, v19
  buffer_load_dwordx4 a[176:179], v1, s[12:15], s61 offen offset:256 nt
  v_mul_f32 v20, v44, v12
  v_fmac_f32 v20, v45, v14
  v_fmac_f32 v20, v46, v16
  v_fmac_f32 v20, v47, v18
  v_mul_f32 v53, v44, v48
  v_fmac_f32 v53, v45, v49
  v_mov_b32_dpp v21, v20 quad_perm:[1,1,3,3] row_mask:0xf bank_mask:0xf
  v_fmac_f32 v53, v46, v50
  v_fmac_f32 v53, v47, v51
  v_cvt_pk_bf16_f32 v20, v20, v21
  v_cndmask_b32 v52, v52, v53, s[100:101]
  v_cndmask_b32 v20, v20, v52, s[42:43]
  v_min_u32 v20, -2, v20
  s_mov_b64 exec, s[46:47]
  s_cmp_lg_u32 s60, 0
  s_cbranch_scc0 Le45
  buffer_store_dword v20, v11, s[20:23], s73 offen
Lf46:
  s_mov_b64 exec, -1
  s_waitcnt vmcnt(8)
  s_xor_b32 s61, s48, 9
  s_mul_i32 s61, s61, 3072
  s_add_u32 s61, s61, 50331648
  buffer_load_dwordx4 a[180:183], v1, s[12:15], s61 offen offset:0 nt
  s_waitcnt vmcnt(8)
  buffer_load_dwordx4 a[184:187], v1, s[12:15], s61 offen offset:128 nt
  s_waitcnt vmcnt(8)
  buffer_load_dwordx4 a[188:191], v1, s[12:15], s61 offen offset:256 nt
  s_waitcnt vmcnt(8)
  s_xor_b32 s61, s48, 10
  s_mul_i32 s61, s61, 3072
  s_add_u32 s61, s61, 50331648
  buffer_load_dwordx4 a[192:195], v1, s[12:15], s61 offen offset:0 nt
  s_waitcnt vmcnt(8)
  buffer_load_dwordx4 a[196:199], v1, s[12:15], s61 offen offset:128 nt
  s_waitcnt vmcnt(8)
  buffer_load_dwordx4 a[200:203], v1, s[12:15], s61 offen offset:256 nt
  s_waitcnt vmcnt(8)
  s_xor_b32 s61, s48, 11
  s_mul_i32 s61, s61, 3072
  s_add_u32 s61, s61, 50331648
  buffer_load_dwordx4 a[204:207], v1, s[12:15], s61 offen offset:0 nt
  v_bfe_u32 v8, v0, 1, 3
  v_lshrrev_b32 v9, 4, v0
  v_and_b32 v7, 1, v0
  v_lshl_add_u32 v7, v9, 1, v7
  v_lshlrev_b32 v7, 4, v7
  s_movk_i32 s63, 384
  v_mad_u32_u24 v7, v8, s63, v7
  v_lshl_add_u32 v8, v9, 1, v8
  v_and_b32 v8, 7, v8
  v_mul_u32_u24 v8, 16, v8
  s_add_u32 s76, s69, 524288
  buffer_load_dwordx2 v[52:53], v8, s[20:23], s76 offen offset:3072 sc1
  buffer_load_dwordx4 v[12:15], v7, s[20:23], s76 offen offset:0 sc1
  buffer_load_dwordx4 v[16:19], v7, s[20:23], s76 offen offset:128 sc1
  buffer_load_dwordx4 v[20:23], v7, s[20:23], s76 offen offset:256 sc1
  v_bfe_u32 v10, v0, 2, 2
  v_and_b32 v11, 48, v0
  v_add_u32 v10, v10, v11
  v_mul_u32_u24 v10, 160, v10
  v_and_b32 v11, 3, v0
  v_lshl_add_u32 v10, v11, 3, v10
  s_add_u32 s64, s95, 30720
  v_add_u32 v10, s64, v10
  ds_read_b64_tr_b16 v[24:25], v10 offset:0
  ds_read_b64_tr_b16 v[26:27], v10 offset:640
  ds_read_b64_tr_b16 v[28:29], v10 offset:1280
  ds_read_b64_tr_b16 v[30:31], v10 offset:1920
  ds_read_b64_tr_b16 v[32:33], v10 offset:10240
  ds_read_b64_tr_b16 v[34:35], v10 offset:10880
  ds_read_b64_tr_b16 v[36:37], v10 offset:11520
  ds_read_b64_tr_b16 v[38:39], v10 offset:12160
  ds_read_b64_tr_b16 v[40:41], v10 offset:20480
  ds_read_b64_tr_b16 v[42:43], v10 offset:21120
  ds_read_b64_tr_b16 v[44:45], v10 offset:21760
  ds_read_b64_tr_b16 v[46:47], v10 offset:22400
  v_and_b32 v11, 15, v0
  v_lshlrev_b32 v11, 1, v11
  v_and_b32 v9, 32, v0
  v_add3_u32 v11, v11, v9, s95
  s_add_u32 s73, s70, 196608
  s_waitcnt vmcnt(8)
  buffer_load_dwordx4 a[208:211], v1, s[12:15], s61 offen offset:128 nt
  s_waitcnt vmcnt(8)
  buffer_load_dwordx4 a[212:215], v1, s[12:15], s61 offen offset:256 nt
  s_waitcnt vmcnt(8)
  s_xor_b32 s61, s48, 12
  s_mul_i32 s61, s61, 3072
  s_add_u32 s61, s61, 50331648
  buffer_load_dwordx4 a[216:219], v1, s[12:15], s61 offen offset:0 nt
  s_waitcnt vmcnt(8)
  buffer_load_dwordx4 a[220:223], v1, s[12:15], s61 offen offset:128 nt
  s_waitcnt vmcnt(8)
  buffer_load_dwordx4 a[224:227], v1, s[12:15], s61 offen offset:256 nt
  s_waitcnt vmcnt(8)
  s_xor_b32 s61, s48, 13
  s_mul_i32 s61, s61, 3072
  s_add_u32 s61, s61, 50331648
  buffer_load_dwordx4 a[228:231], v1, s[12:15], s61 offen offset:0 nt
  s_waitcnt vmcnt(8)
  buffer_load_dwordx4 a[232:235], v1, s[12:15], s61 offen offset:128 nt
  s_waitcnt vmcnt(8)
  buffer_load_dwordx4 a[236:239], v1, s[12:15], s61 offen offset:256 nt
  s_waitcnt vmcnt(8)
  s_xor_b32 s61, s48, 14
  s_mul_i32 s61, s61, 3072
  s_add_u32 s61, s61, 50331648
  buffer_load_dwordx4 a[240:243], v1, s[12:15], s61 offen offset:0 nt
Lc47:
  s_waitcnt lgkmcnt(10)
  v_mfma_f32_16x16x32_bf16 v[48:51], v[12:15], v[24:27], 0
  v_max3_u32 v9, v52, v53, v12
  v_max3_u32 v9, v9, v13, v14
  v_max3_u32 v9, v9, v15, v16
  s_waitcnt lgkmcnt(6)
  v_mfma_f32_16x16x32_bf16 v[48:51], v[16:19], v[32:35], v[48:51]
  v_max3_u32 v9, v9, v17, v18
  v_max3_u32 v9, v9, v19, v20
  v_max3_u32 v9, v9, v21, v22
  s_waitcnt lgkmcnt(2)
  v_mfma_f32_16x16x32_bf16 v[48:51], v[20:23], v[40:43], v[48:51]
  v_max_u32 v9, v9, v23
  v_cmp_eq_u32 vcc, -1, v9
  s_cbranch_vccnz Lr48
  v_max_f32_dpp v9, v52, v52 row_ror:8 row_mask:0xf bank_mask:0xf
  v_mfma_f32_16x16x32_bf16 v[24:27], v[12:15], v[28:31], 0
  ds_read_b64_tr_b16 v[32:33], v10 offset:32
  ds_read_b64_tr_b16 v[34:35], v10 offset:672
  v_max_f32_dpp v9, v9, v9 row_ror:4 row_mask:0xf bank_mask:0xf
  v_mfma_f32_16x16x32_bf16 v[24:27], v[16:19], v[36:39], v[24:27]
  buffer_load_dwordx4 a[244:247], v1, s[12:15], s61 offen offset:128 nt
  ds_read_b64_tr_b16 v[40:41], v10 offset:10272
  ds_read_b64_tr_b16 v[42:43], v10 offset:10912
  v_max_f32_dpp v9, v9, v9 row_ror:2 row_mask:0xf bank_mask:0xf
  s_waitcnt lgkmcnt(4)
  v_mfma_f32_16x16x32_bf16 v[24:27], v[20:23], v[44:47], v[24:27]
  v_sub_f32 v52, v52, v9
  v_exp_f32 v52, v52
  ds_read_b64_tr_b16 v[28:29], v10 offset:20512
  ds_read_b64_tr_b16 v[30:31], v10 offset:21152
  v_mul_f32 v53, v52, v53
  ds_read_b64_tr_b16 v[36:37], v10 offset:1312
  ds_read_b64_tr_b16 v[38:39], v10 offset:1952
  v_add_f32_dpp v53, v53, v53 row_ror:8 row_mask:0xf bank_mask:0xf
  ds_read_b64_tr_b16 v[44:45], v10 offset:11552
  ds_read_b64_tr_b16 v[46:47], v10 offset:12192
  v_add_f32_dpp v53, v53, v53 row_ror:4 row_mask:0xf bank_mask:0xf
  v_add_f32 v48, v48, v25
  v_add_f32 v50, v50, v27
  v_add_f32_dpp v53, v53, v53 row_ror:2 row_mask:0xf bank_mask:0xf
  v_mov_b32 v7, v48
  v_mov_b32 v8, v50
  v_rcp_f32 v53, v53
  s_waitcnt lgkmcnt(8)
  v_mfma_f32_16x16x32_bf16 v[48:51], v[12:15], v[32:35], 0
  ds_read_b64_tr_b16 v[32:33], v10 offset:21792
  ds_read_b64_tr_b16 v[34:35], v10 offset:22432
  v_mul_f32 v9, v52, v53
  s_waitcnt lgkmcnt(8)
  v_mfma_f32_16x16x32_bf16 v[48:51], v[16:19], v[40:43], v[48:51]
  buffer_load_dwordx4 a[248:251], v1, s[12:15], s61 offen offset:256 nt
  s_waitcnt lgkmcnt(6)
  v_mfma_f32_16x16x32_bf16 v[48:51], v[20:23], v[28:31], v[48:51]
  v_mul_f32_dpp v52, v9, v7 row_newbcast:0 row_mask:0xf bank_mask:0xf
  s_waitcnt lgkmcnt(4)
  v_mfma_f32_16x16x32_bf16 v[24:27], v[12:15], v[36:39], 0
  v_mov_b32_dpp v7, v9 row_newbcast:0 row_mask:0xf bank_mask:0xf
  s_waitcnt lgkmcnt(2)
  v_mfma_f32_16x16x32_bf16 v[24:27], v[16:19], v[44:47], v[24:27]
  v_fmac_f32_dpp v52, v9, v8 row_newbcast:2 row_mask:0xf bank_mask:0xf
  s_waitcnt lgkmcnt(0)
  v_mfma_f32_16x16x32_bf16 v[24:27], v[20:23], v[32:35], v[24:27]
  s_xor_b32 s61, s48, 15
  s_mul_i32 s61, s61, 3072
  s_add_u32 s61, s61, 50331648
  buffer_load_dwordx4 a[252:255], v1, s[12:15], s61 offen offset:0 nt
  v_mov_b32_dpp v8, v9 row_newbcast:2 row_mask:0xf bank_mask:0xf
  s_nop 2
  v_add_f32 v48, v48, v25
  v_add_f32 v50, v50, v27
  v_mul_f32 v53, v7, v48
  v_fmac_f32 v53, v8, v50
  s_nop 1
  v_permlane32_swap_b32 v52, v53
  v_add_f32 v52, v52, v53
  v_mov_b32 v53, v52
  s_nop 1
  v_permlane16_swap_b32 v52, v53
  v_add_f32 v52, v52, v53
  s_nop 1
  v_mov_b32_dpp v53, v52 quad_perm:[1,1,3,3] row_mask:0xf bank_mask:0xf
  v_cvt_pk_bf16_f32 v52, v52, v53
  v_min_u32 v52, -2, v52
  s_mov_b64 exec, s[80:81]
  buffer_store_dword v52, v11, s[20:23], s73 offen sc1
  s_mov_b64 exec, -1
  v_bfe_u32 v8, v0, 1, 3
  v_lshrrev_b32 v9, 4, v0
  v_and_b32 v7, 1, v0
  v_lshl_add_u32 v7, v9, 1, v7
  v_lshlrev_b32 v7, 4, v7
  s_movk_i32 s63, 384
  v_mad_u32_u24 v7, v8, s63, v7
  v_lshl_add_u32 v8, v9, 1, v8
  v_and_b32 v8, 7, v8
  v_mul_u32_u24 v8, 16, v8
  s_add_u32 s76, s69, 393216
  buffer_load_dwordx2 v[52:53], v8, s[20:23], s76 offen offset:3072 sc1
  buffer_load_dwordx4 v[12:15], v7, s[20:23], s76 offen offset:0 sc1
  buffer_load_dwordx4 v[16:19], v7, s[20:23], s76 offen offset:128 sc1
  buffer_load_dwordx4 v[20:23], v7, s[20:23], s76 offen offset:256 sc1
  v_bfe_u32 v10, v0, 2, 2
  v_and_b32 v11, 48, v0
  v_add_u32 v10, v10, v11
  v_mul_u32_u24 v10, 160, v10
  v_and_b32 v11, 3, v0
  v_lshl_add_u32 v10, v11, 3, v10
  s_add_u32 s64, s95, 92160
  v_add_u32 v10, s64, v10
  ds_read_b64_tr_b16 v[24:25], v10 offset:0
  ds_read_b64_tr_b16 v[26:27], v10 offset:640
  ds_read_b64_tr_b16 v[28:29], v10 offset:1280
  ds_read_b64_tr_b16 v[30:31], v10 offset:1920
  ds_read_b64_tr_b16 v[32:33], v10 offset:10240
  ds_read_b64_tr_b16 v[34:35], v10 offset:10880
  ds_read_b64_tr_b16 v[36:37], v10 offset:11520
  ds_read_b64_tr_b16 v[38:39], v10 offset:12160
  ds_read_b64_tr_b16 v[40:41], v10 offset:20480
  ds_read_b64_tr_b16 v[42:43], v10 offset:21120
  ds_read_b64_tr_b16 v[44:45], v10 offset:21760
  ds_read_b64_tr_b16 v[46:47], v10 offset:22400
  v_and_b32 v11, 15, v0
  v_lshlrev_b32 v11, 1, v11
  v_and_b32 v9, 32, v0
  v_add3_u32 v11, v11, v9, s95
  s_add_u32 s73, s70, 147456
  s_waitcnt vmcnt(8)
  buffer_load_dwordx4 v[56:59], v1, s[12:15], s61 offen offset:128 nt
  s_waitcnt vmcnt(8)
  buffer_load_dwordx4 v[60:63], v1, s[12:15], s61 offen offset:256 nt
  s_waitcnt vmcnt(8)
  s_xor_b32 s61, s48, 0
  s_mul_i32 s61, s61, 3072
  s_add_u32 s61, s61, 50331648
  buffer_load_dwordx4 v[64:67], v2, s[16:19], s61 offen offset:0 nt
  s_waitcnt vmcnt(8)
  buffer_load_dwordx4 v[68:71], v2, s[16:19], s61 offen offset:256 nt
  s_waitcnt vmcnt(8)
  buffer_load_dwordx4 v[72:75], v2, s[16:19], s61 offen offset:512 nt
  s_waitcnt vmcnt(8)
  s_xor_b32 s61, s48, 1
  s_mul_i32 s61, s61, 3072
  s_add_u32 s61, s61, 50331648
  buffer_load_dwordx4 v[76:79], v2, s[16:19], s61 offen offset:0 nt
  s_waitcnt vmcnt(8)
  buffer_load_dwordx4 v[80:83], v2, s[16:19], s61 offen offset:256 nt
  s_waitcnt vmcnt(8)
  buffer_load_dwordx4 v[84:87], v2, s[16:19], s61 offen offset:512 nt
  s_waitcnt vmcnt(8)
  s_xor_b32 s61, s48, 2
  s_mul_i32 s61, s61, 3072
  s_add_u32 s61, s61, 50331648
  buffer_load_dwordx4 v[88:91], v2, s[16:19], s61 offen offset:0 nt
Lc49:
  s_waitcnt lgkmcnt(10)
  v_mfma_f32_16x16x32_bf16 v[48:51], v[12:15], v[24:27], 0
  v_max3_u32 v9, v52, v53, v12
  v_max3_u32 v9, v9, v13, v14
  v_max3_u32 v9, v9, v15, v16
  s_waitcnt lgkmcnt(6)
  v_mfma_f32_16x16x32_bf16 v[48:51], v[16:19], v[32:35], v[48:51]
  v_max3_u32 v9, v9, v17, v18
  v_max3_u32 v9, v9, v19, v20
  v_max3_u32 v9, v9, v21, v22
  s_waitcnt lgkmcnt(2)
  v_mfma_f32_16x16x32_bf16 v[48:51], v[20:23], v[40:43], v[48:51]
  v_max_u32 v9, v9, v23
  v_cmp_eq_u32 vcc, -1, v9
  s_cbranch_vccnz Lr50
  v_max_f32_dpp v9, v52, v52 row_ror:8 row_mask:0xf bank_mask:0xf
  v_mfma_f32_16x16x32_bf16 v[24:27], v[12:15], v[28:31], 0
  ds_read_b64_tr_b16 v[32:33], v10 offset:32
  ds_read_b64_tr_b16 v[34:35], v10 offset:672
  v_max_f32_dpp v9, v9, v9 row_ror:4 row_mask:0xf bank_mask:0xf
  v_mfma_f32_16x16x32_bf16 v[24:27], v[16:19], v[36:39], v[24:27]
  buffer_load_dwordx4 v[92:95], v2, s[16:19], s61 offen offset:256 nt
  ds_read_b64_tr_b16 v[40:41], v10 offset:10272
  ds_read_b64_tr_b16 v[42:43], v10 offset:10912
  v_max_f32_dpp v9, v9, v9 row_ror:2 row_mask:0xf bank_mask:0xf
  s_waitcnt lgkmcnt(4)
  v_mfma_f32_16x16x32_bf16 v[24:27], v[20:23], v[44:47], v[24:27]
  v_sub_f32 v52, v52, v9
  v_exp_f32 v52, v52
  ds_read_b64_tr_b16 v[28:29], v10 offset:20512
  ds_read_b64_tr_b16 v[30:31], v10 offset:21152
  v_mul_f32 v53, v52, v53
  ds_read_b64_tr_b16 v[36:37], v10 offset:1312
  ds_read_b64_tr_b16 v[38:39], v10 offset:1952
  v_add_f32_dpp v53, v53, v53 row_ror:8 row_mask:0xf bank_mask:0xf
  ds_read_b64_tr_b16 v[44:45], v10 offset:11552
  ds_read_b64_tr_b16 v[46:47], v10 offset:12192
  v_add_f32_dpp v53, v53, v53 row_ror:4 row_mask:0xf bank_mask:0xf
  v_add_f32 v48, v48, v25
  v_add_f32 v50, v50, v27
  v_add_f32_dpp v53, v53, v53 row_ror:2 row_mask:0xf bank_mask:0xf
  v_mov_b32 v7, v48
  v_mov_b32 v8, v50
  v_rcp_f32 v53, v53
  s_waitcnt lgkmcnt(8)
  v_mfma_f32_16x16x32_bf16 v[48:51], v[12:15], v[32:35], 0
  ds_read_b64_tr_b16 v[32:33], v10 offset:21792
  ds_read_b64_tr_b16 v[34:35], v10 offset:22432
  v_mul_f32 v9, v52, v53
  s_waitcnt lgkmcnt(8)
  v_mfma_f32_16x16x32_bf16 v[48:51], v[16:19], v[40:43], v[48:51]
  buffer_load_dwordx4 v[96:99], v2, s[16:19], s61 offen offset:512 nt
  s_waitcnt lgkmcnt(6)
  v_mfma_f32_16x16x32_bf16 v[48:51], v[20:23], v[28:31], v[48:51]
  v_mul_f32_dpp v52, v9, v7 row_newbcast:0 row_mask:0xf bank_mask:0xf
  s_waitcnt lgkmcnt(4)
  v_mfma_f32_16x16x32_bf16 v[24:27], v[12:15], v[36:39], 0
  v_mov_b32_dpp v7, v9 row_newbcast:0 row_mask:0xf bank_mask:0xf
  s_waitcnt lgkmcnt(2)
  v_mfma_f32_16x16x32_bf16 v[24:27], v[16:19], v[44:47], v[24:27]
  v_fmac_f32_dpp v52, v9, v8 row_newbcast:2 row_mask:0xf bank_mask:0xf
  s_waitcnt lgkmcnt(0)
  v_mfma_f32_16x16x32_bf16 v[24:27], v[20:23], v[32:35], v[24:27]
  s_xor_b32 s61, s48, 3
  s_mul_i32 s61, s61, 3072
  s_add_u32 s61, s61, 50331648
  buffer_load_dwordx4 v[100:103], v2, s[16:19], s61 offen offset:0 nt
  v_mov_b32_dpp v8, v9 row_newbcast:2 row_mask:0xf bank_mask:0xf
  s_nop 2
  v_add_f32 v48, v48, v25
  v_add_f32 v50, v50, v27
  v_mul_f32 v53, v7, v48
  v_fmac_f32 v53, v8, v50
  s_nop 1
  v_permlane32_swap_b32 v52, v53
  v_add_f32 v52, v52, v53
  v_mov_b32 v53, v52
  s_nop 1
  v_permlane16_swap_b32 v52, v53
  v_add_f32 v52, v52, v53
  s_nop 1
  v_mov_b32_dpp v53, v52 quad_perm:[1,1,3,3] row_mask:0xf bank_mask:0xf
  v_cvt_pk_bf16_f32 v52, v52, v53
  v_min_u32 v52, -2, v52
  s_mov_b64 exec, s[80:81]
  buffer_store_dword v52, v11, s[20:23], s73 offen sc1
  s_mov_b64 exec, -1
  s_waitcnt vmcnt(8)
  buffer_load_dwordx4 v[104:107], v2, s[16:19], s61 offen offset:256 nt
  s_waitcnt vmcnt(8)
  buffer_load_dwordx4 v[108:111], v2, s[16:19], s61 offen offset:512 nt
  s_waitcnt vmcnt(8)
  s_xor_b32 s61, s48, 4
  s_mul_i32 s61, s61, 3072
  s_add_u32 s61, s61, 50331648
  buffer_load_dwordx4 v[112:115], v2, s[16:19], s61 offen offset:0 nt
  s_waitcnt vmcnt(8)
  buffer_load_dwordx4 v[116:119], v2, s[16:19], s61 offen offset:256 nt
  v_lshrrev_b32 v54, 4, v0
  v_mul_u32_u24 v54, 192, v54
  v_and_b32 v9, 15, v0
  v_lshl_add_u32 v54, v9, 4, v54
  s_mul_i32 s63, s3, 1536
  s_add_u32 s72, s71, s63
  s_add_u32 s72, s72, 196608
  s_add_u32 s35, s72, 768
  v_and_b32 v16, 0x3f803f80, v3
  v_and_b32 v17, 0x3f803f80, v4
  v_and_b32 v18, 0x3f803f80, v5
  v_and_b32 v19, 0x3f803f80, v6
  v_mov_b32 v8, 0
  v_mov_b32 v9, 0
  v_mov_b32 v10, 0
  v_mov_b32 v11, 0
  v_mov_b32 v12, 0
  v_mov_b32 v13, 0
  v_mov_b32 v14, 0
  v_mov_b32 v15, 0
  s_mov_b64 exec, s[32:33]
  buffer_load_dwordx4 v[8:11], v54, s[20:23], s72 offen sc1
  buffer_load_dwordx4 v[12:15], v54, s[20:23], s35 offen sc1
  s_mov_b64 exec, -1
  s_waitcnt vmcnt(8)
  buffer_load_dwordx4 v[120:123], v2, s[16:19], s61 offen offset:512 nt
  s_waitcnt vmcnt(8)
  s_xor_b32 s61, s48, 5
  s_mul_i32 s61, s61, 3072
  s_add_u32 s61, s61, 50331648
  buffer_load_dwordx4 v[124:127], v2, s[16:19], s61 offen offset:0 nt
  s_waitcnt vmcnt(8)
  buffer_load_dwordx4 v[128:131], v2, s[16:19], s61 offen offset:256 nt
  s_waitcnt vmcnt(8)
  buffer_load_dwordx4 v[132:135], v2, s[16:19], s61 offen offset:512 nt
  s_waitcnt vmcnt(8)
  s_xor_b32 s61, s48, 6
  s_mul_i32 s61, s61, 3072
  s_add_u32 s61, s61, 50331648
  buffer_load_dwordx4 v[136:139], v2, s[16:19], s61 offen offset:0 nt
  s_waitcnt vmcnt(8)
  buffer_load_dwordx4 v[140:143], v2, s[16:19], s61 offen offset:256 nt
  s_waitcnt vmcnt(8)
  buffer_load_dwordx4 v[144:147], v2, s[16:19], s61 offen offset:512 nt
  s_waitcnt vmcnt(8)
  s_xor_b32 s61, s48, 7
  s_mul_i32 s61, s61, 3072
  s_add_u32 s61, s61, 50331648
  buffer_load_dwordx4 v[148:151], v2, s[16:19], s61 offen offset:0 nt
  s_waitcnt vmcnt(8)
  buffer_load_dwordx4 v[152:155], v2, s[16:19], s61 offen offset:256 nt
Lc51:
  v_mfma_f32_16x16x32_bf16 v[20:23], v[16:19], v[8:11], 0
  v_max3_u32 v7, v8, v9, v10
  v_max3_u32 v7, v7, v11, v12
  v_max3_u32 v7, v7, v13, v14
  v_mfma_f32_16x16x32_bf16 v[20:23], v[16:19], v[12:15], v[20:23]
  v_max_u32 v7, v7, v15
  v_cmp_eq_u32 vcc, -1, v7
  s_cbranch_vccnz Lr52
  v_and_b32 v7, 15, v0
  v_lshlrev_b32 v7, 5, v7
  v_and_b32 v54, 16, v0
  v_add3_u32 v7, v7, v54, s56
  s_mov_b32 exec_lo, s32
  s_mov_b32 exec_hi, 0
  ds_write_b128 v7, v[20:23] offset:1280
  s_mov_b64 exec, -1
  v_lshl_add_u32 v7, v0, 2, s45
  ds_read_b32 v54, v7 offset:640
  v_lshlrev_b32 v14, 3, v0
  v_add_u32 v14, 154944, v14
  v_mov_b32 v22, s45
  v_mov_b32 v23, 156864
  v_cndmask_b32 v23, v22, v23, s[74:75]
  v_lshrrev_b32 v21, 4, v0
  v_lshl_add_u32 v22, v21, 4, v23
  v_lshl_add_u32 v23, v21, 3, v23
  s_waitcnt lgkmcnt(0)
  s_barrier
  s_mov_b32 exec_hi, 0xff
  ds_read2_b64 v[8:11], v14 offset0:0 offset1:40
  ds_read2_b64 v[12:15], v14 offset0:80 offset1:120
  v_lshlrev_b32 v16, 16, v54
  v_and_b32 v17, 0xffff0000, v54
  s_waitcnt lgkmcnt(1)
  v_pk_add_f32 v[8:9], v[8:9], v[10:11]
  s_waitcnt lgkmcnt(0)
  v_pk_add_f32 v[12:13], v[12:13], v[14:15]
  v_pk_add_f32 v[8:9], v[8:9], v[12:13]
  v_cvt_pk_bf16_f32 v8, v8, v9
  v_and_b32 v9, 0xffff0000, v8
  v_lshlrev_b32 v8, 16, v8
  v_pk_add_f32 v[8:9], v[8:9], v[16:17]
  v_cvt_pk_bf16_f32 v8, v8, v9
  ds_write_b32 v7, v8 offset:640
  s_mov_b64 exec, -1
  v_bfe_u32 v7, v0, 2, 2
  buffer_load_dwordx4 v[156:159], v2, s[16:19], s61 offen offset:512 nt
  v_lshrrev_b32 v9, 4, v0
  v_lshl_add_u32 v8, v9, 3, v7
  v_lshl_add_u32 v7, v9, 2, v7
  v_and_b32 v9, 3, v0
  v_lshlrev_b32 v9, 3, v9
  s_mul_i32 s63, s3, 96
  s_add_u32 s63, s63, 61440
  v_add_u32 v9, s63, v9
  s_movk_i32 s63, 384
  v_mad_u32_u24 v8, v8, s63, v9
  v_mad_u32_u24 v7, v7, s63, v9
  ds_read_b64_tr_b16 v[24:25], v8 offset:0
  ds_read_b64_tr_b16 v[26:27], v8 offset:1536
  ds_read_b64_tr_b16 v[28:29], v8 offset:12288
  ds_read_b64_tr_b16 v[30:31], v8 offset:13824
  ds_read_b64_tr_b16 v[32:33], v7 offset:24576
  ds_read_b64_tr_b16 v[34:35], v8 offset:32
  ds_read_b64_tr_b16 v[36:37], v8 offset:1568
  ds_read_b64_tr_b16 v[38:39], v8 offset:12320
  ds_read_b64_tr_b16 v[40:41], v8 offset:13856
  ds_read_b64_tr_b16 v[42:43], v7 offset:24608
  ds_read_b64_tr_b16 v[44:45], v8 offset:64
  ds_read_b64_tr_b16 v[46:47], v8 offset:1600
  ds_read_b64_tr_b16 v[48:49], v8 offset:12352
  ds_read_b64_tr_b16 v[50:51], v8 offset:13888
  ds_read_b64_tr_b16 v[52:53], v7 offset:24640
  ds_read_b128 v[12:15], v22 offset:640
  ds_read_b128 v[16:19], v22 offset:704
  ds_read_b64 v[20:21], v23 offset:768
  v_lshl_add_u32 v7, v0, 2, s55
  s_add_u32 s73, s66, 2473984
  s_waitcnt lgkmcnt(2)
  v_mfma_f32_16x16x32_bf16 v[8:11], v[12:15], v[24:27], 0
  s_waitcnt lgkmcnt(1)
  v_mfma_f32_16x16x32_bf16 v[8:11], v[16:19], v[28:31], v[8:11]
  s_xor_b32 s61, s48, 8
  s_mul_i32 s61, s61, 3072
  s_add_u32 s61, s61, 50331648
  buffer_load_dwordx4 v[160:163], v2, s[16:19], s61 offen offset:0 nt
  v_mfma_f32_16x16x32_bf16 v[24:27], v[12:15], v[34:37], 0
  v_mfma_f32_16x16x32_bf16 v[24:27], v[16:19], v[38:41], v[24:27]
  v_mfma_f32_16x16x32_bf16 v[28:31], v[12:15], v[44:47], 0
  v_mfma_f32_16x16x32_bf16 v[28:31], v[16:19], v[48:51], v[28:31]
  v_mfma_f32_16x16x32_bf16 v[34:37], v[12:15], v[12:15], 0
  v_mfma_f32_16x16x32_bf16 v[34:37], v[16:19], v[16:19], v[34:37]
  s_waitcnt lgkmcnt(0)
  v_mfma_f32_16x16x16_bf16 v[8:11], v[20:21], v[32:33], v[8:11]
  v_mfma_f32_16x16x16_bf16 v[24:27], v[20:21], v[42:43], v[24:27]
  s_nop 0
  v_mfma_f32_16x16x16_bf16 v[28:31], v[20:21], v[52:53], v[28:31]
  s_nop 0
  v_mfma_f32_16x16x16_bf16 v[34:37], v[20:21], v[20:21], v[34:37]
  s_nop 3
  v_cndmask_b32 v22, v8, v24, s[82:83]
  s_nop 0
  v_cndmask_b32 v22, v22, v28, s[84:85]
  s_nop 0
  v_cndmask_b32 v22, v22, v34, s[86:87]
  v_min_u32 v22, -2, v22
  s_cmp_lg_u32 s60, 0
  s_cbranch_scc0 Le53
  buffer_store_dword v22, v7, s[20:23], s73 offen offset:0
Lf54:
  buffer_load_dwordx4 v[164:167], v2, s[16:19], s61 offen offset:256 nt
  buffer_load_dwordx4 v[168:171], v2, s[16:19], s61 offen offset:512 nt
  s_xor_b32 s61, s48, 9
  s_mul_i32 s61, s61, 3072
  s_add_u32 s61, s61, 50331648
  buffer_load_dwordx4 v[172:175], v2, s[16:19], s61 offen offset:0 nt
  s_cmp_lg_u32 s3, 3
  s_cbranch_scc1 Ls55
  s_call_b64 s[78:79], Lst3
  s_call_b64 s[78:79], Lst4
  s_call_b64 s[78:79], Lst5
  s_call_b64 s[78:79], Lst6
Ls55:
  s_waitcnt vmcnt(8)
  buffer_load_dwordx4 v[176:179], v2, s[16:19], s61 offen offset:256 nt
  s_waitcnt vmcnt(8)
  buffer_load_dwordx4 v[180:183], v2, s[16:19], s61 offen offset:512 nt
  s_waitcnt vmcnt(8)
  s_xor_b32 s61, s48, 10
  s_mul_i32 s61, s61, 3072
  s_add_u32 s61, s61, 50331648
  buffer_load_dwordx4 v[184:187], v2, s[16:19], s61 offen offset:0 nt
  s_waitcnt vmcnt(8)
  buffer_load_dwordx4 v[188:191], v2, s[16:19], s61 offen offset:256 nt
  v_and_b32 v23, 15, v0
  v_lshrrev_b32 v54, 4, v0
  v_mul_u32_u24 v54, 2048, v54
  v_lshl_add_u32 v54, v23, 4, v54
  s_add_u32 s72, s96, 2621440
  s_add_u32 s35, s72, 8192
  buffer_load_dwordx4 v[12:15], v54, s[20:23], s72 offen sc1
  buffer_load_dwordx4 v[16:19], v54, s[20:23], s35 offen sc1
  v_and_b32 v32, 15, v0
  v_lshrrev_b32 v33, 4, v0
  v_and_b32 v34, 1, v33
  v_lshlrev_b32 v34, 1, v34
  v_lshrrev_b32 v28, 1, v33
  v_or_b32 v34, v34, v28
  v_lshl_add_u32 v34, v32, 2, v34
  v_lshl_add_u32 v34, v34, 1, s57
  v_lshl_add_u32 v29, v0, 2, s38
  ds_read_b32 v20, v29 offset:1024
  v_and_b32 v30, 1, v0
  v_lshrrev_b32 v31, 4, v0
  v_lshlrev_b32 v31, 5, v31
  v_lshl_add_u32 v30, v30, 4, v31
  v_add_u32 v30, 158048, v30
  v_mov_b32 v35, 0x3c75e03e
  v_mov_b32 v32, 0x3e13985d
  v_mov_b32 v33, 0x3a71d1e6
  s_waitcnt vmcnt(8)
  buffer_load_dwordx4 v[192:195], v2, s[16:19], s61 offen offset:512 nt
  s_waitcnt vmcnt(8)
  s_xor_b32 s61, s48, 11
  s_mul_i32 s61, s61, 3072
  s_add_u32 s61, s61, 50331648
  buffer_load_dwordx4 v[196:199], v2, s[16:19], s61 offen offset:0 nt
  s_waitcnt vmcnt(8)
  buffer_load_dwordx4 v[200:203], v2, s[16:19], s61 offen offset:256 nt
  s_waitcnt vmcnt(8)
  buffer_load_dwordx4 v[204:207], v2, s[16:19], s61 offen offset:512 nt
  s_waitcnt vmcnt(8)
  s_xor_b32 s61, s48, 12
  s_mul_i32 s61, s61, 3072
  s_add_u32 s61, s61, 50331648
  buffer_load_dwordx4 v[208:211], v2, s[16:19], s61 offen offset:0 nt
  s_waitcnt vmcnt(8)
  buffer_load_dwordx4 v[212:215], v2, s[16:19], s61 offen offset:256 nt
  s_waitcnt vmcnt(8)
  buffer_load_dwordx4 v[216:219], v2, s[16:19], s61 offen offset:512 nt
  s_waitcnt vmcnt(8)
  s_xor_b32 s61, s48, 13
  s_mul_i32 s61, s61, 3072
  s_add_u32 s61, s61, 50331648
  buffer_load_dwordx4 v[220:223], v2, s[16:19], s61 offen offset:0 nt
  s_waitcnt vmcnt(8)
  buffer_load_dwordx4 v[224:227], v2, s[16:19], s61 offen offset:256 nt
Lc56:
  v_max3_u32 v28, v12, v13, v14
  v_max3_u32 v28, v28, v15, v16
  v_max3_u32 v28, v28, v17, v18
  v_max_u32 v28, v28, v19
  v_cmp_eq_u32 vcc, -1, v28
  s_cbranch_vccnz Lr57
  v_pk_add_f32 v[12:13], v[12:13], v[16:17]
  v_pk_add_f32 v[14:15], v[14:15], v[18:19]
  s_nop 0
  v_permlane32_swap_b32 v12, v13
  v_permlane32_swap_b32 v14, v15
  v_add_f32 v12, v12, v13
  v_add_f32 v14, v14, v15
  s_nop 1
  v_permlane16_swap_b32 v12, v14
  v_add_f32 v12, v12, v14
  s_nop 0
  v_readlane_b32 s63, v12, 12
  v_readlane_b32 s64, v12, 44
  s_mov_b32 exec_lo, 0x0fff0fff
  s_mov_b32 exec_hi, 0x0fff0fff
  v_mul_f32 v15, s64, v35
  v_fma_f32 v14, s63, v32, v33
  v_fma_f32 v14, -v15, v15, v14
  v_max_f32 v14, v33, v14
  v_rsq_f32 v14, v14
  s_waitcnt lgkmcnt(0)
  v_fma_f32 v12, -v15, v20, v12
  v_mul_f32 v12, v12, v14
  v_cvt_pk_bf16_f32 v12, v12, v12
  ds_write_b16 v34, v12 offset:384
  s_mov_b64 exec, -1
  s_waitcnt lgkmcnt(0)
  s_barrier
L_pf3:
  ds_read_b128 v[12:15], v30 offset:0
  buffer_load_dwordx4 v[228:231], v2, s[16:19], s61 offen offset:512 nt
  ds_read_b128 v[16:19], v30 offset:128
  ds_read_b128 v[20:23], v30 offset:256
  v_and_b32 v50, 15, v0
  v_lshlrev_b32 v50, 5, v50
  v_and_b32 v51, 16, v0
  v_add3_u32 v50, v50, v51, s39
  v_mov_b32 v51, s54
  v_bfe_u32 v8, v0, 1, 3
  v_lshrrev_b32 v9, 4, v0
  v_and_b32 v7, 1, v0
  s_waitcnt lgkmcnt(2)
  v_mfma_f32_16x16x32_bf16 v[24:27], a[72:75], v[12:15], 0
  v_lshl_add_u32 v7, v9, 1, v7
  v_lshlrev_b32 v7, 4, v7
  s_waitcnt lgkmcnt(1)
  v_mfma_f32_16x16x32_bf16 v[24:27], a[76:79], v[16:19], v[24:27]
  s_movk_i32 s63, 384
  v_mad_u32_u24 v7, v8, s63, v7
  s_waitcnt lgkmcnt(0)
  v_mfma_f32_16x16x32_bf16 v[24:27], a[80:83], v[20:23], v[24:27]
  v_lshl_add_u32 v8, v9, 1, v8
  v_and_b32 v8, 7, v8
  v_mfma_f32_16x16x32_bf16 v[28:31], a[84:87], v[12:15], 0
  s_xor_b32 s61, s48, 14
  s_mul_i32 s61, s61, 3072
  s_add_u32 s61, s61, 50331648
  buffer_load_dwordx4 v[232:235], v2, s[16:19], s61 offen offset:0 nt
  v_mul_u32_u24 v8, 16, v8
  s_add_u32 s76, s69, 655360
  v_mfma_f32_16x16x32_bf16 v[28:31], a[88:91], v[16:19], v[28:31]
  v_mov_b32 v9, 153600
  v_lshl_add_u32 v10, v0, 2, s55
  v_mfma_f32_16x16x32_bf16 v[28:31], a[92:95], v[20:23], v[28:31]
  v_lshl_add_u32 v11, v0, 1, s44
  s_add_u32 s73, s68, 655360
  v_mfma_f32_16x16x32_bf16 v[32:35], a[96:99], v[12:15], 0
  v_mfma_f32_16x16x32_bf16 v[32:35], a[100:103], v[16:19], v[32:35]
  v_add_f32_dpp v36, v24, v25 quad_perm:[0,0,2,2] row_mask:0xf bank_mask:0x1
  v_mfma_f32_16x16x32_bf16 v[32:35], a[104:107], v[20:23], v[32:35]
  s_nop 0
  v_add_f32_dpp v36, v26, v27 quad_perm:[0,0,2,2] row_mask:0xf bank_mask:0x4
  v_mfma_f32_16x16x32_bf16 v[24:27], a[108:111], v[12:15], 0
  v_mfma_f32_16x16x32_bf16 v[24:27], a[112:115], v[16:19], v[24:27]
  v_add_f32_dpp v36, v28, v29 quad_perm:[0,0,2,2] row_mask:0xf bank_mask:0x2
  v_mfma_f32_16x16x32_bf16 v[24:27], a[116:119], v[20:23], v[24:27]
  s_waitcnt vmcnt(8)
  buffer_load_dwordx4 v[236:239], v2, s[16:19], s61 offen offset:256 nt
  v_add_f32_dpp v36, v30, v31 quad_perm:[0,0,2,2] row_mask:0xf bank_mask:0x8
  v_mfma_f32_16x16x32_bf16 v[28:31], a[120:123], v[12:15], 0
  s_nop 0
  v_mov_b32_dpp v36, v36 quad_perm:[1,1,3,3] row_mask:0xf bank_mask:0xf
  v_mfma_f32_16x16x32_bf16 v[28:31], a[124:127], v[16:19], v[28:31]
  v_add_f32_dpp v37, v32, v33 quad_perm:[0,0,2,2] row_mask:0xf bank_mask:0x1
  v_mfma_f32_16x16x32_bf16 v[28:31], a[128:131], v[20:23], v[28:31]
  s_nop 0
  v_add_f32_dpp v37, v34, v35 quad_perm:[0,0,2,2] row_mask:0xf bank_mask:0x4
  v_mfma_f32_16x16x32_bf16 v[32:35], a[132:135], v[12:15], 0
  v_mfma_f32_16x16x32_bf16 v[32:35], a[136:139], v[16:19], v[32:35]
  v_add_f32_dpp v37, v24, v25 quad_perm:[0,0,2,2] row_mask:0xf bank_mask:0x2
  v_mfma_f32_16x16x32_bf16 v[32:35], a[140:143], v[20:23], v[32:35]
  s_nop 0
  v_add_f32_dpp v37, v26, v27 quad_perm:[0,0,2,2] row_mask:0xf bank_mask:0x8
  v_mfma_f32_16x16x32_bf16 v[24:27], a[144:147], v[12:15], 0
  s_nop 0
  v_mov_b32_dpp v37, v37 quad_perm:[1,1,3,3] row_mask:0xf bank_mask:0xf
  v_mfma_f32_16x16x32_bf16 v[24:27], a[148:151], v[16:19], v[24:27]
  v_add_f32_dpp v38, v28, v29 quad_perm:[0,0,2,2] row_mask:0xf bank_mask:0x1
  v_mfma_f32_16x16x32_bf16 v[24:27], a[152:155], v[20:23], v[24:27]
  s_nop 0
  v_add_f32_dpp v38, v30, v31 quad_perm:[0,0,2,2] row_mask:0xf bank_mask:0x4
  v_mfma_f32_16x16x32_bf16 v[28:31], a[156:159], v[12:15], 0
  v_mfma_f32_16x16x32_bf16 v[28:31], a[160:163], v[16:19], v[28:31]
  v_add_f32_dpp v38, v32, v33 quad_perm:[0,0,2,2] row_mask:0xf bank_mask:0x2
  v_mfma_f32_16x16x32_bf16 v[28:31], a[164:167], v[20:23], v[28:31]
  s_waitcnt vmcnt(8)
  buffer_load_dwordx4 v[240:243], v2, s[16:19], s61 offen offset:512 nt
  v_add_f32_dpp v38, v34, v35 quad_perm:[0,0,2,2] row_mask:0xf bank_mask:0x8
  v_mfma_f32_16x16x32_bf16 v[32:35], a[168:171], v[12:15], 0
  s_nop 0
  v_mov_b32_dpp v38, v38 quad_perm:[1,1,3,3] row_mask:0xf bank_mask:0xf
  v_mfma_f32_16x16x32_bf16 v[32:35], a[172:175], v[16:19], v[32:35]
  v_add_f32_dpp v39, v24, v25 quad_perm:[0,0,2,2] row_mask:0xf bank_mask:0x1
  v_mfma_f32_16x16x32_bf16 v[32:35], a[176:179], v[20:23], v[32:35]
  s_nop 0
  v_add_f32_dpp v39, v26, v27 quad_perm:[0,0,2,2] row_mask:0xf bank_mask:0x4
  v_mfma_f32_16x16x32_bf16 v[24:27], a[180:183], v[12:15], 0
  v_mfma_f32_16x16x32_bf16 v[24:27], a[184:187], v[16:19], v[24:27]
  v_add_f32_dpp v39, v28, v29 quad_perm:[0,0,2,2] row_mask:0xf bank_mask:0x2
  v_mfma_f32_16x16x32_bf16 v[24:27], a[188:191], v[20:23], v[24:27]
  s_nop 0
  v_add_f32_dpp v39, v30, v31 quad_perm:[0,0,2,2] row_mask:0xf bank_mask:0x8
  v_mfma_f32_16x16x32_bf16 v[28:31], a[192:195], v[12:15], 0
  s_nop 0
  v_mov_b32_dpp v39, v39 quad_perm:[1,1,3,3] row_mask:0xf bank_mask:0xf
  v_mfma_f32_16x16x32_bf16 v[28:31], a[196:199], v[16:19], v[28:31]
  v_add_f32_dpp v40, v32, v33 quad_perm:[0,0,2,2] row_mask:0xf bank_mask:0x1
  v_mfma_f32_16x16x32_bf16 v[28:31], a[200:203], v[20:23], v[28:31]
  s_nop 0
  v_add_f32_dpp v40, v34, v35 quad_perm:[0,0,2,2] row_mask:0xf bank_mask:0x4
  v_mfma_f32_16x16x32_bf16 v[32:35], a[204:207], v[12:15], 0
  v_mfma_f32_16x16x32_bf16 v[32:35], a[208:211], v[16:19], v[32:35]
  v_add_f32_dpp v40, v24, v25 quad_perm:[0,0,2,2] row_mask:0xf bank_mask:0x2
  v_mfma_f32_16x16x32_bf16 v[32:35], a[212:215], v[20:23], v[32:35]
  s_waitcnt vmcnt(8)
  s_xor_b32 s61, s48, 15
  s_mul_i32 s61, s61, 3072
  s_add_u32 s61, s61, 50331648
  buffer_load_dwordx4 v[244:247], v2, s[16:19], s61 offen offset:0 nt
  v_add_f32_dpp v40, v26, v27 quad_perm:[0,0,2,2] row_mask:0xf bank_mask:0x8
  v_mfma_f32_16x16x32_bf16 v[24:27], a[216:219], v[12:15], 0
  s_nop 0
  v_mov_b32_dpp v40, v40 quad_perm:[1,1,3,3] row_mask:0xf bank_mask:0xf
  v_mfma_f32_16x16x32_bf16 v[24:27], a[220:223], v[16:19], v[24:27]
  v_add_f32_dpp v41, v28, v29 quad_perm:[0,0,2,2] row_mask:0xf bank_mask:0x1
  v_mfma_f32_16x16x32_bf16 v[24:27], a[224:227], v[20:23], v[24:27]
  s_nop 0
  v_add_f32_dpp v41, v30, v31 quad_perm:[0,0,2,2] row_mask:0xf bank_mask:0x4
  v_mfma_f32_16x16x32_bf16 v[28:31], a[228:231], v[12:15], 0
  v_mfma_f32_16x16x32_bf16 v[28:31], a[232:235], v[16:19], v[28:31]
  v_add_f32_dpp v41, v32, v33 quad_perm:[0,0,2,2] row_mask:0xf bank_mask:0x2
  v_mfma_f32_16x16x32_bf16 v[28:31], a[236:239], v[20:23], v[28:31]
  s_nop 0
  v_add_f32_dpp v41, v34, v35 quad_perm:[0,0,2,2] row_mask:0xf bank_mask:0x8
  v_mfma_f32_16x16x32_bf16 v[32:35], a[240:243], v[12:15], 0
  s_nop 0
  v_mov_b32_dpp v41, v41 quad_perm:[1,1,3,3] row_mask:0xf bank_mask:0xf
  v_mfma_f32_16x16x32_bf16 v[32:35], a[244:247], v[16:19], v[32:35]
  v_add_f32_dpp v42, v24, v25 quad_perm:[0,0,2,2] row_mask:0xf bank_mask:0x1
  v_mfma_f32_16x16x32_bf16 v[32:35], a[248:251], v[20:23], v[32:35]
  s_nop 0
  v_add_f32_dpp v42, v26, v27 quad_perm:[0,0,2,2] row_mask:0xf bank_mask:0x4
  v_mfma_f32_16x16x32_bf16 v[24:27], a[252:255], v[12:15], 0
  v_mfma_f32_16x16x32_bf16 v[24:27], v[56:59], v[16:19], v[24:27]
  v_add_f32_dpp v42, v28, v29 quad_perm:[0,0,2,2] row_mask:0xf bank_mask:0x2
  v_mfma_f32_16x16x32_bf16 v[24:27], v[60:63], v[20:23], v[24:27]
  s_waitcnt vmcnt(8)
  buffer_load_dwordx4 v[248:251], v2, s[16:19], s61 offen offset:256 nt
  v_add_f32_dpp v42, v30, v31 quad_perm:[0,0,2,2] row_mask:0xf bank_mask:0x8
  v_add_f32_dpp v43, v32, v33 quad_perm:[0,0,2,2] row_mask:0xf bank_mask:0x1
  s_nop 1
  v_add_f32_dpp v43, v34, v35 quad_perm:[0,0,2,2] row_mask:0xf bank_mask:0x4
  s_nop 1
  v_add_f32_dpp v43, v24, v25 quad_perm:[0,0,2,2] row_mask:0xf bank_mask:0x2
  v_max3_f32 v52, v36, v37, v38
  v_max3_f32 v52, v52, v39, v40
  v_add_f32_dpp v43, v26, v27 quad_perm:[0,0,2,2] row_mask:0xf bank_mask:0x8
  v_max3_f32 v52, v52, v41, v42
  v_max_f32 v52, v52, v43
  v_mov_b32_dpp v42, v42 quad_perm:[1,1,3,3] row_mask:0xf bank_mask:0xf
  v_mov_b32_dpp v43, v43 quad_perm:[1,1,3,3] row_mask:0xf bank_mask:0xf
  v_max_f32_dpp v52, v52, v52 row_ror:8 row_mask:0xf bank_mask:0xf
  s_nop 1
  v_max_f32_dpp v52, v52, v52 row_ror:4 row_mask:0xf bank_mask:0xf
  s_nop 1
  v_max_f32_dpp v52, v52, v52 row_bcast:15 row_mask:0xa bank_mask:0xf
  s_nop 1
  v_max_f32_dpp v52, v52, v52 row_bcast:31 row_mask:0xc bank_mask:0xf
  s_nop 0
  v_readlane_b32 s34, v52, 63
  s_nop 1
  v_subrev_f32 v36, s34, v36
  v_exp_f32 v36, v36
  v_subrev_f32 v37, s34, v37
  v_mov_b32 v53, v36
  v_cvt_pk_bf16_f32 v36, v36, v36
  v_exp_f32 v37, v37
  v_and_b32 v12, v36, v3
  v_and_b32 v13, v36, v4
  v_and_b32_dpp v14, v36, v5 row_shr:4 row_mask:0xf bank_mask:0xf bound_ctrl:0
  v_and_b32_dpp v15, v36, v6 row_shr:4 row_mask:0xf bank_mask:0xf bound_ctrl:0
  v_mov_b32 v52, s34
  ds_write_b32 v51, v52
  v_mfma_f32_16x16x32_bf16 v[24:27], v[12:15], v[64:67], 0
  v_and_b32 v18, v36, v5
  v_and_b32 v19, v36, v6
  v_mfma_f32_16x16x32_bf16 v[28:31], v[12:15], v[68:71], 0
  v_and_b32_dpp v16, v36, v3 row_shl:4 row_mask:0xf bank_mask:0xf bound_ctrl:0
  v_and_b32_dpp v17, v36, v4 row_shl:4 row_mask:0xf bank_mask:0xf bound_ctrl:0
  v_mfma_f32_16x16x32_bf16 v[32:35], v[12:15], v[72:75], 0
  v_add_f32 v53, v53, v37
  v_cvt_pk_bf16_f32 v37, v37, v37
  s_branch Lpg3
.p2align 12
Lst3:
  s_setpc_b64 s[78:79]
Lpg3:
  v_mfma_f32_16x16x32_bf16 v[24:27], v[16:19], v[76:79], v[24:27]
  v_and_b32 v12, v37, v3
  v_and_b32 v13, v37, v4
  v_mfma_f32_16x16x32_bf16 v[28:31], v[16:19], v[80:83], v[28:31]
  v_and_b32_dpp v14, v37, v5 row_shr:4 row_mask:0xf bank_mask:0xf bound_ctrl:0
  v_and_b32_dpp v15, v37, v6 row_shr:4 row_mask:0xf bank_mask:0xf bound_ctrl:0
  v_mfma_f32_16x16x32_bf16 v[32:35], v[16:19], v[84:87], v[32:35]
  v_subrev_f32 v38, s34, v38
  v_exp_f32 v38, v38
  v_mfma_f32_16x16x32_bf16 v[24:27], v[12:15], v[88:91], v[24:27]
  buffer_load_dwordx4 v[252:255], v2, s[16:19], s61 offen offset:512 nt
  v_and_b32 v18, v37, v5
  v_and_b32 v19, v37, v6
  v_mfma_f32_16x16x32_bf16 v[28:31], v[12:15], v[92:95], v[28:31]
  v_and_b32_dpp v16, v37, v3 row_shl:4 row_mask:0xf bank_mask:0xf bound_ctrl:0
  v_and_b32_dpp v17, v37, v4 row_shl:4 row_mask:0xf bank_mask:0xf bound_ctrl:0
  v_mfma_f32_16x16x32_bf16 v[32:35], v[12:15], v[96:99], v[32:35]
  v_add_f32 v53, v53, v38
  v_cvt_pk_bf16_f32 v38, v38, v38
  v_mfma_f32_16x16x32_bf16 v[24:27], v[16:19], v[100:103], v[24:27]
  v_and_b32 v12, v38, v3
  v_and_b32 v13, v38, v4
  v_mfma_f32_16x16x32_bf16 v[28:31], v[16:19], v[104:107], v[28:31]
  v_and_b32_dpp v14, v38, v5 row_shr:4 row_mask:0xf bank_mask:0xf bound_ctrl:0
  v_and_b32_dpp v15, v38, v6 row_shr:4 row_mask:0xf bank_mask:0xf bound_ctrl:0
  v_mfma_f32_16x16x32_bf16 v[32:35], v[16:19], v[108:111], v[32:35]
  v_subrev_f32 v39, s34, v39
  v_exp_f32 v39, v39
  v_mfma_f32_16x16x32_bf16 v[24:27], v[12:15], v[112:115], v[24:27]
  v_and_b32 v18, v38, v5
  v_and_b32 v19, v38, v6
  v_mfma_f32_16x16x32_bf16 v[28:31], v[12:15], v[116:119], v[28:31]
  v_and_b32_dpp v16, v38, v3 row_shl:4 row_mask:0xf bank_mask:0xf bound_ctrl:0
  v_and_b32_dpp v17, v38, v4 row_shl:4 row_mask:0xf bank_mask:0xf bound_ctrl:0
  v_mfma_f32_16x16x32_bf16 v[32:35], v[12:15], v[120:123], v[32:35]
  v_add_f32 v53, v53, v39
  v_cvt_pk_bf16_f32 v39, v39, v39
  v_mfma_f32_16x16x32_bf16 v[24:27], v[16:19], v[124:127], v[24:27]
  v_and_b32 v12, v39, v3
  v_and_b32 v13, v39, v4
  v_mfma_f32_16x16x32_bf16 v[28:31], v[16:19], v[128:131], v[28:31]
  v_and_b32_dpp v14, v39, v5 row_shr:4 row_mask:0xf bank_mask:0xf bound_ctrl:0
  v_and_b32_dpp v15, v39, v6 row_shr:4 row_mask:0xf bank_mask:0xf bound_ctrl:0
  v_mfma_f32_16x16x32_bf16 v[32:35], v[16:19], v[132:135], v[32:35]
  v_subrev_f32 v40, s34, v40
  v_exp_f32 v40, v40
  v_mfma_f32_16x16x32_bf16 v[24:27], v[12:15], v[136:139], v[24:27]
  v_and_b32 v18, v39, v5
  v_and_b32 v19, v39, v6
  v_mfma_f32_16x16x32_bf16 v[28:31], v[12:15], v[140:143], v[28:31]
  v_and_b32_dpp v16, v39, v3 row_shl:4 row_mask:0xf bank_mask:0xf bound_ctrl:0
  v_and_b32_dpp v17, v39, v4 row_shl:4 row_mask:0xf bank_mask:0xf bound_ctrl:0
  v_mfma_f32_16x16x32_bf16 v[32:35], v[12:15], v[144:147], v[32:35]
  v_add_f32 v53, v53, v40
  v_cvt_pk_bf16_f32 v40, v40, v40
  v_mfma_f32_16x16x32_bf16 v[24:27], v[16:19], v[148:151], v[24:27]
  v_and_b32 v12, v40, v3
  v_and_b32 v13, v40, v4
  v_mfma_f32_16x16x32_bf16 v[28:31], v[16:19], v[152:155], v[28:31]
  v_and_b32_dpp v14, v40, v5 row_shr:4 row_mask:0xf bank_mask:0xf bound_ctrl:0
  v_and_b32_dpp v15, v40, v6 row_shr:4 row_mask:0xf bank_mask:0xf bound_ctrl:0
  v_mfma_f32_16x16x32_bf16 v[32:35], v[16:19], v[156:159], v[32:35]
  v_subrev_f32 v41, s34, v41
  v_exp_f32 v41, v41
  v_mfma_f32_16x16x32_bf16 v[24:27], v[12:15], v[160:163], v[24:27]
  v_and_b32 v18, v40, v5
  v_and_b32 v19, v40, v6
  v_mfma_f32_16x16x32_bf16 v[28:31], v[12:15], v[164:167], v[28:31]
  v_and_b32_dpp v16, v40, v3 row_shl:4 row_mask:0xf bank_mask:0xf bound_ctrl:0
  v_and_b32_dpp v17, v40, v4 row_shl:4 row_mask:0xf bank_mask:0xf bound_ctrl:0
  v_mfma_f32_16x16x32_bf16 v[32:35], v[12:15], v[168:171], v[32:35]
  v_add_f32 v53, v53, v41
  v_cvt_pk_bf16_f32 v41, v41, v41
  v_mfma_f32_16x16x32_bf16 v[24:27], v[16:19], v[172:175], v[24:27]
  v_and_b32 v12, v41, v3
  v_and_b32 v13, v41, v4
  v_mfma_f32_16x16x32_bf16 v[28:31], v[16:19], v[176:179], v[28:31]
  v_and_b32_dpp v14, v41, v5 row_shr:4 row_mask:0xf bank_mask:0xf bound_ctrl:0
  v_and_b32_dpp v15, v41, v6 row_shr:4 row_mask:0xf bank_mask:0xf bound_ctrl:0
  v_mfma_f32_16x16x32_bf16 v[32:35], v[16:19], v[180:183], v[32:35]
  v_subrev_f32 v42, s34, v42
  v_exp_f32 v42, v42
  v_mfma_f32_16x16x32_bf16 v[24:27], v[12:15], v[184:187], v[24:27]
  v_and_b32 v18, v41, v5
  v_and_b32 v19, v41, v6
  v_mfma_f32_16x16x32_bf16 v[28:31], v[12:15], v[188:191], v[28:31]
  v_and_b32_dpp v16, v41, v3 row_shl:4 row_mask:0xf bank_mask:0xf bound_ctrl:0
  v_and_b32_dpp v17, v41, v4 row_shl:4 row_mask:0xf bank_mask:0xf bound_ctrl:0
  v_mfma_f32_16x16x32_bf16 v[32:35], v[12:15], v[192:195], v[32:35]
  v_add_f32 v53, v53, v42
  v_cvt_pk_bf16_f32 v42, v42, v42
  v_mfma_f32_16x16x32_bf16 v[24:27], v[16:19], v[196:199], v[24:27]
  v_and_b32 v12, v42, v3
  v_and_b32 v13, v42, v4
  v_mfma_f32_16x16x32_bf16 v[28:31], v[16:19], v[200:203], v[28:31]
  v_and_b32_dpp v14, v42, v5 row_shr:4 row_mask:0xf bank_mask:0xf bound_ctrl:0
  v_and_b32_dpp v15, v42, v6 row_shr:4 row_mask:0xf bank_mask:0xf bound_ctrl:0
  v_mfma_f32_16x16x32_bf16 v[32:35], v[16:19], v[204:207], v[32:35]
  v_subrev_f32 v43, s34, v43
  v_exp_f32 v43, v43
  v_mfma_f32_16x16x32_bf16 v[24:27], v[12:15], v[208:211], v[24:27]
  v_and_b32 v18, v42, v5
  v_and_b32 v19, v42, v6
  v_mfma_f32_16x16x32_bf16 v[28:31], v[12:15], v[212:215], v[28:31]
  v_and_b32_dpp v16, v42, v3 row_shl:4 row_mask:0xf bank_mask:0xf bound_ctrl:0
  v_and_b32_dpp v17, v42, v4 row_shl:4 row_mask:0xf bank_mask:0xf bound_ctrl:0
  s_waitcnt vmcnt(9)
  v_mfma_f32_16x16x32_bf16 v[32:35], v[12:15], v[216:219], v[32:35]
  v_add_f32 v53, v53, v43
  v_cvt_pk_bf16_f32 v43, v43, v43
  s_waitcnt vmcnt(8)
  v_mfma_f32_16x16x32_bf16 v[24:27], v[16:19], v[220:223], v[24:27]
  v_and_b32 v12, v43, v3
  v_and_b32 v13, v43, v4
  s_waitcnt vmcnt(7)
  v_mfma_f32_16x16x32_bf16 v[28:31], v[16:19], v[224:227], v[28:31]
  v_and_b32_dpp v14, v43, v5 row_shr:4 row_mask:0xf bank_mask:0xf bound_ctrl:0
  v_and_b32_dpp v15, v43, v6 row_shr:4 row_mask:0xf bank_mask:0xf bound_ctrl:0
  s_waitcnt vmcnt(6)
  v_mfma_f32_16x16x32_bf16 v[32:35], v[16:19], v[228:231], v[32:35]
  s_waitcnt vmcnt(5)
  v_mfma_f32_16x16x32_bf16 v[24:27], v[12:15], v[232:235], v[24:27]
  v_and_b32 v18, v43, v5
  v_and_b32 v19, v43, v6
  v_add_f32_dpp v53, v53, v53 row_ror:8 row_mask:0xf bank_mask:0xf
  s_waitcnt vmcnt(4)
  v_mfma_f32_16x16x32_bf16 v[28:31], v[12:15], v[236:239], v[28:31]
  v_and_b32_dpp v16, v43, v3 row_shl:4 row_mask:0xf bank_mask:0xf bound_ctrl:0
  v_and_b32_dpp v17, v43, v4 row_shl:4 row_mask:0xf bank_mask:0xf bound_ctrl:0
  v_add_f32_dpp v53, v53, v53 row_ror:4 row_mask:0xf bank_mask:0xf
  s_waitcnt vmcnt(3)
  v_mfma_f32_16x16x32_bf16 v[32:35], v[12:15], v[240:243], v[32:35]
  v_add_f32_dpp v53, v53, v53 row_bcast:15 row_mask:0xa bank_mask:0xf
  s_waitcnt vmcnt(2)
  v_mfma_f32_16x16x32_bf16 v[24:27], v[16:19], v[244:247], v[24:27]
  v_add_f32_dpp v53, v53, v53 row_bcast:31 row_mask:0xc bank_mask:0xf
  s_waitcnt vmcnt(1)
  v_mfma_f32_16x16x32_bf16 v[28:31], v[16:19], v[248:251], v[28:31]
  s_mov_b64 exec, s[36:37]
  ds_write_b32 v51, v53 offset:16
  s_mov_b64 exec, -1
  s_waitcnt vmcnt(0)
  v_mfma_f32_16x16x32_bf16 v[32:35], v[16:19], v[252:255], v[32:35]
  s_mov_b32 exec_lo, 0xffffffff
  s_mov_b32 exec_hi, 0x0
  ds_write_b128 v50, v[24:27] offset:0
  s_mov_b32 exec_lo, 0xff00ff
  s_mov_b32 exec_hi, 0xff00ff00
  ds_write_b128 v50, v[28:31] offset:512
  s_mov_b32 exec_lo, 0x0
  s_mov_b32 exec_hi, 0xffffffff
  ds_write_b128 v50, v[32:35] offset:1024
  s_mov_b64 exec, -1
  s_waitcnt lgkmcnt(0)
  s_barrier
  ds_read_b128 v[44:47], v9
  ds_read_b128 v[48:51], v9 offset:16
  ds_read2st64_b32 v[12:13], v10 offset0:0 offset1:3
  ds_read2st64_b32 v[14:15], v10 offset0:6 offset1:9
  ds_read2st64_b32 v[16:17], v10 offset0:12 offset1:15
  ds_read2st64_b32 v[18:19], v10 offset0:18 offset1:21
  s_waitcnt lgkmcnt(5)
  v_max3_f32 v52, v44, v45, v46
  v_max_f32 v52, v52, v47
  v_sub_f32 v44, v44, v52
  v_sub_f32 v45, v45, v52
  v_sub_f32 v46, v46, v52
  v_sub_f32 v47, v47, v52
  v_exp_f32 v44, v44
  v_exp_f32 v45, v45
  v_exp_f32 v46, v46
  v_exp_f32 v47, v47
  s_waitcnt lgkmcnt(3)
  v_add_f32 v12, v12, v13
  s_waitcnt lgkmcnt(2)
  v_add_f32 v14, v14, v15
  s_waitcnt lgkmcnt(1)
  v_add_f32 v16, v16, v17
  s_waitcnt lgkmcnt(0)
  v_add_f32 v18, v18, v19
  v_mul_f32 v20, v44, v12
  v_fmac_f32 v20, v45, v14
  v_fmac_f32 v20, v46, v16
  v_fmac_f32 v20, v47, v18
  v_mul_f32 v53, v44, v48
  v_fmac_f32 v53, v45, v49
  v_mov_b32_dpp v21, v20 quad_perm:[1,1,3,3] row_mask:0xf bank_mask:0xf
  v_fmac_f32 v53, v46, v50
  v_fmac_f32 v53, v47, v51
  v_cvt_pk_bf16_f32 v20, v20, v21
  v_cndmask_b32 v52, v52, v53, s[100:101]
  v_cndmask_b32 v20, v20, v52, s[42:43]
  v_min_u32 v20, -2, v20
  s_mov_b64 exec, s[46:47]
  s_cmp_lg_u32 s60, 0
  s_cbranch_scc0 Le58
  buffer_store_dword v20, v11, s[20:23], s73 offen
Lf59:
  s_mov_b64 exec, -1
  s_cmp_eq_u32 s3, 3
  s_cbranch_scc1 Ls60
  v_bfe_u32 v10, v0, 2, 2
  v_and_b32 v11, 48, v0
  v_add_u32 v10, v10, v11
  v_mul_u32_u24 v10, 160, v10
  v_and_b32 v11, 3, v0
  v_lshl_add_u32 v10, v11, 3, v10
  s_add_u32 s64, s95, 92160
  v_add_u32 v10, s64, v10
  ds_read_b64_tr_b16 v[24:25], v10 offset:0
  ds_read_b64_tr_b16 v[26:27], v10 offset:640
  ds_read_b64_tr_b16 v[28:29], v10 offset:1280
  ds_read_b64_tr_b16 v[30:31], v10 offset:1920
  ds_read_b64_tr_b16 v[32:33], v10 offset:10240
  ds_read_b64_tr_b16 v[34:35], v10 offset:10880
  ds_read_b64_tr_b16 v[36:37], v10 offset:11520
  ds_read_b64_tr_b16 v[38:39], v10 offset:12160
  ds_read_b64_tr_b16 v[40:41], v10 offset:20480
  ds_read_b64_tr_b16 v[42:43], v10 offset:21120
  ds_read_b64_tr_b16 v[44:45], v10 offset:21760
  ds_read_b64_tr_b16 v[46:47], v10 offset:22400
  v_and_b32 v11, 15, v0
  v_lshlrev_b32 v11, 1, v11
  v_and_b32 v9, 32, v0
  v_add3_u32 v11, v11, v9, s95
  s_add_u32 s73, s70, 245760
  buffer_load_dwordx2 v[52:53], v8, s[20:23], s76 offen offset:3072 sc1
  buffer_load_dwordx4 v[12:15], v7, s[20:23], s76 offen offset:0 sc1
  buffer_load_dwordx4 v[16:19], v7, s[20:23], s76 offen offset:128 sc1
  buffer_load_dwordx4 v[20:23], v7, s[20:23], s76 offen offset:256 sc1
  s_waitcnt vmcnt(0)
Lc61:
  s_waitcnt lgkmcnt(10)
  v_mfma_f32_16x16x32_bf16 v[48:51], v[12:15], v[24:27], 0
  v_max3_u32 v9, v52, v53, v12
  v_max3_u32 v9, v9, v13, v14
  v_max3_u32 v9, v9, v15, v16
  s_waitcnt lgkmcnt(6)
  v_mfma_f32_16x16x32_bf16 v[48:51], v[16:19], v[32:35], v[48:51]
  v_max3_u32 v9, v9, v17, v18
  v_max3_u32 v9, v9, v19, v20
  v_max3_u32 v9, v9, v21, v22
  s_waitcnt lgkmcnt(2)
  v_mfma_f32_16x16x32_bf16 v[48:51], v[20:23], v[40:43], v[48:51]
  v_max_u32 v9, v9, v23
  v_cmp_eq_u32 vcc, -1, v9
  s_cbranch_vccnz Lr62
  v_max_f32_dpp v9, v52, v52 row_ror:8 row_mask:0xf bank_mask:0xf
  v_mfma_f32_16x16x32_bf16 v[24:27], v[12:15], v[28:31], 0
  ds_read_b64_tr_b16 v[32:33], v10 offset:32
  ds_read_b64_tr_b16 v[34:35], v10 offset:672
  v_max_f32_dpp v9, v9, v9 row_ror:4 row_mask:0xf bank_mask:0xf
  v_mfma_f32_16x16x32_bf16 v[24:27], v[16:19], v[36:39], v[24:27]
  ds_read_b64_tr_b16 v[40:41], v10 offset:10272
  ds_read_b64_tr_b16 v[42:43], v10 offset:10912
  v_max_f32_dpp v9, v9, v9 row_ror:2 row_mask:0xf bank_mask:0xf
  s_waitcnt lgkmcnt(4)
  v_mfma_f32_16x16x32_bf16 v[24:27], v[20:23], v[44:47], v[24:27]
  v_sub_f32 v52, v52, v9
  v_exp_f32 v52, v52
  ds_read_b64_tr_b16 v[28:29], v10 offset:20512
  ds_read_b64_tr_b16 v[30:31], v10 offset:21152
  v_mul_f32 v53, v52, v53
  ds_read_b64_tr_b16 v[36:37], v10 offset:1312
  ds_read_b64_tr_b16 v[38:39], v10 offset:1952
  v_add_f32_dpp v53, v53, v53 row_ror:8 row_mask:0xf bank_mask:0xf
  ds_read_b64_tr_b16 v[44:45], v10 offset:11552
  ds_read_b64_tr_b16 v[46:47], v10 offset:12192
  v_add_f32_dpp v53, v53, v53 row_ror:4 row_mask:0xf bank_mask:0xf
  v_add_f32 v48, v48, v25
  v_add_f32 v50, v50, v27
  v_add_f32_dpp v53, v53, v53 row_ror:2 row_mask:0xf bank_mask:0xf
  v_mov_b32 v7, v48
  v_mov_b32 v8, v50
  v_rcp_f32 v53, v53
  s_waitcnt lgkmcnt(8)
  v_mfma_f32_16x16x32_bf16 v[48:51], v[12:15], v[32:35], 0
  ds_read_b64_tr_b16 v[32:33], v10 offset:21792
  ds_read_b64_tr_b16 v[34:35], v10 offset:22432
  v_mul_f32 v9, v52, v53
  s_waitcnt lgkmcnt(8)
  v_mfma_f32_16x16x32_bf16 v[48:51], v[16:19], v[40:43], v[48:51]
  s_waitcnt lgkmcnt(6)
  v_mfma_f32_16x16x32_bf16 v[48:51], v[20:23], v[28:31], v[48:51]
  v_mul_f32_dpp v52, v9, v7 row_newbcast:0 row_mask:0xf bank_mask:0xf
  s_waitcnt lgkmcnt(4)
  v_mfma_f32_16x16x32_bf16 v[24:27], v[12:15], v[36:39], 0
  v_mov_b32_dpp v7, v9 row_newbcast:0 row_mask:0xf bank_mask:0xf
  s_waitcnt lgkmcnt(2)
  v_mfma_f32_16x16x32_bf16 v[24:27], v[16:19], v[44:47], v[24:27]
  v_fmac_f32_dpp v52, v9, v8 row_newbcast:2 row_mask:0xf bank_mask:0xf
  s_waitcnt lgkmcnt(0)
  v_mfma_f32_16x16x32_bf16 v[24:27], v[20:23], v[32:35], v[24:27]
  v_mov_b32_dpp v8, v9 row_newbcast:2 row_mask:0xf bank_mask:0xf
  s_nop 6
  v_add_f32 v48, v48, v25
  v_add_f32 v50, v50, v27
  v_mul_f32 v53, v7, v48
  v_fmac_f32 v53, v8, v50
  s_nop 1
  v_permlane32_swap_b32 v52, v53
  v_add_f32 v52, v52, v53
  v_mov_b32 v53, v52
  s_nop 1
  v_permlane16_swap_b32 v52, v53
  v_add_f32 v52, v52, v53
  s_nop 1
  v_mov_b32_dpp v53, v52 quad_perm:[1,1,3,3] row_mask:0xf bank_mask:0xf
  v_cvt_pk_bf16_f32 v52, v52, v53
  v_min_u32 v52, -2, v52
  s_mov_b64 exec, s[80:81]
  buffer_store_dword v52, v11, s[20:23], s73 offen sc1
  s_mov_b64 exec, -1
Ls60:
  v_lshrrev_b32 v54, 4, v0
  v_mul_u32_u24 v54, 192, v54
  v_and_b32 v9, 15, v0
  v_lshl_add_u32 v54, v9, 4, v54
  s_waitcnt vmcnt(0)
  s_waitcnt lgkmcnt(0)
  s_barrier
  v_bfe_u32 v7, v0, 2, 2
  v_lshrrev_b32 v9, 4, v0
  v_lshl_add_u32 v8, v9, 3, v7
  v_lshl_add_u32 v7, v9, 2, v7
  v_and_b32 v9, 3, v0
  v_lshlrev_b32 v9, 3, v9
  s_mul_i32 s63, s3, 96
  s_add_u32 s63, s63, 0
  v_add_u32 v9, s63, v9
  s_movk_i32 s63, 384
  v_mad_u32_u24 v8, v8, s63, v9
  v_mad_u32_u24 v7, v7, s63, v9
  ds_read_b64_tr_b16 v[24:25], v8 offset:0
  ds_read_b64_tr_b16 v[26:27], v8 offset:1536
  ds_read_b64_tr_b16 v[28:29], v8 offset:12288
  ds_read_b64_tr_b16 v[30:31], v8 offset:13824
  ds_read_b64_tr_b16 v[32:33], v7 offset:24576
  ds_read_b64_tr_b16 v[34:35], v8 offset:32
  ds_read_b64_tr_b16 v[36:37], v8 offset:1568
  ds_read_b64_tr_b16 v[38:39], v8 offset:12320
  ds_read_b64_tr_b16 v[40:41], v8 offset:13856
  ds_read_b64_tr_b16 v[42:43], v7 offset:24608
  ds_read_b64_tr_b16 v[44:45], v8 offset:64
  ds_read_b64_tr_b16 v[46:47], v8 offset:1600
  ds_read_b64_tr_b16 v[48:49], v8 offset:12352
  ds_read_b64_tr_b16 v[50:51], v8 offset:13888
  ds_read_b64_tr_b16 v[52:53], v7 offset:24640
  s_mul_i32 s63, s3, 1536
  s_add_u32 s72, s71, s63
  s_add_u32 s72, s72, 245760
  s_add_u32 s35, s72, 768
  v_and_b32 v16, 0x3f803f80, v3
  v_and_b32 v17, 0x3f803f80, v4
  v_and_b32 v18, 0x3f803f80, v5
  v_and_b32 v19, 0x3f803f80, v6
  v_mov_b32 v8, 0
  v_mov_b32 v9, 0
  v_mov_b32 v10, 0
  v_mov_b32 v11, 0
  v_mov_b32 v12, 0
  v_mov_b32 v13, 0
  v_mov_b32 v14, 0
  v_mov_b32 v15, 0
  s_mov_b64 exec, s[32:33]
  buffer_load_dwordx4 v[8:11], v54, s[20:23], s72 offen sc1
  buffer_load_dwordx4 v[12:15], v54, s[20:23], s35 offen sc1
  s_mov_b64 exec, -1
  s_branch Lpg4
.p2align 12
Lst4:
  s_setpc_b64 s[78:79]
Lpg4:
  s_waitcnt vmcnt(0)
Lc63:
  v_mfma_f32_16x16x32_bf16 v[20:23], v[16:19], v[8:11], 0
  v_max3_u32 v7, v8, v9, v10
  v_max3_u32 v7, v7, v11, v12
  v_max3_u32 v7, v7, v13, v14
  v_mfma_f32_16x16x32_bf16 v[20:23], v[16:19], v[12:15], v[20:23]
  v_max_u32 v7, v7, v15
  v_cmp_eq_u32 vcc, -1, v7
  s_cbranch_vccnz Lr64
  v_and_b32 v7, 15, v0
  v_lshlrev_b32 v7, 5, v7
  v_and_b32 v54, 16, v0
  v_add3_u32 v7, v7, v54, s56
  s_mov_b32 exec_lo, s32
  s_mov_b32 exec_hi, 0
  ds_write_b128 v7, v[20:23] offset:1280
  s_mov_b64 exec, -1
  v_lshl_add_u32 v7, v0, 2, s45
  ds_read_b32 v54, v7 offset:640
  v_lshlrev_b32 v14, 3, v0
  v_add_u32 v14, 154944, v14
  v_mov_b32 v22, s45
  v_mov_b32 v23, 156864
  v_cndmask_b32 v23, v22, v23, s[74:75]
  v_lshrrev_b32 v21, 4, v0
  v_lshl_add_u32 v22, v21, 4, v23
  v_lshl_add_u32 v23, v21, 3, v23
  s_waitcnt lgkmcnt(0)
  s_barrier
  s_mov_b32 exec_hi, 0xff
  ds_read2_b64 v[8:11], v14 offset0:0 offset1:40
  ds_read2_b64 v[12:15], v14 offset0:80 offset1:120
  v_lshlrev_b32 v16, 16, v54
  v_and_b32 v17, 0xffff0000, v54
  s_waitcnt lgkmcnt(1)
  v_pk_add_f32 v[8:9], v[8:9], v[10:11]
  s_waitcnt lgkmcnt(0)
  v_pk_add_f32 v[12:13], v[12:13], v[14:15]
  v_pk_add_f32 v[8:9], v[8:9], v[12:13]
  v_cvt_pk_bf16_f32 v8, v8, v9
  v_and_b32 v9, 0xffff0000, v8
  v_lshlrev_b32 v8, 16, v8
  v_pk_add_f32 v[8:9], v[8:9], v[16:17]
  v_cvt_pk_bf16_f32 v8, v8, v9
  ds_write_b32 v7, v8 offset:640
  s_mov_b64 exec, -1
  ds_read_b128 v[12:15], v22 offset:640
  ds_read_b128 v[16:19], v22 offset:704
  ds_read_b64 v[20:21], v23 offset:768
  v_lshl_add_u32 v7, v0, 2, s55
  s_add_u32 s73, s66, 2998272
  v_and_b32 v23, 15, v0
  v_lshrrev_b32 v54, 4, v0
  v_mul_u32_u24 v54, 2048, v54
  v_lshl_add_u32 v54, v23, 4, v54
  s_add_u32 s72, s96, 3145728
  s_add_u32 s35, s72, 8192
  v_cndmask_b32 v22, 0, v8, s[98:99]
  v_lshlrev_b32 v23, 16, v22
  v_and_b32 v22, 0xffff0000, v22
  v_mul_f32 v9, v22, v22
  v_fmac_f32 v9, v23, v23
  v_add_f32 v23, v22, v23
  v_mov_b32 v22, v9
  s_waitcnt lgkmcnt(2)
  v_mfma_f32_16x16x32_bf16 v[8:11], v[12:15], v[24:27], 0
  v_add_f32_dpp v23, v23, v23 row_ror:8 row_mask:0xf bank_mask:0xf
  v_add_f32_dpp v22, v22, v22 row_ror:8 row_mask:0xf bank_mask:0xf
  s_waitcnt lgkmcnt(1)
  v_mfma_f32_16x16x32_bf16 v[8:11], v[16:19], v[28:31], v[8:11]
  v_add_f32_dpp v23, v23, v23 row_ror:4 row_mask:0xf bank_mask:0xf
  v_add_f32_dpp v22, v22, v22 row_ror:4 row_mask:0xf bank_mask:0xf
  v_mfma_f32_16x16x32_bf16 v[24:27], v[12:15], v[34:37], 0
  v_add_f32_dpp v23, v23, v23 row_ror:2 row_mask:0xf bank_mask:0xf
  v_add_f32_dpp v22, v22, v22 row_ror:2 row_mask:0xf bank_mask:0xf
  v_mfma_f32_16x16x32_bf16 v[24:27], v[16:19], v[38:41], v[24:27]
  v_add_f32_dpp v23, v23, v23 row_ror:1 row_mask:0xf bank_mask:0xf
  v_add_f32_dpp v22, v22, v22 row_ror:1 row_mask:0xf bank_mask:0xf
  v_mfma_f32_16x16x32_bf16 v[28:31], v[12:15], v[44:47], 0
  v_add_f32_dpp v23, v23, v23 row_bcast:15 row_mask:0xa bank_mask:0xf
  v_add_f32_dpp v22, v22, v22 row_bcast:15 row_mask:0xa bank_mask:0xf
  v_mfma_f32_16x16x32_bf16 v[28:31], v[16:19], v[48:51], v[28:31]
  v_add_f32_dpp v23, v23, v23 row_bcast:31 row_mask:0xc bank_mask:0xf
  v_add_f32_dpp v22, v22, v22 row_bcast:31 row_mask:0xc bank_mask:0xf
  s_waitcnt lgkmcnt(0)
  v_mfma_f32_16x16x16_bf16 v[8:11], v[20:21], v[32:33], v[8:11]
  v_cndmask_b32 v23, v22, v23, s[74:75]
  v_mfma_f32_16x16x16_bf16 v[24:27], v[20:21], v[42:43], v[24:27]
  v_mfma_f32_16x16x16_bf16 v[28:31], v[20:21], v[52:53], v[28:31]
  s_cmp_lg_u32 s60, 0
  s_nop 3
  v_cndmask_b32 v22, v8, v23, s[86:87]
  s_nop 0
  v_cndmask_b32 v22, v22, v24, s[82:83]
  v_cndmask_b32 v22, v22, v28, s[84:85]
  v_min_u32 v22, -2, v22
  s_cbranch_scc0 Le65
  buffer_store_dword v22, v7, s[20:23], s73 offen
Lf66:
  v_and_b32 v32, 15, v0
  v_lshrrev_b32 v33, 4, v0
  v_and_b32 v34, 1, v33
  v_lshlrev_b32 v34, 1, v34
  v_lshrrev_b32 v28, 1, v33
  v_or_b32 v34, v34, v28
  v_lshl_add_u32 v34, v32, 2, v34
  v_lshl_add_u32 v34, v34, 1, s57
  v_lshl_add_u32 v29, v0, 2, s38
  ds_read_b32 v20, v29 offset:0
  v_and_b32 v30, 1, v0
  v_lshrrev_b32 v31, 4, v0
  v_lshlrev_b32 v31, 5, v31
  v_lshl_add_u32 v30, v30, 4, v31
  v_add_u32 v30, 158048, v30
  v_mov_b32 v35, 0x3c75e03e
  v_mov_b32 v32, 0x3e13985d
  v_mov_b32 v33, 0x3a71d1e6
  buffer_load_dwordx4 v[12:15], v54, s[20:23], s72 offen sc1
  buffer_load_dwordx4 v[16:19], v54, s[20:23], s35 offen sc1
  v_lshl_add_u32 v37, v0, 4, s94
  ds_read_b128 v[38:41], v37 offset:0
  ds_read_b128 v[42:45], v37 offset:1024
  ds_read_b128 v[46:49], v37 offset:2048
  s_waitcnt vmcnt(0)
Lc67:
  v_max3_u32 v28, v12, v13, v14
  v_max3_u32 v28, v28, v15, v16
  v_max3_u32 v28, v28, v17, v18
  v_max_u32 v28, v28, v19
  v_cmp_eq_u32 vcc, -1, v28
  s_cbranch_vccnz Lr68
  v_pk_add_f32 v[12:13], v[12:13], v[16:17]
  v_pk_add_f32 v[14:15], v[14:15], v[18:19]
  s_nop 0
  v_permlane32_swap_b32 v12, v13
  v_permlane32_swap_b32 v14, v15
  v_add_f32 v12, v12, v13
  v_add_f32 v14, v14, v15
  s_nop 1
  v_permlane16_swap_b32 v12, v14
  v_add_f32 v12, v12, v14
  s_nop 0
  v_readlane_b32 s63, v12, 12
  v_readlane_b32 s64, v12, 44
  s_mov_b32 exec_lo, 0x0fff0fff
  s_mov_b32 exec_hi, 0x0fff0fff
  v_mul_f32 v15, s64, v35
  v_fma_f32 v14, s63, v32, v33
  v_fma_f32 v14, -v15, v15, v14
  v_max_f32 v14, v33, v14
  v_rsq_f32 v14, v14
  s_waitcnt lgkmcnt(3)
  v_fma_f32 v12, -v15, v20, v12
  v_mul_f32 v12, v12, v14
  v_cvt_pk_bf16_f32 v12, v12, v12
  ds_write_b16 v34, v12 offset:384
  s_mov_b64 exec, -1
  s_waitcnt lgkmcnt(0)
  s_barrier
  ds_read_b128 v[12:15], v30 offset:0
  ds_read_b128 v[16:19], v30 offset:128
  ds_read_b128 v[20:23], v30 offset:256
  s_add_u32 s64, s68, 786432
  v_mov_b32 v54, s44
  s_mov_b32 m0, 160480
  s_nop 0
  buffer_load_dword v54, s[20:23], s64 offen sc1 lds
  s_lshl_b32 s63, s3, 8
  v_and_b32 v54, 1, v0
  v_lshl_add_u32 v54, v54, 7, s63
  s_add_u32 s64, s66, 3670016
  s_mov_b32 m0, 160480
  s_nop 0
  buffer_load_dword v54, s[20:23], s64 offen sc1 lds
  s_waitcnt lgkmcnt(2)
  v_mfma_f32_16x16x32_bf16 v[24:27], a[0:3], v[12:15], 0
  v_and_b32 v50, 15, v0
  v_lshlrev_b32 v50, 5, v50
  s_waitcnt lgkmcnt(1)
  v_mfma_f32_16x16x32_bf16 v[24:27], a[4:7], v[16:19], v[24:27]
  v_and_b32 v51, 16, v0
  v_add3_u32 v50, v50, v51, s39
  s_waitcnt lgkmcnt(0)
  v_mfma_f32_16x16x32_bf16 v[24:27], a[8:11], v[20:23], v[24:27]
  v_mov_b32 v51, s54
  v_bfe_u32 v8, v0, 1, 3
  v_mfma_f32_16x16x32_bf16 v[28:31], a[12:15], v[12:15], 0
  v_lshrrev_b32 v9, 4, v0
  v_and_b32 v7, 1, v0
  v_mfma_f32_16x16x32_bf16 v[28:31], a[16:19], v[16:19], v[28:31]
  v_lshl_add_u32 v7, v9, 1, v7
  v_lshlrev_b32 v7, 4, v7
  v_mfma_f32_16x16x32_bf16 v[28:31], a[20:23], v[20:23], v[28:31]
  s_movk_i32 s63, 384
  v_mad_u32_u24 v7, v8, s63, v7
  v_mfma_f32_16x16x32_bf16 v[32:35], a[24:27], v[12:15], 0
  v_lshl_add_u32 v8, v9, 1, v8
  v_and_b32 v8, 7, v8
  v_mfma_f32_16x16x32_bf16 v[32:35], a[28:31], v[16:19], v[32:35]
  v_add_f32_dpp v36, v24, v25 quad_perm:[0,0,2,2] row_mask:0xf bank_mask:0x2
  v_mfma_f32_16x16x32_bf16 v[32:35], a[32:35], v[20:23], v[32:35]
  v_mul_u32_u24 v8, 16, v8
  v_add_f32_dpp v36, v26, v27 quad_perm:[0,0,2,2] row_mask:0xf bank_mask:0x8
  v_mfma_f32_16x16x32_bf16 v[24:27], a[36:39], v[12:15], 0
  s_add_u32 s76, s69, 786432
  v_mov_b32 v9, 153600
  v_mfma_f32_16x16x32_bf16 v[24:27], a[40:43], v[16:19], v[24:27]
  v_add_f32_dpp v37, v28, v29 quad_perm:[0,0,2,2] row_mask:0xf bank_mask:0x1
  v_mfma_f32_16x16x32_bf16 v[24:27], a[44:47], v[20:23], v[24:27]
  v_lshl_add_u32 v10, v0, 2, s55
  v_add_f32_dpp v37, v30, v31 quad_perm:[0,0,2,2] row_mask:0xf bank_mask:0x4
  v_add_f32_dpp v36, v32, v33 quad_perm:[0,0,2,2] row_mask:0xf bank_mask:0x1
  v_lshl_add_u32 v11, v0, 1, s44
  s_add_u32 s73, s68, 786432
  v_add_f32_dpp v36, v34, v35 quad_perm:[0,0,2,2] row_mask:0xf bank_mask:0x4
  s_nop 1
  v_add_f32_dpp v37, v24, v25 quad_perm:[0,0,2,2] row_mask:0xf bank_mask:0x2
  s_nop 1
  v_add_f32_dpp v37, v26, v27 quad_perm:[0,0,2,2] row_mask:0xf bank_mask:0x8
  v_max_f32 v52, v36, v37
  v_mov_b32_dpp v36, v36 quad_perm:[1,1,3,3] row_mask:0xf bank_mask:0xf
  v_mov_b32_dpp v37, v37 quad_perm:[1,1,3,3] row_mask:0xf bank_mask:0xf
  v_max_f32_dpp v52, v52, v52 row_ror:8 row_mask:0xf bank_mask:0xf
  s_nop 1
  v_max_f32_dpp v52, v52, v52 row_ror:4 row_mask:0xf bank_mask:0xf
  s_nop 1
  v_max_f32_dpp v52, v52, v52 row_bcast:15 row_mask:0xa bank_mask:0xf
  s_nop 1
  v_max_f32_dpp v52, v52, v52 row_bcast:31 row_mask:0xc bank_mask:0xf
  s_nop 0
  v_readlane_b32 s34, v52, 63
  s_nop 1
  v_subrev_f32 v36, s34, v36
  v_exp_f32 v36, v36
  v_subrev_f32 v37, s34, v37
  v_mov_b32 v53, v36
  v_cvt_pk_bf16_f32 v36, v36, v36
  v_exp_f32 v37, v37
  v_and_b32 v12, v36, v3
  v_and_b32 v13, v36, v4
  v_and_b32_dpp v14, v36, v5 row_shr:4 row_mask:0xf bank_mask:0xf bound_ctrl:0
  v_and_b32_dpp v15, v36, v6 row_shr:4 row_mask:0xf bank_mask:0xf bound_ctrl:0
  v_mov_b32 v52, s34
  ds_write_b32 v51, v52
  v_mfma_f32_16x16x32_bf16 v[24:27], v[12:15], v[38:41], 0
  v_and_b32 v18, v36, v5
  v_and_b32 v19, v36, v6
  v_mfma_f32_16x16x32_bf16 v[28:31], v[12:15], v[42:45], 0
  v_and_b32_dpp v16, v36, v3 row_shl:4 row_mask:0xf bank_mask:0xf bound_ctrl:0
  v_and_b32_dpp v17, v36, v4 row_shl:4 row_mask:0xf bank_mask:0xf bound_ctrl:0
  v_mfma_f32_16x16x32_bf16 v[32:35], v[12:15], v[46:49], 0
  v_add_f32 v53, v53, v37
  v_cvt_pk_bf16_f32 v37, v37, v37
  v_lshl_add_u32 v54, v0, 4, s94
  ds_read_b128 v[38:41], v54 offset:3072
  ds_read_b128 v[42:45], v54 offset:4096
  ds_read_b128 v[46:49], v54 offset:5120
  v_mfma_f32_16x16x32_bf16 v[24:27], v[16:19], a[48:51], v[24:27]
  v_and_b32 v12, v37, v3
  v_and_b32 v13, v37, v4
  v_mfma_f32_16x16x32_bf16 v[28:31], v[16:19], a[52:55], v[28:31]
  v_and_b32_dpp v14, v37, v5 row_shr:4 row_mask:0xf bank_mask:0xf bound_ctrl:0
  v_and_b32_dpp v15, v37, v6 row_shr:4 row_mask:0xf bank_mask:0xf bound_ctrl:0
  v_mfma_f32_16x16x32_bf16 v[32:35], v[16:19], a[56:59], v[32:35]
  s_nop 0
  v_mfma_f32_16x16x32_bf16 v[24:27], v[12:15], a[60:63], v[24:27]
  v_and_b32 v18, v37, v5
  v_and_b32 v19, v37, v6
  v_add_f32_dpp v53, v53, v53 row_ror:8 row_mask:0xf bank_mask:0xf
  v_mfma_f32_16x16x32_bf16 v[28:31], v[12:15], a[64:67], v[28:31]
  v_and_b32_dpp v16, v37, v3 row_shl:4 row_mask:0xf bank_mask:0xf bound_ctrl:0
  v_and_b32_dpp v17, v37, v4 row_shl:4 row_mask:0xf bank_mask:0xf bound_ctrl:0
  v_add_f32_dpp v53, v53, v53 row_ror:4 row_mask:0xf bank_mask:0xf
  v_mfma_f32_16x16x32_bf16 v[32:35], v[12:15], a[68:71], v[32:35]
  s_nop 0
  v_add_f32_dpp v53, v53, v53 row_bcast:15 row_mask:0xa bank_mask:0xf
  s_waitcnt lgkmcnt(2)
  v_mfma_f32_16x16x32_bf16 v[24:27], v[16:19], v[38:41], v[24:27]
  v_add_f32_dpp v53, v53, v53 row_bcast:31 row_mask:0xc bank_mask:0xf
  s_waitcnt lgkmcnt(1)
  v_mfma_f32_16x16x32_bf16 v[28:31], v[16:19], v[42:45], v[28:31]
  s_mov_b64 exec, s[36:37]
  ds_write_b32 v51, v53 offset:16
  s_mov_b64 exec, -1
  s_waitcnt lgkmcnt(1)
  v_mfma_f32_16x16x32_bf16 v[32:35], v[16:19], v[46:49], v[32:35]
  s_mov_b32 exec_lo, 0xffffffff
  s_mov_b32 exec_hi, 0x0
  ds_write_b128 v50, v[24:27] offset:0
  s_mov_b32 exec_lo, 0xff00ff
  s_mov_b32 exec_hi, 0xff00ff00
  ds_write_b128 v50, v[28:31] offset:512
  s_mov_b32 exec_lo, 0x0
  s_mov_b32 exec_hi, 0xffffffff
  ds_write_b128 v50, v[32:35] offset:1024
  s_mov_b64 exec, -1
  s_waitcnt lgkmcnt(0)
  s_barrier
  ds_read_b128 v[44:47], v9
  ds_read_b128 v[48:51], v9 offset:16
  ds_read2st64_b32 v[12:13], v10 offset0:0 offset1:3
  ds_read2st64_b32 v[14:15], v10 offset0:6 offset1:9
  ds_read2st64_b32 v[16:17], v10 offset0:12 offset1:15
  ds_read2st64_b32 v[18:19], v10 offset0:18 offset1:21
  s_waitcnt lgkmcnt(5)
  v_max3_f32 v52, v44, v45, v46
  v_max_f32 v52, v52, v47
  v_sub_f32 v44, v44, v52
  v_sub_f32 v45, v45, v52
  v_sub_f32 v46, v46, v52
  v_sub_f32 v47, v47, v52
  v_exp_f32 v44, v44
  v_exp_f32 v45, v45
  v_exp_f32 v46, v46
  v_exp_f32 v47, v47
  s_waitcnt lgkmcnt(3)
  v_add_f32 v12, v12, v13
  s_waitcnt lgkmcnt(2)
  v_add_f32 v14, v14, v15
  s_waitcnt lgkmcnt(1)
  v_add_f32 v16, v16, v17
  s_waitcnt lgkmcnt(0)
  v_add_f32 v18, v18, v19
  v_mul_f32 v20, v44, v12
  v_fmac_f32 v20, v45, v14
  v_fmac_f32 v20, v46, v16
  v_fmac_f32 v20, v47, v18
  v_mul_f32 v53, v44, v48
  v_fmac_f32 v53, v45, v49
  v_mov_b32_dpp v21, v20 quad_perm:[1,1,3,3] row_mask:0xf bank_mask:0xf
  v_fmac_f32 v53, v46, v50
  v_fmac_f32 v53, v47, v51
  v_cvt_pk_bf16_f32 v20, v20, v21
  v_cndmask_b32 v52, v52, v53, s[100:101]
  v_cndmask_b32 v20, v20, v52, s[42:43]
  v_min_u32 v20, -2, v20
  s_mov_b64 exec, s[46:47]
  s_cmp_lg_u32 s60, 0
  s_cbranch_scc0 Le69
  buffer_store_dword v20, v11, s[20:23], s73 offen
Lf70:
  s_mov_b64 exec, -1
  s_cmp_eq_u32 s3, 3
  s_cbranch_scc1 Ls71
  v_bfe_u32 v10, v0, 2, 2
  v_and_b32 v11, 48, v0
  v_add_u32 v10, v10, v11
  v_mul_u32_u24 v10, 160, v10
  v_and_b32 v11, 3, v0
  v_lshl_add_u32 v10, v11, 3, v10
  s_add_u32 s64, s95, 30720
  v_add_u32 v10, s64, v10
  ds_read_b64_tr_b16 v[24:25], v10 offset:0
  ds_read_b64_tr_b16 v[26:27], v10 offset:640
  ds_read_b64_tr_b16 v[28:29], v10 offset:1280
  ds_read_b64_tr_b16 v[30:31], v10 offset:1920
  ds_read_b64_tr_b16 v[32:33], v10 offset:10240
  ds_read_b64_tr_b16 v[34:35], v10 offset:10880
  ds_read_b64_tr_b16 v[36:37], v10 offset:11520
  ds_read_b64_tr_b16 v[38:39], v10 offset:12160
  ds_read_b64_tr_b16 v[40:41], v10 offset:20480
  ds_read_b64_tr_b16 v[42:43], v10 offset:21120
  ds_read_b64_tr_b16 v[44:45], v10 offset:21760
  ds_read_b64_tr_b16 v[46:47], v10 offset:22400
  v_and_b32 v11, 15, v0
  v_lshlrev_b32 v11, 1, v11
  v_and_b32 v9, 32, v0
  v_add3_u32 v11, v11, v9, s95
  s_add_u32 s73, s70, 294912
  buffer_load_dwordx2 v[52:53], v8, s[20:23], s76 offen offset:3072 sc1
  buffer_load_dwordx4 v[12:15], v7, s[20:23], s76 offen offset:0 sc1
  buffer_load_dwordx4 v[16:19], v7, s[20:23], s76 offen offset:128 sc1
  buffer_load_dwordx4 v[20:23], v7, s[20:23], s76 offen offset:256 sc1
  s_waitcnt vmcnt(0)
Lc72:
  s_waitcnt lgkmcnt(10)
  v_mfma_f32_16x16x32_bf16 v[48:51], v[12:15], v[24:27], 0
  v_max3_u32 v9, v52, v53, v12
  v_max3_u32 v9, v9, v13, v14
  v_max3_u32 v9, v9, v15, v16
  s_waitcnt lgkmcnt(6)
  v_mfma_f32_16x16x32_bf16 v[48:51], v[16:19], v[32:35], v[48:51]
  v_max3_u32 v9, v9, v17, v18
  v_max3_u32 v9, v9, v19, v20
  v_max3_u32 v9, v9, v21, v22
  s_waitcnt lgkmcnt(2)
  v_mfma_f32_16x16x32_bf16 v[48:51], v[20:23], v[40:43], v[48:51]
  v_max_u32 v9, v9, v23
  v_cmp_eq_u32 vcc, -1, v9
  s_cbranch_vccnz Lr73
  v_max_f32_dpp v9, v52, v52 row_ror:8 row_mask:0xf bank_mask:0xf
  v_mfma_f32_16x16x32_bf16 v[24:27], v[12:15], v[28:31], 0
  ds_read_b64_tr_b16 v[32:33], v10 offset:32
  ds_read_b64_tr_b16 v[34:35], v10 offset:672
  v_max_f32_dpp v9, v9, v9 row_ror:4 row_mask:0xf bank_mask:0xf
  v_mfma_f32_16x16x32_bf16 v[24:27], v[16:19], v[36:39], v[24:27]
  ds_read_b64_tr_b16 v[40:41], v10 offset:10272
  ds_read_b64_tr_b16 v[42:43], v10 offset:10912
  v_max_f32_dpp v9, v9, v9 row_ror:2 row_mask:0xf bank_mask:0xf
  s_waitcnt lgkmcnt(4)
  v_mfma_f32_16x16x32_bf16 v[24:27], v[20:23], v[44:47], v[24:27]
  v_sub_f32 v52, v52, v9
  v_exp_f32 v52, v52
  ds_read_b64_tr_b16 v[28:29], v10 offset:20512
  ds_read_b64_tr_b16 v[30:31], v10 offset:21152
  v_mul_f32 v53, v52, v53
  ds_read_b64_tr_b16 v[36:37], v10 offset:1312
  ds_read_b64_tr_b16 v[38:39], v10 offset:1952
  v_add_f32_dpp v53, v53, v53 row_ror:8 row_mask:0xf bank_mask:0xf
  ds_read_b64_tr_b16 v[44:45], v10 offset:11552
  ds_read_b64_tr_b16 v[46:47], v10 offset:12192
  v_add_f32_dpp v53, v53, v53 row_ror:4 row_mask:0xf bank_mask:0xf
  v_add_f32 v48, v48, v25
  v_add_f32 v50, v50, v27
  v_add_f32_dpp v53, v53, v53 row_ror:2 row_mask:0xf bank_mask:0xf
  v_mov_b32 v7, v48
  v_mov_b32 v8, v50
  v_rcp_f32 v53, v53
  s_waitcnt lgkmcnt(8)
  v_mfma_f32_16x16x32_bf16 v[48:51], v[12:15], v[32:35], 0
  ds_read_b64_tr_b16 v[32:33], v10 offset:21792
  ds_read_b64_tr_b16 v[34:35], v10 offset:22432
  v_mul_f32 v9, v52, v53
  s_waitcnt lgkmcnt(8)
  v_mfma_f32_16x16x32_bf16 v[48:51], v[16:19], v[40:43], v[48:51]
  s_waitcnt lgkmcnt(6)
  v_mfma_f32_16x16x32_bf16 v[48:51], v[20:23], v[28:31], v[48:51]
  v_mul_f32_dpp v52, v9, v7 row_newbcast:0 row_mask:0xf bank_mask:0xf
  s_waitcnt lgkmcnt(4)
  v_mfma_f32_16x16x32_bf16 v[24:27], v[12:15], v[36:39], 0
  v_mov_b32_dpp v7, v9 row_newbcast:0 row_mask:0xf bank_mask:0xf
  s_waitcnt lgkmcnt(2)
  v_mfma_f32_16x16x32_bf16 v[24:27], v[16:19], v[44:47], v[24:27]
  v_fmac_f32_dpp v52, v9, v8 row_newbcast:2 row_mask:0xf bank_mask:0xf
  s_waitcnt lgkmcnt(0)
  v_mfma_f32_16x16x32_bf16 v[24:27], v[20:23], v[32:35], v[24:27]
  v_mov_b32_dpp v8, v9 row_newbcast:2 row_mask:0xf bank_mask:0xf
  s_nop 6
  v_add_f32 v48, v48, v25
  v_add_f32 v50, v50, v27
  v_mul_f32 v53, v7, v48
  v_fmac_f32 v53, v8, v50
  s_nop 1
  v_permlane32_swap_b32 v52, v53
  v_add_f32 v52, v52, v53
  v_mov_b32 v53, v52
  s_nop 1
  v_permlane16_swap_b32 v52, v53
  v_add_f32 v52, v52, v53
  s_nop 1
  v_mov_b32_dpp v53, v52 quad_perm:[1,1,3,3] row_mask:0xf bank_mask:0xf
  v_cvt_pk_bf16_f32 v52, v52, v53
  v_min_u32 v52, -2, v52
  s_mov_b64 exec, s[80:81]
  buffer_store_dword v52, v11, s[20:23], s73 offen sc1
  s_mov_b64 exec, -1
Ls71:
  v_lshrrev_b32 v54, 4, v0
  v_mul_u32_u24 v54, 192, v54
  v_and_b32 v9, 15, v0
  v_lshl_add_u32 v54, v9, 4, v54
  s_waitcnt vmcnt(0)
  s_waitcnt lgkmcnt(0)
  s_barrier
  v_bfe_u32 v7, v0, 2, 2
  v_lshrrev_b32 v9, 4, v0
  v_lshl_add_u32 v8, v9, 3, v7
  v_lshl_add_u32 v7, v9, 2, v7
  v_and_b32 v9, 3, v0
  v_lshlrev_b32 v9, 3, v9
  s_mul_i32 s63, s3, 96
  s_add_u32 s63, s63, 61440
  v_add_u32 v9, s63, v9
  s_movk_i32 s63, 384
  v_mad_u32_u24 v8, v8, s63, v9
  v_mad_u32_u24 v7, v7, s63, v9
  ds_read_b64_tr_b16 v[24:25], v8 offset:0
  ds_read_b64_tr_b16 v[26:27], v8 offset:1536
  ds_read_b64_tr_b16 v[28:29], v8 offset:12288
  ds_read_b64_tr_b16 v[30:31], v8 offset:13824
  ds_read_b64_tr_b16 v[32:33], v7 offset:24576
  ds_read_b64_tr_b16 v[34:35], v8 offset:32
  ds_read_b64_tr_b16 v[36:37], v8 offset:1568
  ds_read_b64_tr_b16 v[38:39], v8 offset:12320
  ds_read_b64_tr_b16 v[40:41], v8 offset:13856
  ds_read_b64_tr_b16 v[42:43], v7 offset:24608
  ds_read_b64_tr_b16 v[44:45], v8 offset:64
  ds_read_b64_tr_b16 v[46:47], v8 offset:1600
  ds_read_b64_tr_b16 v[48:49], v8 offset:12352
  ds_read_b64_tr_b16 v[50:51], v8 offset:13888
  ds_read_b64_tr_b16 v[52:53], v7 offset:24640
  s_mul_i32 s63, s3, 1536
  s_add_u32 s72, s71, s63
  s_add_u32 s72, s72, 294912
  s_add_u32 s35, s72, 768
  v_and_b32 v16, 0x3f803f80, v3
  v_and_b32 v17, 0x3f803f80, v4
  v_and_b32 v18, 0x3f803f80, v5
  v_and_b32 v19, 0x3f803f80, v6
  v_mov_b32 v8, 0
  v_mov_b32 v9, 0
  v_mov_b32 v10, 0
  v_mov_b32 v11, 0
  v_mov_b32 v12, 0
  v_mov_b32 v13, 0
  v_mov_b32 v14, 0
  v_mov_b32 v15, 0
  s_mov_b64 exec, s[32:33]
  buffer_load_dwordx4 v[8:11], v54, s[20:23], s72 offen sc1
  buffer_load_dwordx4 v[12:15], v54, s[20:23], s35 offen sc1
  s_mov_b64 exec, -1
  s_branch Lpg5
.p2align 12
Lst5:
  s_setpc_b64 s[78:79]
Lpg5:
  s_waitcnt vmcnt(0)
Lc74:
  v_mfma_f32_16x16x32_bf16 v[20:23], v[16:19], v[8:11], 0
  v_max3_u32 v7, v8, v9, v10
  v_max3_u32 v7, v7, v11, v12
  v_max3_u32 v7, v7, v13, v14
  v_mfma_f32_16x16x32_bf16 v[20:23], v[16:19], v[12:15], v[20:23]
  v_max_u32 v7, v7, v15
  v_cmp_eq_u32 vcc, -1, v7
  s_cbranch_vccnz Lr75
  v_and_b32 v7, 15, v0
  v_lshlrev_b32 v7, 5, v7
  v_and_b32 v54, 16, v0
  v_add3_u32 v7, v7, v54, s56
  s_mov_b32 exec_lo, s32
  s_mov_b32 exec_hi, 0
  ds_write_b128 v7, v[20:23] offset:1280
  s_mov_b64 exec, -1
  v_lshl_add_u32 v7, v0, 2, s45
  ds_read_b32 v54, v7 offset:640
  v_lshlrev_b32 v14, 3, v0
  v_add_u32 v14, 154944, v14
  v_mov_b32 v22, s45
  v_mov_b32 v23, 156864
  v_cndmask_b32 v23, v22, v23, s[74:75]
  v_lshrrev_b32 v21, 4, v0
  v_lshl_add_u32 v22, v21, 4, v23
  v_lshl_add_u32 v23, v21, 3, v23
  s_waitcnt lgkmcnt(0)
  s_barrier
  s_mov_b32 exec_hi, 0xff
  ds_read2_b64 v[8:11], v14 offset0:0 offset1:40
  ds_read2_b64 v[12:15], v14 offset0:80 offset1:120
  v_lshlrev_b32 v16, 16, v54
  v_and_b32 v17, 0xffff0000, v54
  s_waitcnt lgkmcnt(1)
  v_pk_add_f32 v[8:9], v[8:9], v[10:11]
  s_waitcnt lgkmcnt(0)
  v_pk_add_f32 v[12:13], v[12:13], v[14:15]
  v_pk_add_f32 v[8:9], v[8:9], v[12:13]
  v_cvt_pk_bf16_f32 v8, v8, v9
  v_and_b32 v9, 0xffff0000, v8
  v_lshlrev_b32 v8, 16, v8
  v_pk_add_f32 v[8:9], v[8:9], v[16:17]
  v_cvt_pk_bf16_f32 v8, v8, v9
  ds_write_b32 v7, v8 offset:640
  s_mov_b64 exec, -1
  ds_read_b128 v[12:15], v22 offset:640
  ds_read_b128 v[16:19], v22 offset:704
  ds_read_b64 v[20:21], v23 offset:768
  v_lshl_add_u32 v7, v0, 2, s55
  s_add_u32 s73, s66, 3522560
  v_and_b32 v23, 15, v0
  v_lshrrev_b32 v54, 4, v0
  v_mul_u32_u24 v54, 2048, v54
  v_lshl_add_u32 v54, v23, 4, v54
  s_add_u32 s72, s96, 3670016
  s_add_u32 s35, s72, 8192
  v_cndmask_b32 v22, 0, v8, s[98:99]
  v_lshlrev_b32 v23, 16, v22
  v_and_b32 v22, 0xffff0000, v22
  v_mul_f32 v9, v22, v22
  v_fmac_f32 v9, v23, v23
  v_add_f32 v23, v22, v23
  v_mov_b32 v22, v9
  s_waitcnt lgkmcnt(2)
  v_mfma_f32_16x16x32_bf16 v[8:11], v[12:15], v[24:27], 0
  v_add_f32_dpp v23, v23, v23 row_ror:8 row_mask:0xf bank_mask:0xf
  v_add_f32_dpp v22, v22, v22 row_ror:8 row_mask:0xf bank_mask:0xf
  s_waitcnt lgkmcnt(1)
  v_mfma_f32_16x16x32_bf16 v[8:11], v[16:19], v[28:31], v[8:11]
  v_add_f32_dpp v23, v23, v23 row_ror:4 row_mask:0xf bank_mask:0xf
  v_add_f32_dpp v22, v22, v22 row_ror:4 row_mask:0xf bank_mask:0xf
  v_mfma_f32_16x16x32_bf16 v[24:27], v[12:15], v[34:37], 0
  v_add_f32_dpp v23, v23, v23 row_ror:2 row_mask:0xf bank_mask:0xf
  v_add_f32_dpp v22, v22, v22 row_ror:2 row_mask:0xf bank_mask:0xf
  v_mfma_f32_16x16x32_bf16 v[24:27], v[16:19], v[38:41], v[24:27]
  v_add_f32_dpp v23, v23, v23 row_ror:1 row_mask:0xf bank_mask:0xf
  v_add_f32_dpp v22, v22, v22 row_ror:1 row_mask:0xf bank_mask:0xf
  v_mfma_f32_16x16x32_bf16 v[28:31], v[12:15], v[44:47], 0
  v_add_f32_dpp v23, v23, v23 row_bcast:15 row_mask:0xa bank_mask:0xf
  v_add_f32_dpp v22, v22, v22 row_bcast:15 row_mask:0xa bank_mask:0xf
  v_mfma_f32_16x16x32_bf16 v[28:31], v[16:19], v[48:51], v[28:31]
  v_add_f32_dpp v23, v23, v23 row_bcast:31 row_mask:0xc bank_mask:0xf
  v_add_f32_dpp v22, v22, v22 row_bcast:31 row_mask:0xc bank_mask:0xf
  s_waitcnt lgkmcnt(0)
  v_mfma_f32_16x16x16_bf16 v[8:11], v[20:21], v[32:33], v[8:11]
  v_cndmask_b32 v23, v22, v23, s[74:75]
  v_mfma_f32_16x16x16_bf16 v[24:27], v[20:21], v[42:43], v[24:27]
  v_mfma_f32_16x16x16_bf16 v[28:31], v[20:21], v[52:53], v[28:31]
  s_cmp_lg_u32 s60, 0
  s_nop 3
  v_cndmask_b32 v22, v8, v23, s[86:87]
  s_nop 0
  v_cndmask_b32 v22, v22, v24, s[82:83]
  v_cndmask_b32 v22, v22, v28, s[84:85]
  v_min_u32 v22, -2, v22
  s_cbranch_scc0 Le76
  buffer_store_dword v22, v7, s[20:23], s73 offen
Lf77:
  v_and_b32 v32, 15, v0
  v_lshrrev_b32 v33, 4, v0
  v_and_b32 v34, 1, v33
  v_lshlrev_b32 v34, 1, v34
  v_lshrrev_b32 v28, 1, v33
  v_or_b32 v34, v34, v28
  v_lshl_add_u32 v34, v32, 2, v34
  v_lshl_add_u32 v34, v34, 1, s57
  v_lshl_add_u32 v29, v0, 2, s38
  ds_read_b32 v20, v29 offset:1024
  v_and_b32 v30, 1, v0
  v_lshrrev_b32 v31, 4, v0
  v_lshlrev_b32 v31, 5, v31
  v_lshl_add_u32 v30, v30, 4, v31
  v_add_u32 v30, 158048, v30
  v_mov_b32 v35, 0x3c75e03e
  v_mov_b32 v32, 0x3e13985d
  v_mov_b32 v33, 0x3a71d1e6
  buffer_load_dwordx4 v[12:15], v54, s[20:23], s72 offen sc1
  buffer_load_dwordx4 v[16:19], v54, s[20:23], s35 offen sc1
  s_waitcnt vmcnt(0)
Lc78:
  v_max3_u32 v28, v12, v13, v14
  v_max3_u32 v28, v28, v15, v16
  v_max3_u32 v28, v28, v17, v18
  v_max_u32 v28, v28, v19
  v_cmp_eq_u32 vcc, -1, v28
  s_cbranch_vccnz Lr79
  v_pk_add_f32 v[12:13], v[12:13], v[16:17]
  v_pk_add_f32 v[14:15], v[14:15], v[18:19]
  s_nop 0
  v_permlane32_swap_b32 v12, v13
  v_permlane32_swap_b32 v14, v15
  v_add_f32 v12, v12, v13
  v_add_f32 v14, v14, v15
  s_nop 1
  v_permlane16_swap_b32 v12, v14
  v_add_f32 v12, v12, v14
  s_nop 0
  v_readlane_b32 s63, v12, 12
  v_readlane_b32 s64, v12, 44
  s_mov_b32 exec_lo, 0x0fff0fff
  s_mov_b32 exec_hi, 0x0fff0fff
  v_mul_f32 v15, s64, v35
  v_fma_f32 v14, s63, v32, v33
  v_fma_f32 v14, -v15, v15, v14
  v_max_f32 v14, v33, v14
  v_rsq_f32 v14, v14
  s_waitcnt lgkmcnt(0)
  v_fma_f32 v12, -v15, v20, v12
  v_mul_f32 v12, v12, v14
  v_cvt_pk_bf16_f32 v12, v12, v12
  ds_write_b16 v34, v12 offset:384
  s_mov_b64 exec, -1
  s_waitcnt lgkmcnt(0)
  s_barrier
  ds_read_b128 v[12:15], v30 offset:0
  ds_read_b128 v[16:19], v30 offset:128
  ds_read_b128 v[20:23], v30 offset:256
  s_add_u32 s64, s68, 917504
  v_mov_b32 v54, s44
  s_mov_b32 m0, 160480
  s_nop 0
  buffer_load_dword v54, s[20:23], s64 offen sc1 lds
  v_and_b32 v50, 15, v0
  v_lshlrev_b32 v50, 5, v50
  v_and_b32 v51, 16, v0
  v_add3_u32 v50, v50, v51, s39
  v_mov_b32 v51, s54
  s_waitcnt lgkmcnt(2)
  v_mfma_f32_16x16x32_bf16 v[24:27], a[72:75], v[12:15], 0
  v_bfe_u32 v8, v0, 1, 3
  v_lshrrev_b32 v9, 4, v0
  s_waitcnt lgkmcnt(1)
  v_mfma_f32_16x16x32_bf16 v[24:27], a[76:79], v[16:19], v[24:27]
  v_and_b32 v7, 1, v0
  v_lshl_add_u32 v7, v9, 1, v7
  s_waitcnt lgkmcnt(0)
  v_mfma_f32_16x16x32_bf16 v[24:27], a[80:83], v[20:23], v[24:27]
  v_lshlrev_b32 v7, 4, v7
  s_movk_i32 s63, 384
  v_mfma_f32_16x16x32_bf16 v[28:31], a[84:87], v[12:15], 0
  v_mad_u32_u24 v7, v8, s63, v7
  v_lshl_add_u32 v8, v9, 1, v8
  v_mfma_f32_16x16x32_bf16 v[28:31], a[88:91], v[16:19], v[28:31]
  v_and_b32 v8, 7, v8
  v_mul_u32_u24 v8, 16, v8
  v_mfma_f32_16x16x32_bf16 v[28:31], a[92:95], v[20:23], v[28:31]
  s_add_u32 s76, s69, 917504
  v_mov_b32 v9, 153600
  v_mfma_f32_16x16x32_bf16 v[32:35], a[96:99], v[12:15], 0
  v_lshl_add_u32 v10, v0, 2, s55
  v_lshl_add_u32 v11, v0, 1, s44
  v_mfma_f32_16x16x32_bf16 v[32:35], a[100:103], v[16:19], v[32:35]
  v_add_f32_dpp v36, v24, v25 quad_perm:[0,0,2,2] row_mask:0xf bank_mask:0x1
  v_mfma_f32_16x16x32_bf16 v[32:35], a[104:107], v[20:23], v[32:35]
  s_add_u32 s73, s68, 917504
  v_add_f32_dpp v36, v26, v27 quad_perm:[0,0,2,2] row_mask:0xf bank_mask:0x4
  v_mfma_f32_16x16x32_bf16 v[24:27], a[108:111], v[12:15], 0
  v_mfma_f32_16x16x32_bf16 v[24:27], a[112:115], v[16:19], v[24:27]
  v_add_f32_dpp v36, v28, v29 quad_perm:[0,0,2,2] row_mask:0xf bank_mask:0x2
  v_mfma_f32_16x16x32_bf16 v[24:27], a[116:119], v[20:23], v[24:27]
  s_nop 0
  v_add_f32_dpp v36, v30, v31 quad_perm:[0,0,2,2] row_mask:0xf bank_mask:0x8
  v_mfma_f32_16x16x32_bf16 v[28:31], a[120:123], v[12:15], 0
  s_nop 0
  v_mov_b32_dpp v36, v36 quad_perm:[1,1,3,3] row_mask:0xf bank_mask:0xf
  v_mfma_f32_16x16x32_bf16 v[28:31], a[124:127], v[16:19], v[28:31]
  v_add_f32_dpp v37, v32, v33 quad_perm:[0,0,2,2] row_mask:0xf bank_mask:0x1
  v_mfma_f32_16x16x32_bf16 v[28:31], a[128:131], v[20:23], v[28:31]
  s_nop 0
  v_add_f32_dpp v37, v34, v35 quad_perm:[0,0,2,2] row_mask:0xf bank_mask:0x4
  v_mfma_f32_16x16x32_bf16 v[32:35], a[132:135], v[12:15], 0
  v_mfma_f32_16x16x32_bf16 v[32:35], a[136:139], v[16:19], v[32:35]
  v_add_f32_dpp v37, v24, v25 quad_perm:[0,0,2,2] row_mask:0xf bank_mask:0x2
  v_mfma_f32_16x16x32_bf16 v[32:35], a[140:143], v[20:23], v[32:35]
  s_nop 0
  v_add_f32_dpp v37, v26, v27 quad_perm:[0,0,2,2] row_mask:0xf bank_mask:0x8
  v_mfma_f32_16x16x32_bf16 v[24:27], a[144:147], v[12:15], 0
  s_nop 0
  v_mov_b32_dpp v37, v37 quad_perm:[1,1,3,3] row_mask:0xf bank_mask:0xf
  v_mfma_f32_16x16x32_bf16 v[24:27], a[148:151], v[16:19], v[24:27]
  v_add_f32_dpp v38, v28, v29 quad_perm:[0,0,2,2] row_mask:0xf bank_mask:0x1
  v_mfma_f32_16x16x32_bf16 v[24:27], a[152:155], v[20:23], v[24:27]
  s_nop 0
  v_add_f32_dpp v38, v30, v31 quad_perm:[0,0,2,2] row_mask:0xf bank_mask:0x4
  v_mfma_f32_16x16x32_bf16 v[28:31], a[156:159], v[12:15], 0
  v_mfma_f32_16x16x32_bf16 v[28:31], a[160:163], v[16:19], v[28:31]
  v_add_f32_dpp v38, v32, v33 quad_perm:[0,0,2,2] row_mask:0xf bank_mask:0x2
  v_mfma_f32_16x16x32_bf16 v[28:31], a[164:167], v[20:23], v[28:31]
  s_nop 0
  v_add_f32_dpp v38, v34, v35 quad_perm:[0,0,2,2] row_mask:0xf bank_mask:0x8
  v_mfma_f32_16x16x32_bf16 v[32:35], a[168:171], v[12:15], 0
  s_nop 0
  v_mov_b32_dpp v38, v38 quad_perm:[1,1,3,3] row_mask:0xf bank_mask:0xf
  v_mfma_f32_16x16x32_bf16 v[32:35], a[172:175], v[16:19], v[32:35]
  v_add_f32_dpp v39, v24, v25 quad_perm:[0,0,2,2] row_mask:0xf bank_mask:0x1
  v_mfma_f32_16x16x32_bf16 v[32:35], a[176:179], v[20:23], v[32:35]
  s_nop 0
  v_add_f32_dpp v39, v26, v27 quad_perm:[0,0,2,2] row_mask:0xf bank_mask:0x4
  v_mfma_f32_16x16x32_bf16 v[24:27], a[180:183], v[12:15], 0
  v_mfma_f32_16x16x32_bf16 v[24:27], a[184:187], v[16:19], v[24:27]
  v_add_f32_dpp v39, v28, v29 quad_perm:[0,0,2,2] row_mask:0xf bank_mask:0x2
  v_mfma_f32_16x16x32_bf16 v[24:27], a[188:191], v[20:23], v[24:27]
  s_nop 0
  v_add_f32_dpp v39, v30, v31 quad_perm:[0,0,2,2] row_mask:0xf bank_mask:0x8
  v_mfma_f32_16x16x32_bf16 v[28:31], a[192:195], v[12:15], 0
  s_nop 0
  v_mov_b32_dpp v39, v39 quad_perm:[1,1,3,3] row_mask:0xf bank_mask:0xf
  v_mfma_f32_16x16x32_bf16 v[28:31], a[196:199], v[16:19], v[28:31]
  v_add_f32_dpp v40, v32, v33 quad_perm:[0,0,2,2] row_mask:0xf bank_mask:0x1
  v_mfma_f32_16x16x32_bf16 v[28:31], a[200:203], v[20:23], v[28:31]
  s_nop 0
  v_add_f32_dpp v40, v34, v35 quad_perm:[0,0,2,2] row_mask:0xf bank_mask:0x4
  v_mfma_f32_16x16x32_bf16 v[32:35], a[204:207], v[12:15], 0
  v_mfma_f32_16x16x32_bf16 v[32:35], a[208:211], v[16:19], v[32:35]
  v_add_f32_dpp v40, v24, v25 quad_perm:[0,0,2,2] row_mask:0xf bank_mask:0x2
  v_mfma_f32_16x16x32_bf16 v[32:35], a[212:215], v[20:23], v[32:35]
  s_nop 0
  v_add_f32_dpp v40, v26, v27 quad_perm:[0,0,2,2] row_mask:0xf bank_mask:0x8
  v_mfma_f32_16x16x32_bf16 v[24:27], a[216:219], v[12:15], 0
  s_nop 0
  v_mov_b32_dpp v40, v40 quad_perm:[1,1,3,3] row_mask:0xf bank_mask:0xf
  v_mfma_f32_16x16x32_bf16 v[24:27], a[220:223], v[16:19], v[24:27]
  v_add_f32_dpp v41, v28, v29 quad_perm:[0,0,2,2] row_mask:0xf bank_mask:0x1
  v_mfma_f32_16x16x32_bf16 v[24:27], a[224:227], v[20:23], v[24:27]
  s_nop 0
  v_add_f32_dpp v41, v30, v31 quad_perm:[0,0,2,2] row_mask:0xf bank_mask:0x4
  v_mfma_f32_16x16x32_bf16 v[28:31], a[228:231], v[12:15], 0
  v_mfma_f32_16x16x32_bf16 v[28:31], a[232:235], v[16:19], v[28:31]
  v_add_f32_dpp v41, v32, v33 quad_perm:[0,0,2,2] row_mask:0xf bank_mask:0x2
  v_mfma_f32_16x16x32_bf16 v[28:31], a[236:239], v[20:23], v[28:31]
  s_nop 0
  v_add_f32_dpp v41, v34, v35 quad_perm:[0,0,2,2] row_mask:0xf bank_mask:0x8
  v_mfma_f32_16x16x32_bf16 v[32:35], a[240:243], v[12:15], 0
  s_nop 0
  v_mov_b32_dpp v41, v41 quad_perm:[1,1,3,3] row_mask:0xf bank_mask:0xf
  v_mfma_f32_16x16x32_bf16 v[32:35], a[244:247], v[16:19], v[32:35]
  v_add_f32_dpp v42, v24, v25 quad_perm:[0,0,2,2] row_mask:0xf bank_mask:0x1
  v_mfma_f32_16x16x32_bf16 v[32:35], a[248:251], v[20:23], v[32:35]
  s_nop 0
  v_add_f32_dpp v42, v26, v27 quad_perm:[0,0,2,2] row_mask:0xf bank_mask:0x4
  v_mfma_f32_16x16x32_bf16 v[24:27], a[252:255], v[12:15], 0
  v_mfma_f32_16x16x32_bf16 v[24:27], v[56:59], v[16:19], v[24:27]
  v_add_f32_dpp v42, v28, v29 quad_perm:[0,0,2,2] row_mask:0xf bank_mask:0x2
  v_mfma_f32_16x16x32_bf16 v[24:27], v[60:63], v[20:23], v[24:27]
  s_nop 0
  v_add_f32_dpp v42, v30, v31 quad_perm:[0,0,2,2] row_mask:0xf bank_mask:0x8
  v_add_f32_dpp v43, v32, v33 quad_perm:[0,0,2,2] row_mask:0xf bank_mask:0x1
  s_nop 1
  v_add_f32_dpp v43, v34, v35 quad_perm:[0,0,2,2] row_mask:0xf bank_mask:0x4
  s_nop 1
  v_add_f32_dpp v43, v24, v25 quad_perm:[0,0,2,2] row_mask:0xf bank_mask:0x2
  v_max3_f32 v52, v36, v37, v38
  v_max3_f32 v52, v52, v39, v40
  v_add_f32_dpp v43, v26, v27 quad_perm:[0,0,2,2] row_mask:0xf bank_mask:0x8
  v_max3_f32 v52, v52, v41, v42
  v_max_f32 v52, v52, v43
  v_mov_b32_dpp v42, v42 quad_perm:[1,1,3,3] row_mask:0xf bank_mask:0xf
  v_mov_b32_dpp v43, v43 quad_perm:[1,1,3,3] row_mask:0xf bank_mask:0xf
  v_max_f32_dpp v52, v52, v52 row_ror:8 row_mask:0xf bank_mask:0xf
  s_nop 1
  v_max_f32_dpp v52, v52, v52 row_ror:4 row_mask:0xf bank_mask:0xf
  s_nop 1
  v_max_f32_dpp v52, v52, v52 row_bcast:15 row_mask:0xa bank_mask:0xf
  s_nop 1
  v_max_f32_dpp v52, v52, v52 row_bcast:31 row_mask:0xc bank_mask:0xf
  s_nop 0
  v_readlane_b32 s34, v52, 63
  s_nop 1
  v_subrev_f32 v36, s34, v36
  v_exp_f32 v36, v36
  v_subrev_f32 v37, s34, v37
  v_mov_b32 v53, v36
  v_cvt_pk_bf16_f32 v36, v36, v36
  v_exp_f32 v37, v37
  v_and_b32 v12, v36, v3
  v_and_b32 v13, v36, v4
  v_and_b32_dpp v14, v36, v5 row_shr:4 row_mask:0xf bank_mask:0xf bound_ctrl:0
  v_and_b32_dpp v15, v36, v6 row_shr:4 row_mask:0xf bank_mask:0xf bound_ctrl:0
  v_mov_b32 v52, s34
  ds_write_b32 v51, v52
  v_mfma_f32_16x16x32_bf16 v[24:27], v[12:15], v[64:67], 0
  v_and_b32 v18, v36, v5
  v_and_b32 v19, v36, v6
  v_mfma_f32_16x16x32_bf16 v[28:31], v[12:15], v[68:71], 0
  v_and_b32_dpp v16, v36, v3 row_shl:4 row_mask:0xf bank_mask:0xf bound_ctrl:0
  v_and_b32_dpp v17, v36, v4 row_shl:4 row_mask:0xf bank_mask:0xf bound_ctrl:0
  v_mfma_f32_16x16x32_bf16 v[32:35], v[12:15], v[72:75], 0
  v_add_f32 v53, v53, v37
  v_cvt_pk_bf16_f32 v37, v37, v37
  v_mfma_f32_16x16x32_bf16 v[24:27], v[16:19], v[76:79], v[24:27]
  v_and_b32 v12, v37, v3
  v_and_b32 v13, v37, v4
  v_mfma_f32_16x16x32_bf16 v[28:31], v[16:19], v[80:83], v[28:31]
  v_and_b32_dpp v14, v37, v5 row_shr:4 row_mask:0xf bank_mask:0xf bound_ctrl:0
  v_and_b32_dpp v15, v37, v6 row_shr:4 row_mask:0xf bank_mask:0xf bound_ctrl:0
  v_mfma_f32_16x16x32_bf16 v[32:35], v[16:19], v[84:87], v[32:35]
  v_subrev_f32 v38, s34, v38
  v_exp_f32 v38, v38
  v_mfma_f32_16x16x32_bf16 v[24:27], v[12:15], v[88:91], v[24:27]
  v_and_b32 v18, v37, v5
  v_and_b32 v19, v37, v6
  v_mfma_f32_16x16x32_bf16 v[28:31], v[12:15], v[92:95], v[28:31]
  v_and_b32_dpp v16, v37, v3 row_shl:4 row_mask:0xf bank_mask:0xf bound_ctrl:0
  v_and_b32_dpp v17, v37, v4 row_shl:4 row_mask:0xf bank_mask:0xf bound_ctrl:0
  v_mfma_f32_16x16x32_bf16 v[32:35], v[12:15], v[96:99], v[32:35]
  v_add_f32 v53, v53, v38
  v_cvt_pk_bf16_f32 v38, v38, v38
  v_mfma_f32_16x16x32_bf16 v[24:27], v[16:19], v[100:103], v[24:27]
  v_and_b32 v12, v38, v3
  v_and_b32 v13, v38, v4
  v_mfma_f32_16x16x32_bf16 v[28:31], v[16:19], v[104:107], v[28:31]
  v_and_b32_dpp v14, v38, v5 row_shr:4 row_mask:0xf bank_mask:0xf bound_ctrl:0
  v_and_b32_dpp v15, v38, v6 row_shr:4 row_mask:0xf bank_mask:0xf bound_ctrl:0
  v_mfma_f32_16x16x32_bf16 v[32:35], v[16:19], v[108:111], v[32:35]
  v_subrev_f32 v39, s34, v39
  v_exp_f32 v39, v39
  v_mfma_f32_16x16x32_bf16 v[24:27], v[12:15], v[112:115], v[24:27]
  v_and_b32 v18, v38, v5
  v_and_b32 v19, v38, v6
  v_mfma_f32_16x16x32_bf16 v[28:31], v[12:15], v[116:119], v[28:31]
  v_and_b32_dpp v16, v38, v3 row_shl:4 row_mask:0xf bank_mask:0xf bound_ctrl:0
  v_and_b32_dpp v17, v38, v4 row_shl:4 row_mask:0xf bank_mask:0xf bound_ctrl:0
  v_mfma_f32_16x16x32_bf16 v[32:35], v[12:15], v[120:123], v[32:35]
  v_add_f32 v53, v53, v39
  v_cvt_pk_bf16_f32 v39, v39, v39
  v_mfma_f32_16x16x32_bf16 v[24:27], v[16:19], v[124:127], v[24:27]
  v_and_b32 v12, v39, v3
  v_and_b32 v13, v39, v4
  v_mfma_f32_16x16x32_bf16 v[28:31], v[16:19], v[128:131], v[28:31]
  v_and_b32_dpp v14, v39, v5 row_shr:4 row_mask:0xf bank_mask:0xf bound_ctrl:0
  v_and_b32_dpp v15, v39, v6 row_shr:4 row_mask:0xf bank_mask:0xf bound_ctrl:0
  v_mfma_f32_16x16x32_bf16 v[32:35], v[16:19], v[132:135], v[32:35]
  v_subrev_f32 v40, s34, v40
  v_exp_f32 v40, v40
  v_mfma_f32_16x16x32_bf16 v[24:27], v[12:15], v[136:139], v[24:27]
  v_and_b32 v18, v39, v5
  v_and_b32 v19, v39, v6
  v_mfma_f32_16x16x32_bf16 v[28:31], v[12:15], v[140:143], v[28:31]
  v_and_b32_dpp v16, v39, v3 row_shl:4 row_mask:0xf bank_mask:0xf bound_ctrl:0
  v_and_b32_dpp v17, v39, v4 row_shl:4 row_mask:0xf bank_mask:0xf bound_ctrl:0
  v_mfma_f32_16x16x32_bf16 v[32:35], v[12:15], v[144:147], v[32:35]
  v_add_f32 v53, v53, v40
  v_cvt_pk_bf16_f32 v40, v40, v40
  v_mfma_f32_16x16x32_bf16 v[24:27], v[16:19], v[148:151], v[24:27]
  v_and_b32 v12, v40, v3
  v_and_b32 v13, v40, v4
  v_mfma_f32_16x16x32_bf16 v[28:31], v[16:19], v[152:155], v[28:31]
  v_and_b32_dpp v14, v40, v5 row_shr:4 row_mask:0xf bank_mask:0xf bound_ctrl:0
  v_and_b32_dpp v15, v40, v6 row_shr:4 row_mask:0xf bank_mask:0xf bound_ctrl:0
  v_mfma_f32_16x16x32_bf16 v[32:35], v[16:19], v[156:159], v[32:35]
  v_subrev_f32 v41, s34, v41
  v_exp_f32 v41, v41
  v_mfma_f32_16x16x32_bf16 v[24:27], v[12:15], v[160:163], v[24:27]
  v_and_b32 v18, v40, v5
  v_and_b32 v19, v40, v6
  v_mfma_f32_16x16x32_bf16 v[28:31], v[12:15], v[164:167], v[28:31]
  v_and_b32_dpp v16, v40, v3 row_shl:4 row_mask:0xf bank_mask:0xf bound_ctrl:0
  v_and_b32_dpp v17, v40, v4 row_shl:4 row_mask:0xf bank_mask:0xf bound_ctrl:0
  v_mfma_f32_16x16x32_bf16 v[32:35], v[12:15], v[168:171], v[32:35]
  v_add_f32 v53, v53, v41
  v_cvt_pk_bf16_f32 v41, v41, v41
  v_mfma_f32_16x16x32_bf16 v[24:27], v[16:19], v[172:175], v[24:27]
  v_and_b32 v12, v41, v3
  v_and_b32 v13, v41, v4
  v_mfma_f32_16x16x32_bf16 v[28:31], v[16:19], v[176:179], v[28:31]
  v_and_b32_dpp v14, v41, v5 row_shr:4 row_mask:0xf bank_mask:0xf bound_ctrl:0
  v_and_b32_dpp v15, v41, v6 row_shr:4 row_mask:0xf bank_mask:0xf bound_ctrl:0
  v_mfma_f32_16x16x32_bf16 v[32:35], v[16:19], v[180:183], v[32:35]
  v_subrev_f32 v42, s34, v42
  v_exp_f32 v42, v42
  v_mfma_f32_16x16x32_bf16 v[24:27], v[12:15], v[184:187], v[24:27]
  v_and_b32 v18, v41, v5
  v_and_b32 v19, v41, v6
  v_mfma_f32_16x16x32_bf16 v[28:31], v[12:15], v[188:191], v[28:31]
  v_and_b32_dpp v16, v41, v3 row_shl:4 row_mask:0xf bank_mask:0xf bound_ctrl:0
  v_and_b32_dpp v17, v41, v4 row_shl:4 row_mask:0xf bank_mask:0xf bound_ctrl:0
  v_mfma_f32_16x16x32_bf16 v[32:35], v[12:15], v[192:195], v[32:35]
  v_add_f32 v53, v53, v42
  v_cvt_pk_bf16_f32 v42, v42, v42
  v_mfma_f32_16x16x32_bf16 v[24:27], v[16:19], v[196:199], v[24:27]
  v_and_b32 v12, v42, v3
  v_and_b32 v13, v42, v4
  v_mfma_f32_16x16x32_bf16 v[28:31], v[16:19], v[200:203], v[28:31]
  v_and_b32_dpp v14, v42, v5 row_shr:4 row_mask:0xf bank_mask:0xf bound_ctrl:0
  v_and_b32_dpp v15, v42, v6 row_shr:4 row_mask:0xf bank_mask:0xf bound_ctrl:0
  v_mfma_f32_16x16x32_bf16 v[32:35], v[16:19], v[204:207], v[32:35]
  v_subrev_f32 v43, s34, v43
  v_exp_f32 v43, v43
  v_mfma_f32_16x16x32_bf16 v[24:27], v[12:15], v[208:211], v[24:27]
  v_and_b32 v18, v42, v5
  v_and_b32 v19, v42, v6
  v_mfma_f32_16x16x32_bf16 v[28:31], v[12:15], v[212:215], v[28:31]
  v_and_b32_dpp v16, v42, v3 row_shl:4 row_mask:0xf bank_mask:0xf bound_ctrl:0
  v_and_b32_dpp v17, v42, v4 row_shl:4 row_mask:0xf bank_mask:0xf bound_ctrl:0
  v_mfma_f32_16x16x32_bf16 v[32:35], v[12:15], v[216:219], v[32:35]
  v_add_f32 v53, v53, v43
  v_cvt_pk_bf16_f32 v43, v43, v43
  v_mfma_f32_16x16x32_bf16 v[24:27], v[16:19], v[220:223], v[24:27]
  v_and_b32 v12, v43, v3
  v_and_b32 v13, v43, v4
  v_mfma_f32_16x16x32_bf16 v[28:31], v[16:19], v[224:227], v[28:31]
  v_and_b32_dpp v14, v43, v5 row_shr:4 row_mask:0xf bank_mask:0xf bound_ctrl:0
  v_and_b32_dpp v15, v43, v6 row_shr:4 row_mask:0xf bank_mask:0xf bound_ctrl:0
  v_mfma_f32_16x16x32_bf16 v[32:35], v[16:19], v[228:231], v[32:35]
  s_nop 0
  v_mfma_f32_16x16x32_bf16 v[24:27], v[12:15], v[232:235], v[24:27]
  v_and_b32 v18, v43, v5
  v_and_b32 v19, v43, v6
  v_add_f32_dpp v53, v53, v53 row_ror:8 row_mask:0xf bank_mask:0xf
  v_mfma_f32_16x16x32_bf16 v[28:31], v[12:15], v[236:239], v[28:31]
  v_and_b32_dpp v16, v43, v3 row_shl:4 row_mask:0xf bank_mask:0xf bound_ctrl:0
  v_and_b32_dpp v17, v43, v4 row_shl:4 row_mask:0xf bank_mask:0xf bound_ctrl:0
  v_add_f32_dpp v53, v53, v53 row_ror:4 row_mask:0xf bank_mask:0xf
  v_mfma_f32_16x16x32_bf16 v[32:35], v[12:15], v[240:243], v[32:35]
  s_nop 0
  v_add_f32_dpp v53, v53, v53 row_bcast:15 row_mask:0xa bank_mask:0xf
  v_mfma_f32_16x16x32_bf16 v[24:27], v[16:19], v[244:247], v[24:27]
  s_nop 0
  v_add_f32_dpp v53, v53, v53 row_bcast:31 row_mask:0xc bank_mask:0xf
  v_mfma_f32_16x16x32_bf16 v[28:31], v[16:19], v[248:251], v[28:31]
  s_mov_b64 exec, s[36:37]
  ds_write_b32 v51, v53 offset:16
  s_mov_b64 exec, -1
  v_mfma_f32_16x16x32_bf16 v[32:35], v[16:19], v[252:255], v[32:35]
  s_mov_b32 exec_lo, 0xffffffff
  s_mov_b32 exec_hi, 0x0
  ds_write_b128 v50, v[24:27] offset:0
  s_mov_b32 exec_lo, 0xff00ff
  s_mov_b32 exec_hi, 0xff00ff00
  ds_write_b128 v50, v[28:31] offset:512
  s_mov_b32 exec_lo, 0x0
  s_mov_b32 exec_hi, 0xffffffff
  ds_write_b128 v50, v[32:35] offset:1024
  s_mov_b64 exec, -1
  s_waitcnt lgkmcnt(0)
  s_barrier
  ds_read_b128 v[44:47], v9
  ds_read_b128 v[48:51], v9 offset:16
  ds_read2st64_b32 v[12:13], v10 offset0:0 offset1:3
  ds_read2st64_b32 v[14:15], v10 offset0:6 offset1:9
  ds_read2st64_b32 v[16:17], v10 offset0:12 offset1:15
  ds_read2st64_b32 v[18:19], v10 offset0:18 offset1:21
  s_waitcnt lgkmcnt(5)
  v_max3_f32 v52, v44, v45, v46
  v_max_f32 v52, v52, v47
  v_sub_f32 v44, v44, v52
  v_sub_f32 v45, v45, v52
  v_sub_f32 v46, v46, v52
  v_sub_f32 v47, v47, v52
  v_exp_f32 v44, v44
  v_exp_f32 v45, v45
  v_exp_f32 v46, v46
  v_exp_f32 v47, v47
  s_waitcnt lgkmcnt(3)
  v_add_f32 v12, v12, v13
  s_waitcnt lgkmcnt(2)
  v_add_f32 v14, v14, v15
  s_waitcnt lgkmcnt(1)
  v_add_f32 v16, v16, v17
  s_waitcnt lgkmcnt(0)
  v_add_f32 v18, v18, v19
  v_mul_f32 v20, v44, v12
  v_fmac_f32 v20, v45, v14
  v_fmac_f32 v20, v46, v16
  v_fmac_f32 v20, v47, v18
  v_mul_f32 v53, v44, v48
  v_fmac_f32 v53, v45, v49
  v_mov_b32_dpp v21, v20 quad_perm:[1,1,3,3] row_mask:0xf bank_mask:0xf
  v_fmac_f32 v53, v46, v50
  v_fmac_f32 v53, v47, v51
  v_cvt_pk_bf16_f32 v20, v20, v21
  v_cndmask_b32 v52, v52, v53, s[100:101]
  v_cndmask_b32 v20, v20, v52, s[42:43]
  v_min_u32 v20, -2, v20
  s_mov_b64 exec, s[46:47]
  s_cmp_lg_u32 s60, 0
  s_cbranch_scc0 Le80
  buffer_store_dword v20, v11, s[20:23], s73 offen
Lf81:
  s_mov_b64 exec, -1
  s_cmp_eq_u32 s3, 3
  s_cbranch_scc1 Ls82
  v_bfe_u32 v10, v0, 2, 2
  v_and_b32 v11, 48, v0
  v_add_u32 v10, v10, v11
  v_mul_u32_u24 v10, 160, v10
  v_and_b32 v11, 3, v0
  v_lshl_add_u32 v10, v11, 3, v10
  s_add_u32 s64, s95, 92160
  v_add_u32 v10, s64, v10
  ds_read_b64_tr_b16 v[24:25], v10 offset:0
  ds_read_b64_tr_b16 v[26:27], v10 offset:640
  ds_read_b64_tr_b16 v[28:29], v10 offset:1280
  ds_read_b64_tr_b16 v[30:31], v10 offset:1920
  ds_read_b64_tr_b16 v[32:33], v10 offset:10240
  ds_read_b64_tr_b16 v[34:35], v10 offset:10880
  ds_read_b64_tr_b16 v[36:37], v10 offset:11520
  ds_read_b64_tr_b16 v[38:39], v10 offset:12160
  ds_read_b64_tr_b16 v[40:41], v10 offset:20480
  ds_read_b64_tr_b16 v[42:43], v10 offset:21120
  ds_read_b64_tr_b16 v[44:45], v10 offset:21760
  ds_read_b64_tr_b16 v[46:47], v10 offset:22400
  v_and_b32 v11, 15, v0
  v_lshlrev_b32 v11, 1, v11
  v_and_b32 v9, 32, v0
  v_add3_u32 v11, v11, v9, s95
  s_add_u32 s73, s70, 344064
  buffer_load_dwordx2 v[52:53], v8, s[20:23], s76 offen offset:3072 sc1
  buffer_load_dwordx4 v[12:15], v7, s[20:23], s76 offen offset:0 sc1
  buffer_load_dwordx4 v[16:19], v7, s[20:23], s76 offen offset:128 sc1
  buffer_load_dwordx4 v[20:23], v7, s[20:23], s76 offen offset:256 sc1
  s_waitcnt vmcnt(0)
Lc83:
  s_waitcnt lgkmcnt(10)
  v_mfma_f32_16x16x32_bf16 v[48:51], v[12:15], v[24:27], 0
  v_max3_u32 v9, v52, v53, v12
  v_max3_u32 v9, v9, v13, v14
  v_max3_u32 v9, v9, v15, v16
  s_waitcnt lgkmcnt(6)
  v_mfma_f32_16x16x32_bf16 v[48:51], v[16:19], v[32:35], v[48:51]
  v_max3_u32 v9, v9, v17, v18
  v_max3_u32 v9, v9, v19, v20
  v_max3_u32 v9, v9, v21, v22
  s_waitcnt lgkmcnt(2)
  v_mfma_f32_16x16x32_bf16 v[48:51], v[20:23], v[40:43], v[48:51]
  v_max_u32 v9, v9, v23
  v_cmp_eq_u32 vcc, -1, v9
  s_cbranch_vccnz Lr84
  v_max_f32_dpp v9, v52, v52 row_ror:8 row_mask:0xf bank_mask:0xf
  v_mfma_f32_16x16x32_bf16 v[24:27], v[12:15], v[28:31], 0
  ds_read_b64_tr_b16 v[32:33], v10 offset:32
  ds_read_b64_tr_b16 v[34:35], v10 offset:672
  v_max_f32_dpp v9, v9, v9 row_ror:4 row_mask:0xf bank_mask:0xf
  v_mfma_f32_16x16x32_bf16 v[24:27], v[16:19], v[36:39], v[24:27]
  ds_read_b64_tr_b16 v[40:41], v10 offset:10272
  ds_read_b64_tr_b16 v[42:43], v10 offset:10912
  v_max_f32_dpp v9, v9, v9 row_ror:2 row_mask:0xf bank_mask:0xf
  s_waitcnt lgkmcnt(4)
  v_mfma_f32_16x16x32_bf16 v[24:27], v[20:23], v[44:47], v[24:27]
  v_sub_f32 v52, v52, v9
  v_exp_f32 v52, v52
  ds_read_b64_tr_b16 v[28:29], v10 offset:20512
  ds_read_b64_tr_b16 v[30:31], v10 offset:21152
  v_mul_f32 v53, v52, v53
  ds_read_b64_tr_b16 v[36:37], v10 offset:1312
  ds_read_b64_tr_b16 v[38:39], v10 offset:1952
  v_add_f32_dpp v53, v53, v53 row_ror:8 row_mask:0xf bank_mask:0xf
  ds_read_b64_tr_b16 v[44:45], v10 offset:11552
  ds_read_b64_tr_b16 v[46:47], v10 offset:12192
  v_add_f32_dpp v53, v53, v53 row_ror:4 row_mask:0xf bank_mask:0xf
  v_add_f32 v48, v48, v25
  v_add_f32 v50, v50, v27
  v_add_f32_dpp v53, v53, v53 row_ror:2 row_mask:0xf bank_mask:0xf
  v_mov_b32 v7, v48
  v_mov_b32 v8, v50
  v_rcp_f32 v53, v53
  s_waitcnt lgkmcnt(8)
  v_mfma_f32_16x16x32_bf16 v[48:51], v[12:15], v[32:35], 0
  ds_read_b64_tr_b16 v[32:33], v10 offset:21792
  ds_read_b64_tr_b16 v[34:35], v10 offset:22432
  v_mul_f32 v9, v52, v53
  s_waitcnt lgkmcnt(8)
  v_mfma_f32_16x16x32_bf16 v[48:51], v[16:19], v[40:43], v[48:51]
  s_waitcnt lgkmcnt(6)
  v_mfma_f32_16x16x32_bf16 v[48:51], v[20:23], v[28:31], v[48:51]
  v_mul_f32_dpp v52, v9, v7 row_newbcast:0 row_mask:0xf bank_mask:0xf
  s_waitcnt lgkmcnt(4)
  v_mfma_f32_16x16x32_bf16 v[24:27], v[12:15], v[36:39], 0
  v_mov_b32_dpp v7, v9 row_newbcast:0 row_mask:0xf bank_mask:0xf
  s_waitcnt lgkmcnt(2)
  v_mfma_f32_16x16x32_bf16 v[24:27], v[16:19], v[44:47], v[24:27]
  v_fmac_f32_dpp v52, v9, v8 row_newbcast:2 row_mask:0xf bank_mask:0xf
  s_waitcnt lgkmcnt(0)
  v_mfma_f32_16x16x32_bf16 v[24:27], v[20:23], v[32:35], v[24:27]
  v_mov_b32_dpp v8, v9 row_newbcast:2 row_mask:0xf bank_mask:0xf
  s_nop 6
  v_add_f32 v48, v48, v25
  v_add_f32 v50, v50, v27
  v_mul_f32 v53, v7, v48
  v_fmac_f32 v53, v8, v50
  s_nop 1
  v_permlane32_swap_b32 v52, v53
  v_add_f32 v52, v52, v53
  v_mov_b32 v53, v52
  s_nop 1
  v_permlane16_swap_b32 v52, v53
  v_add_f32 v52, v52, v53
  s_nop 1
  v_mov_b32_dpp v53, v52 quad_perm:[1,1,3,3] row_mask:0xf bank_mask:0xf
  v_cvt_pk_bf16_f32 v52, v52, v53
  v_min_u32 v52, -2, v52
  s_mov_b64 exec, s[80:81]
  buffer_store_dword v52, v11, s[20:23], s73 offen sc1
  s_mov_b64 exec, -1
Ls82:
  v_lshrrev_b32 v54, 4, v0
  v_mul_u32_u24 v54, 192, v54
  v_and_b32 v9, 15, v0
  v_lshl_add_u32 v54, v9, 4, v54
  s_cmp_eq_u32 s58, 1
  s_cbranch_scc1 L_out0
  s_cmp_lg_u32 s58, 0
  s_cbranch_scc1 L_fin
  s_branch Lpg6
.p2align 12
Lst6:
  s_setpc_b64 s[78:79]
Lpg6:
  s_waitcnt vmcnt(0)
  s_waitcnt lgkmcnt(0)
  s_barrier
  s_cmp_lg_u32 s3, 0
  s_cbranch_scc1 L_fin
  v_and_b32 v16, 0x3f803f80, v3
  v_and_b32 v17, 0x3f803f80, v4
  v_and_b32 v18, 0x3f803f80, v5
  v_and_b32 v19, 0x3f803f80, v6
  v_and_b32 v9, 15, v0
  v_lshlrev_b32 v9, 4, v9
  v_bfe_u32 v10, v0, 4, 1
  v_lshl_add_u32 v9, v10, 3, v9
  v_add_u32 v10, 156864, v9
  ds_read_b64 v[10:11], v10
  s_add_u32 s4, s71, 344064
  s_add_u32 s5, s71, 344832
  s_add_u32 s6, s71, 345600
  s_add_u32 s7, s71, 346368
  s_add_u32 s8, s71, 347136
  s_add_u32 s9, s71, 347904
  s_add_u32 s10, s71, 348672
  s_add_u32 s11, s71, 349440
  s_waitcnt lgkmcnt(0)
  v_lshlrev_b32 v12, 16, v10
  v_and_b32 v13, 0xffff0000, v10
  v_lshlrev_b32 v14, 16, v11
  v_and_b32 v15, 0xffff0000, v11
  s_mul_i32 s63, s59, 160
  s_mov_b64 exec, s[32:33]
  buffer_load_dwordx4 v[60:63], v54, s[20:23], s4 offen sc1
  buffer_load_dwordx4 v[64:67], v54, s[20:23], s5 offen sc1
  buffer_load_dwordx4 v[68:71], v54, s[20:23], s6 offen sc1
  buffer_load_dwordx4 v[72:75], v54, s[20:23], s7 offen sc1
  buffer_load_dwordx4 v[76:79], v54, s[20:23], s8 offen sc1
  buffer_load_dwordx4 v[80:83], v54, s[20:23], s9 offen sc1
  buffer_load_dwordx4 v[84:87], v54, s[20:23], s10 offen sc1
  buffer_load_dwordx4 v[88:91], v54, s[20:23], s11 offen sc1
  s_mov_b64 exec, -1
  s_waitcnt vmcnt(0)
Lc85:
  v_mfma_f32_16x16x32_bf16 v[20:23], v[16:19], v[60:63], 0
  v_max3_u32 v7, v60, v61, v62
  v_max3_u32 v7, v7, v63, v64
  v_max3_u32 v7, v7, v65, v66
  v_mfma_f32_16x16x32_bf16 v[20:23], v[16:19], v[64:67], v[20:23]
  v_max3_u32 v7, v7, v67, v68
  v_max3_u32 v7, v7, v69, v70
  v_max3_u32 v7, v7, v71, v72
  v_mfma_f32_16x16x32_bf16 v[20:23], v[16:19], v[68:71], v[20:23]
  v_max3_u32 v7, v7, v73, v74
  v_max3_u32 v7, v7, v75, v76
  v_max3_u32 v7, v7, v77, v78
  v_mfma_f32_16x16x32_bf16 v[20:23], v[16:19], v[72:75], v[20:23]
  v_max3_u32 v7, v7, v79, v80
  v_max3_u32 v7, v7, v81, v82
  v_max3_u32 v7, v7, v83, v84
  v_mfma_f32_16x16x32_bf16 v[20:23], v[16:19], v[76:79], v[20:23]
  v_max3_u32 v7, v7, v85, v86
  v_max3_u32 v7, v7, v87, v88
  v_max3_u32 v7, v7, v89, v90
  v_mfma_f32_16x16x32_bf16 v[20:23], v[16:19], v[80:83], v[20:23]
  v_max_u32 v7, v7, v91
  v_cmp_eq_u32 vcc, -1, v7
  v_mfma_f32_16x16x32_bf16 v[20:23], v[16:19], v[84:87], v[20:23]
  v_mfma_f32_16x16x32_bf16 v[20:23], v[16:19], v[88:91], v[20:23]
  s_and_b64 vcc, vcc, s[32:33]
  s_cbranch_vccnz Lr86
  s_mov_b32 exec_lo, s32
  s_mov_b32 exec_hi, 0
  s_nop 3
  v_cvt_pk_bf16_f32 v20, v20, v21
  v_cvt_pk_bf16_f32 v22, v22, v23
  v_and_b32 v21, 0xffff0000, v20
  v_lshlrev_b32 v20, 16, v20
  v_and_b32 v23, 0xffff0000, v22
  v_lshlrev_b32 v22, 16, v22
  v_pk_add_f32 v[20:21], v[20:21], v[12:13]
  v_pk_add_f32 v[22:23], v[22:23], v[14:15]
  v_cvt_pk_bf16_f32 v20, v20, v21
  v_cvt_pk_bf16_f32 v21, v22, v23
  buffer_store_dwordx2 v[20:21], v9, s[28:31], s63 offen offset:1280
  s_mov_b64 exec, -1
  s_branch L_fin
L_out0:
  s_nop 7
  s_waitcnt vmcnt(0) lgkmcnt(0)
  s_cmp_lg_u32 s3, 0
  s_cbranch_scc1 L_fin
  v_and_b32 v16, 0x3f803f80, v3
  v_and_b32 v17, 0x3f803f80, v4
  v_and_b32 v18, 0x3f803f80, v5
  v_and_b32 v19, 0x3f803f80, v6
  v_and_b32 v9, 15, v0
  v_lshlrev_b32 v9, 4, v9
  v_bfe_u32 v10, v0, 4, 1
  v_lshl_add_u32 v9, v10, 3, v9
  v_add_u32 v10, 156224, v9
  ds_read_b64 v[10:11], v10
  s_add_u32 s4, s71, 147456
  s_add_u32 s5, s71, 148224
  s_add_u32 s6, s71, 148992
  s_add_u32 s7, s71, 149760
  s_add_u32 s8, s71, 150528
  s_add_u32 s9, s71, 151296
  s_add_u32 s10, s71, 152064
  s_add_u32 s11, s71, 152832
  s_waitcnt lgkmcnt(0)
  v_lshlrev_b32 v12, 16, v10
  v_and_b32 v13, 0xffff0000, v10
  v_lshlrev_b32 v14, 16, v11
  v_and_b32 v15, 0xffff0000, v11
  s_mul_i32 s63, s59, 160
  s_mov_b64 exec, s[32:33]
  buffer_load_dwordx4 v[60:63], v54, s[20:23], s4 offen sc1
  buffer_load_dwordx4 v[64:67], v54, s[20:23], s5 offen sc1
  buffer_load_dwordx4 v[68:71], v54, s[20:23], s6 offen sc1
  buffer_load_dwordx4 v[72:75], v54, s[20:23], s7 offen sc1
  buffer_load_dwordx4 v[76:79], v54, s[20:23], s8 offen sc1
  buffer_load_dwordx4 v[80:83], v54, s[20:23], s9 offen sc1
  buffer_load_dwordx4 v[84:87], v54, s[20:23], s10 offen sc1
  buffer_load_dwordx4 v[88:91], v54, s[20:23], s11 offen sc1
  s_mov_b64 exec, -1
  s_waitcnt vmcnt(0)
Lc87:
  v_mfma_f32_16x16x32_bf16 v[20:23], v[16:19], v[60:63], 0
  v_max3_u32 v7, v60, v61, v62
  v_max3_u32 v7, v7, v63, v64
  v_max3_u32 v7, v7, v65, v66
  v_mfma_f32_16x16x32_bf16 v[20:23], v[16:19], v[64:67], v[20:23]
  v_max3_u32 v7, v7, v67, v68
  v_max3_u32 v7, v7, v69, v70
  v_max3_u32 v7, v7, v71, v72
  v_mfma_f32_16x16x32_bf16 v[20:23], v[16:19], v[68:71], v[20:23]
  v_max3_u32 v7, v7, v73, v74
  v_max3_u32 v7, v7, v75, v76
  v_max3_u32 v7, v7, v77, v78
  v_mfma_f32_16x16x32_bf16 v[20:23], v[16:19], v[72:75], v[20:23]
  v_max3_u32 v7, v7, v79, v80
  v_max3_u32 v7, v7, v81, v82
  v_max3_u32 v7, v7, v83, v84
  v_mfma_f32_16x16x32_bf16 v[20:23], v[16:19], v[76:79], v[20:23]
  v_max3_u32 v7, v7, v85, v86
  v_max3_u32 v7, v7, v87, v88
  v_max3_u32 v7, v7, v89, v90
  v_mfma_f32_16x16x32_bf16 v[20:23], v[16:19], v[80:83], v[20:23]
  v_max_u32 v7, v7, v91
  v_cmp_eq_u32 vcc, -1, v7
  v_mfma_f32_16x16x32_bf16 v[20:23], v[16:19], v[84:87], v[20:23]
  v_mfma_f32_16x16x32_bf16 v[20:23], v[16:19], v[88:91], v[20:23]
  s_and_b64 vcc, vcc, s[32:33]
  s_cbranch_vccnz Lr88
  s_mov_b32 exec_lo, s32
  s_mov_b32 exec_hi, 0
  s_nop 3
  v_cvt_pk_bf16_f32 v20, v20, v21
  v_cvt_pk_bf16_f32 v22, v22, v23
  v_and_b32 v21, 0xffff0000, v20
  v_lshlrev_b32 v20, 16, v20
  v_and_b32 v23, 0xffff0000, v22
  v_lshlrev_b32 v22, 16, v22
  v_pk_add_f32 v[20:21], v[20:21], v[12:13]
  v_pk_add_f32 v[22:23], v[22:23], v[14:15]
  v_cvt_pk_bf16_f32 v20, v20, v21
  v_cvt_pk_bf16_f32 v21, v22, v23
  buffer_store_dwordx2 v[20:21], v9, s[28:31], s63 offen offset:0
  s_mov_b64 exec, -1
L_fin:
  s_nop 7
L_end:
  s_endpgm
.p2align 12
LstR:
  s_setpc_b64 s[78:79]
Lr25:
  s_mov_b64 exec, vcc
  buffer_load_dwordx2 v[52:53], v8, s[20:23], s76 offen offset:3072 sc1
  buffer_load_dwordx4 v[12:15], v7, s[20:23], s76 offen offset:0 sc1
  buffer_load_dwordx4 v[16:19], v7, s[20:23], s76 offen offset:128 sc1
  buffer_load_dwordx4 v[20:23], v7, s[20:23], s76 offen offset:256 sc1
  s_mov_b64 exec, -1
  s_add_u32 s62, s62, 1
  s_cmp_gt_u32 s62, 2000000
  s_cbranch_scc1 L_end
  s_waitcnt vmcnt(0)
  s_branch Lc24
Lr27:
  s_mov_b64 exec, vcc
  buffer_load_dwordx4 v[8:11], v54, s[20:23], s72 offen sc1
  buffer_load_dwordx4 v[12:15], v54, s[20:23], s35 offen sc1
  s_mov_b64 exec, -1
  s_add_u32 s62, s62, 1
  s_cmp_gt_u32 s62, 2000000
  s_cbranch_scc1 L_end
  s_waitcnt vmcnt(0)
  s_branch Lc26
Lr31:
  s_mov_b64 exec, vcc
  buffer_load_dwordx4 v[12:15], v54, s[20:23], s72 offen sc1
  buffer_load_dwordx4 v[16:19], v54, s[20:23], s35 offen sc1
  s_mov_b64 exec, -1
  s_add_u32 s62, s62, 1
  s_cmp_gt_u32 s62, 2000000
  s_cbranch_scc1 L_end
  s_waitcnt vmcnt(0)
  s_branch Lc30
Lr36:
  s_mov_b64 exec, vcc
  buffer_load_dwordx2 v[52:53], v8, s[20:23], s76 offen offset:3072 sc1
  buffer_load_dwordx4 v[12:15], v7, s[20:23], s76 offen offset:0 sc1
  buffer_load_dwordx4 v[16:19], v7, s[20:23], s76 offen offset:128 sc1
  buffer_load_dwordx4 v[20:23], v7, s[20:23], s76 offen offset:256 sc1
  s_mov_b64 exec, -1
  s_add_u32 s62, s62, 1
  s_cmp_gt_u32 s62, 2000000
  s_cbranch_scc1 L_end
  s_waitcnt vmcnt(0)
  s_branch Lc35
Lr38:
  s_mov_b64 exec, vcc
  buffer_load_dwordx4 v[8:11], v54, s[20:23], s72 offen sc1
  buffer_load_dwordx4 v[12:15], v54, s[20:23], s35 offen sc1
  s_mov_b64 exec, -1
  s_add_u32 s62, s62, 1
  s_cmp_gt_u32 s62, 2000000
  s_cbranch_scc1 L_end
  s_waitcnt vmcnt(0)
  s_branch Lc37
Lr42:
  s_mov_b64 exec, vcc
  buffer_load_dwordx4 v[12:15], v54, s[20:23], s72 offen sc1
  buffer_load_dwordx4 v[16:19], v54, s[20:23], s35 offen sc1
  s_mov_b64 exec, -1
  s_add_u32 s62, s62, 1
  s_cmp_gt_u32 s62, 2000000
  s_cbranch_scc1 L_end
  s_waitcnt vmcnt(0)
  s_branch Lc41
Lr62:
  s_mov_b64 exec, vcc
  buffer_load_dwordx2 v[52:53], v8, s[20:23], s76 offen offset:3072 sc1
  buffer_load_dwordx4 v[12:15], v7, s[20:23], s76 offen offset:0 sc1
  buffer_load_dwordx4 v[16:19], v7, s[20:23], s76 offen offset:128 sc1
  buffer_load_dwordx4 v[20:23], v7, s[20:23], s76 offen offset:256 sc1
  s_mov_b64 exec, -1
  s_add_u32 s62, s62, 1
  s_cmp_gt_u32 s62, 2000000
  s_cbranch_scc1 L_end
  s_waitcnt vmcnt(0)
  s_branch Lc61
Lr64:
  s_mov_b64 exec, vcc
  buffer_load_dwordx4 v[8:11], v54, s[20:23], s72 offen sc1
  buffer_load_dwordx4 v[12:15], v54, s[20:23], s35 offen sc1
  s_mov_b64 exec, -1
  s_add_u32 s62, s62, 1
  s_cmp_gt_u32 s62, 2000000
  s_cbranch_scc1 L_end
  s_waitcnt vmcnt(0)
  s_branch Lc63
Lr68:
  s_mov_b64 exec, vcc
  buffer_load_dwordx4 v[12:15], v54, s[20:23], s72 offen sc1
  buffer_load_dwordx4 v[16:19], v54, s[20:23], s35 offen sc1
  s_mov_b64 exec, -1
  s_add_u32 s62, s62, 1
  s_cmp_gt_u32 s62, 2000000
  s_cbranch_scc1 L_end
  s_waitcnt vmcnt(0)
  s_branch Lc67
Lr73:
  s_mov_b64 exec, vcc
  buffer_load_dwordx2 v[52:53], v8, s[20:23], s76 offen offset:3072 sc1
  buffer_load_dwordx4 v[12:15], v7, s[20:23], s76 offen offset:0 sc1
  buffer_load_dwordx4 v[16:19], v7, s[20:23], s76 offen offset:128 sc1
  buffer_load_dwordx4 v[20:23], v7, s[20:23], s76 offen offset:256 sc1
  s_mov_b64 exec, -1
  s_add_u32 s62, s62, 1
  s_cmp_gt_u32 s62, 2000000
  s_cbranch_scc1 L_end
  s_waitcnt vmcnt(0)
  s_branch Lc72
Lr75:
  s_mov_b64 exec, vcc
  buffer_load_dwordx4 v[8:11], v54, s[20:23], s72 offen sc1
  buffer_load_dwordx4 v[12:15], v54, s[20:23], s35 offen sc1
  s_mov_b64 exec, -1
  s_add_u32 s62, s62, 1
  s_cmp_gt_u32 s62, 2000000
  s_cbranch_scc1 L_end
  s_waitcnt vmcnt(0)
  s_branch Lc74
Lr79:
  s_mov_b64 exec, vcc
  buffer_load_dwordx4 v[12:15], v54, s[20:23], s72 offen sc1
  buffer_load_dwordx4 v[16:19], v54, s[20:23], s35 offen sc1
  s_mov_b64 exec, -1
  s_add_u32 s62, s62, 1
  s_cmp_gt_u32 s62, 2000000
  s_cbranch_scc1 L_end
  s_waitcnt vmcnt(0)
  s_branch Lc78
Lr84:
  s_mov_b64 exec, vcc
  buffer_load_dwordx2 v[52:53], v8, s[20:23], s76 offen offset:3072 sc1
  buffer_load_dwordx4 v[12:15], v7, s[20:23], s76 offen offset:0 sc1
  buffer_load_dwordx4 v[16:19], v7, s[20:23], s76 offen offset:128 sc1
  buffer_load_dwordx4 v[20:23], v7, s[20:23], s76 offen offset:256 sc1
  s_mov_b64 exec, -1
  s_add_u32 s62, s62, 1
  s_cmp_gt_u32 s62, 2000000
  s_cbranch_scc1 L_end
  s_waitcnt vmcnt(0)
  s_branch Lc83
Lr86:
  s_mov_b64 exec, vcc
  buffer_load_dwordx4 v[60:63], v54, s[20:23], s4 offen sc1
  buffer_load_dwordx4 v[64:67], v54, s[20:23], s5 offen sc1
  buffer_load_dwordx4 v[68:71], v54, s[20:23], s6 offen sc1
  buffer_load_dwordx4 v[72:75], v54, s[20:23], s7 offen sc1
  buffer_load_dwordx4 v[76:79], v54, s[20:23], s8 offen sc1
  buffer_load_dwordx4 v[80:83], v54, s[20:23], s9 offen sc1
  buffer_load_dwordx4 v[84:87], v54, s[20:23], s10 offen sc1
  buffer_load_dwordx4 v[88:91], v54, s[20:23], s11 offen sc1
  s_mov_b64 exec, -1
  s_add_u32 s62, s62, 1
  s_cmp_gt_u32 s62, 2000000
  s_cbranch_scc1 L_end
  s_waitcnt vmcnt(0)
  s_branch Lc85
Lr88:
  s_mov_b64 exec, vcc
  buffer_load_dwordx4 v[60:63], v54, s[20:23], s4 offen sc1
  buffer_load_dwordx4 v[64:67], v54, s[20:23], s5 offen sc1
  buffer_load_dwordx4 v[68:71], v54, s[20:23], s6 offen sc1
  buffer_load_dwordx4 v[72:75], v54, s[20:23], s7 offen sc1
  buffer_load_dwordx4 v[76:79], v54, s[20:23], s8 offen sc1
  buffer_load_dwordx4 v[80:83], v54, s[20:23], s9 offen sc1
  buffer_load_dwordx4 v[84:87], v54, s[20:23], s10 offen sc1
  buffer_load_dwordx4 v[88:91], v54, s[20:23], s11 offen sc1
  s_mov_b64 exec, -1
  s_add_u32 s62, s62, 1
  s_cmp_gt_u32 s62, 2000000
  s_cbranch_scc1 L_end
  s_waitcnt vmcnt(0)
  s_branch Lc87
Lr3:
  global_load_dword v8, v7, s[54:55] sc1
  s_add_u32 s62, s62, 1
  s_cmp_gt_u32 s62, 2000000
  s_cbranch_scc1 L_end
  s_waitcnt vmcnt(0)
  s_branch Lc2
Lr5:
  s_mov_b64 exec, vcc
  buffer_load_dwordx4 v[12:15], v54, s[20:23], s72 offen sc1
  buffer_load_dwordx4 v[16:19], v54, s[20:23], s35 offen sc1
  buffer_load_dwordx4 v[20:23], v54, s[20:23], s72 offen offset:1024 sc1
  buffer_load_dwordx4 v[24:27], v54, s[20:23], s35 offen offset:1024 sc1
  s_mov_b64 exec, -1
  s_add_u32 s62, s62, 1
  s_cmp_gt_u32 s62, 2000000
  s_cbranch_scc1 L_end
  s_waitcnt vmcnt(0)
  s_branch Lc4
Le6:
  buffer_store_dword v20, v11, s[20:23], s73 offen sc1
  s_branch Lf7
Lr9:
  s_mov_b64 exec, vcc
  buffer_load_dwordx4 v[12:15], v54, s[20:23], s72 offen sc1
  buffer_load_dwordx4 v[16:19], v54, s[20:23], s35 offen sc1
  s_mov_b64 exec, -1
  s_add_u32 s62, s62, 1
  s_cmp_gt_u32 s62, 2000000
  s_cbranch_scc1 L_end
  s_waitcnt vmcnt(0)
  s_branch Lc8
Lr11:
  s_mov_b64 exec, vcc
  buffer_load_dwordx2 v[52:53], v8, s[20:23], s76 offen offset:3072 sc1
  buffer_load_dwordx4 v[12:15], v7, s[20:23], s76 offen offset:0 sc1
  buffer_load_dwordx4 v[16:19], v7, s[20:23], s76 offen offset:128 sc1
  buffer_load_dwordx4 v[20:23], v7, s[20:23], s76 offen offset:256 sc1
  s_mov_b64 exec, -1
  s_add_u32 s62, s62, 1
  s_cmp_gt_u32 s62, 2000000
  s_cbranch_scc1 L_end
  s_waitcnt vmcnt(0)
  s_branch Lc10
Lr13:
  s_mov_b64 exec, vcc
  buffer_load_dwordx4 v[8:11], v54, s[20:23], s72 offen sc1
  buffer_load_dwordx4 v[12:15], v54, s[20:23], s35 offen sc1
  s_mov_b64 exec, -1
  s_add_u32 s62, s62, 1
  s_cmp_gt_u32 s62, 2000000
  s_cbranch_scc1 L_end
  s_waitcnt vmcnt(0)
  s_branch Lc12
Le14:
  buffer_store_dword v22, v7, s[20:23], s73 offen offset:0 sc1
  s_branch Lf15
Le16:
  buffer_store_dword v23, v7, s[20:23], s73 offen offset:1024 sc1
  s_branch Lf17
Lr20:
  s_mov_b64 exec, vcc
  buffer_load_dwordx4 v[12:15], v54, s[20:23], s72 offen sc1
  buffer_load_dwordx4 v[16:19], v54, s[20:23], s35 offen sc1
  buffer_load_dwordx4 v[20:23], v54, s[20:23], s72 offen offset:1024 sc1
  buffer_load_dwordx4 v[24:27], v54, s[20:23], s35 offen offset:1024 sc1
  s_mov_b64 exec, -1
  s_add_u32 s62, s62, 1
  s_cmp_gt_u32 s62, 2000000
  s_cbranch_scc1 L_end
  s_waitcnt vmcnt(0)
  s_branch Lc19
Le21:
  buffer_store_dword v20, v11, s[20:23], s73 offen sc1
  s_branch Lf22
Le28:
  buffer_store_dword v22, v7, s[20:23], s73 offen sc1
  s_branch Lf29
Le32:
  buffer_store_dword v20, v11, s[20:23], s73 offen sc1
  s_branch Lf33
Le39:
  buffer_store_dword v22, v7, s[20:23], s73 offen sc1
  s_branch Lf40
Le43:
  buffer_store_dword v20, v11, s[20:23], s73 offen sc1
  s_branch Lf44
Le45:
  buffer_store_dword v20, v11, s[20:23], s73 offen sc1
  s_branch Lf46
Lr48:
  s_mov_b64 exec, vcc
  buffer_load_dwordx2 v[52:53], v8, s[20:23], s76 offen offset:3072 sc1
  buffer_load_dwordx4 v[12:15], v7, s[20:23], s76 offen offset:0 sc1
  buffer_load_dwordx4 v[16:19], v7, s[20:23], s76 offen offset:128 sc1
  buffer_load_dwordx4 v[20:23], v7, s[20:23], s76 offen offset:256 sc1
  s_mov_b64 exec, -1
  s_add_u32 s62, s62, 1
  s_cmp_gt_u32 s62, 2000000
  s_cbranch_scc1 L_end
  s_waitcnt vmcnt(0)
  s_branch Lc47
Lr50:
  s_mov_b64 exec, vcc
  buffer_load_dwordx2 v[52:53], v8, s[20:23], s76 offen offset:3072 sc1
  buffer_load_dwordx4 v[12:15], v7, s[20:23], s76 offen offset:0 sc1
  buffer_load_dwordx4 v[16:19], v7, s[20:23], s76 offen offset:128 sc1
  buffer_load_dwordx4 v[20:23], v7, s[20:23], s76 offen offset:256 sc1
  s_mov_b64 exec, -1
  s_add_u32 s62, s62, 1
  s_cmp_gt_u32 s62, 2000000
  s_cbranch_scc1 L_end
  s_waitcnt vmcnt(0)
  s_branch Lc49
Lr52:
  s_mov_b64 exec, vcc
  buffer_load_dwordx4 v[8:11], v54, s[20:23], s72 offen sc1
  buffer_load_dwordx4 v[12:15], v54, s[20:23], s35 offen sc1
  s_mov_b64 exec, -1
  s_add_u32 s62, s62, 1
  s_cmp_gt_u32 s62, 2000000
  s_cbranch_scc1 L_end
  s_waitcnt vmcnt(0)
  s_branch Lc51
Le53:
  buffer_store_dword v22, v7, s[20:23], s73 offen offset:0 sc1
  s_branch Lf54
Lr57:
  s_mov_b64 exec, vcc
  buffer_load_dwordx4 v[12:15], v54, s[20:23], s72 offen sc1
  buffer_load_dwordx4 v[16:19], v54, s[20:23], s35 offen sc1
  s_mov_b64 exec, -1
  s_add_u32 s62, s62, 1
  s_cmp_gt_u32 s62, 2000000
  s_cbranch_scc1 L_end
  s_waitcnt vmcnt(0)
  s_branch Lc56
Le58:
  buffer_store_dword v20, v11, s[20:23], s73 offen sc1
  s_branch Lf59
Le65:
  buffer_store_dword v22, v7, s[20:23], s73 offen sc1
  s_branch Lf66
Le69:
  buffer_store_dword v20, v11, s[20:23], s73 offen sc1
  s_branch Lf70
Le76:
  buffer_store_dword v22, v7, s[20:23], s73 offen sc1
  s_branch Lf77
Le80:
  buffer_store_dword v20, v11, s[20:23], s73 offen sc1
  s_branch Lf81
L_pf9:
  s_endpgm
.section .rodata,"a"
.p2align 6
.amdhsa_kernel interleave_layers__sliding_block_cached__gqa_block_cached__decode_kernel
  .amdhsa_next_free_vgpr 512
  .amdhsa_next_free_sgpr 102
  .amdhsa_accum_offset 256
  .amdhsa_group_segment_fixed_size 0
  .amdhsa_kernarg_size 104
  .amdhsa_user_sgpr_count 2
  .amdhsa_user_sgpr_kernarg_segment_ptr 1
  .amdhsa_system_sgpr_workgroup_id_x 1
.end_amdhsa_kernel
```
